```python
import torch

def _softmax(x, axis=-1):
    return torch.softmax(x, dim=axis)
def _gelu(x):
    return torch.nn.functional.gelu(x, approximate="tanh")
def _silu(x):
    return torch.nn.functional.silu(x)
def _sigmoid(x):
    return torch.sigmoid(x)
def _layernorm(x, axis=-1, eps=1e-5):
    m = x.mean(dim=axis, keepdim=True)
    v = x.var(dim=axis, keepdim=True, unbiased=False)
    return (x - m) / torch.sqrt(v + eps)
def _scatter_add(tgt, idx, src, axis=0):
    return tgt.clone().index_add_(axis, idx, src)
def _segment_sum(src, seg, n):
    out = torch.zeros((n,) + src.shape[1:], dtype=src.dtype)
    return out.index_add_(0, seg, src)
def _pad(x, pw):
    flat = tuple(v for pair in reversed(pw) for v in pair)
    return torch.nn.functional.pad(x, flat)

kernel_name = 'interleave_layers__ssm_conv_h3__glu_gated_geglu__prompt'

def setup_inputs():

    _w = (lambda a: (lambda t: t.to(torch.bfloat16) if t.is_floating_point() else t)(torch.as_tensor(a)))
    def _A_setup():
        B, S, D = 1, 2048, 640
        ks = 4
        return {
            "q": _w((lambda *s: torch.randn(*s, dtype=torch.bfloat16) * 0.05)(B, S, D)),
            "k": _w((lambda *s: torch.randn(*s, dtype=torch.bfloat16) * 0.2)(B, S, D)),
            "v": _w((lambda *s: torch.randn(*s, dtype=torch.bfloat16) * 0.2)(B, S, D)),
            "shift_k": _w((lambda *s: torch.randn(*s, dtype=torch.bfloat16) * 0.2)(D, ks) * 0.5),
            "ssm_k": _w((lambda *s: torch.randn(*s, dtype=torch.bfloat16) * 0.8)(D, S) * (1.0 / S ** 0.5)),
            "ssm_D": _w((lambda *s: torch.randn(*s, dtype=torch.bfloat16) * 0.2)(D)),
        }
    _A_in = _A_setup()

    def _B_setup():
        B, S, Dm, Df = 1, 2048, 640, 1728
        return {
            "x": _w((lambda *s: torch.randn(*s, dtype=torch.bfloat16) * 0.05)(B, S, Dm)),
            "w_gate": _w((lambda *s: torch.randn(*s, dtype=torch.bfloat16) * 0.4)(Dm, Df) * (Dm ** -0.5)),
            "w_up": _w((lambda *s: torch.randn(*s, dtype=torch.bfloat16) * 0.4)(Dm, Df) * (Dm ** -0.5)),
            "w_down": _w((lambda *s: torch.randn(*s, dtype=torch.bfloat16) * 0.4)(Df, Dm) * (Df ** -0.5)),
        }
    _B_in = _B_setup()

    return {
        "A_q": _A_in["q"],
        "A_k": _A_in["k"],
        "A_v": _A_in["v"],
        "A_shift_k": _A_in["shift_k"],
        "A_ssm_k": _A_in["ssm_k"],
        "A_ssm_D": _A_in["ssm_D"],
        "B_x": _B_in["x"],
        "B_w_gate": _B_in["w_gate"],
        "B_w_up": _B_in["w_up"],
        "B_w_down": _B_in["w_down"],
    }

def reference(A_q, A_k, A_v, A_shift_k, A_ssm_k, A_ssm_D, B_x, B_w_gate, B_w_up, B_w_down):
    def _A_ref(q, k, v, shift_k, ssm_k, ssm_D):
        B, S, D = q.shape
        ks = shift_k.shape[-1]
        k_pad = _pad(k, ((0, 0), (ks - 1, 0), (0, 0)))
        k_shift = torch.zeros_like(k)
        for t in range(ks):
            k_shift = k_shift + k_pad[:, t:t + S, :] * shift_k[:, ks - 1 - t][None, None, :]
        kv = k_shift * v
        L = 2 * S
        kv_pad = _pad(kv, ((0, 0), (0, S), (0, 0)))
        kf_pad = _pad(ssm_k, ((0, 0), (0, S)))
        kv_f = (lambda x, axes=(-2,-1): torch.fft.rfft2(x.float(), dim=axes))(kv_pad[:, None, :, :], axes=(1, 2))
        kf_f = (lambda x, axes=(-2,-1): torch.fft.rfft2(x.float(), dim=axes))(kf_pad[:, None, :], axes=(1, 2))
        kf_f = (lambda x, *d: x.permute(*d))(kf_f, 1, 2, 0)
        y_f = kv_f * kf_f[None, :, :, :]
        y = (lambda x, s, axes=(-2,-1): torch.fft.irfft2(x, s=s, dim=axes).to(torch.bfloat16))(y_f, (1, L), axes=(1, 2))[:, 0, :S, :]
        y = y + kv * ssm_D[None, None, :]
        return q * y

    def _B_ref(x, w_gate, w_up, w_down):
        g = torch.einsum("bsd,df->bsf", x, w_gate)
        u = torch.einsum("bsd,df->bsf", x, w_up)
        h = _gelu(g) * u
        return torch.einsum("bsf,fd->bsd", h, w_down)

    x = A_q
    x = x + _A_ref(_layernorm(x, axis=-1), A_k, A_v, A_shift_k, A_ssm_k, A_ssm_D)
    x = x + _B_ref(_layernorm(x, axis=-1), B_w_gate, B_w_up, B_w_down)
    x = x + _A_ref(_layernorm(x, axis=-1), A_k, A_v, A_shift_k, A_ssm_k, A_ssm_D)
    x = x + _B_ref(_layernorm(x, axis=-1), B_w_gate, B_w_up, B_w_down)
    return x
```

```asm
; @launch grid=(256,1,1) block=(256,1,1) lds=163840
.amdgcn_target "amdgcn-amd-amdhsa--gfx950"
.text
.globl interleave_layers__ssm_conv_h3__glu_gated_geglu__prompt_kernel
.p2align 8
.type interleave_layers__ssm_conv_h3__glu_gated_geglu__prompt_kernel,@function
interleave_layers__ssm_conv_h3__glu_gated_geglu__prompt_kernel:
    s_cmp_ge_u32 s2, 256
    s_cbranch_scc1 L_exit
    s_load_dwordx16 s[16:31], s[0:1], 0
    s_load_dwordx8 s[32:39], s[0:1], 64
    s_load_dwordx2 s[40:41], s[0:1], 96
    s_getpc_b64 s[96:97]
L_pc:
    s_sub_u32 s96, s96, L_pc-interleave_layers__ssm_conv_h3__glu_gated_geglu__prompt_kernel
    s_subb_u32 s97, s97, 0
    s_lshl_b32 s65, s2, 8
    s_and_b32 s65, s65, 0xf800
    v_lshlrev_b32 v254, 3, v0
    v_and_b32 v254, 0x780, v254
    v_add_u32 v254, s65, v254
    v_min_u32 v254, L_exit-interleave_layers__ssm_conv_h3__glu_gated_geglu__prompt_kernel, v254
    global_load_dword v254, v254, s[96:97]
    v_lshrrev_b32 v2, 6, v0
    v_and_b32 v0, 63, v0
    v_readfirstlane_b32 s52, v2
    s_and_b32 s53, s2, 7
    s_lshr_b32 s54, s2, 3
    s_mov_b32 s60, 0xffff0000
    v_lshlrev_b32 v1, 4, v0
    s_cmp_ge_u32 s54, 20
    s_cbranch_scc1 L_shuf
    s_mul_i32 s58, s53, 20
    s_add_u32 s58, s58, s54
    s_lshr_b32 s59, s58, 4
    s_and_b32 s64, s58, 15
    s_lshl_b32 s64, s64, 7
    s_lshl_b32 s65, s52, 5
    s_add_u32 s66, s64, s65
    s_mul_i32 s67, s66, 1280
    s_lshl_b32 s68, s59, 7
    s_add_u32 s67, s67, s68
    v_and_b32 v2, 7, v0
    v_lshrrev_b32 v3, 3, v0
    v_mul_u32_u24 v4, 5120, v3
    v_lshl_add_u32 v4, v2, 4, v4
    v_add_u32 v4, s67, v4
    v_subrev_u32 v8, 3840, v4
    v_mov_b32 v9, 0x80000000
    v_cmp_gt_u32 vcc, 1280, v4
    s_lshl_b32 s68, s59, 9
    s_lshl_b32 s69, s58, 2
    v_cndmask_b32 v8, v8, v9, vcc
    v_lshlrev_b32 v9, 6, v2
    s_add_u32 s69, s69, s52
    s_lshl_b32 s70, s69, 12
    s_lshr_b32 s71, s69, 1
    s_lshl_b32 s71, s71, 2
    v_subrev_u32 v10, 32, v1
    v_subrev_u32 v11, 16, v1
    v_add_u32 v12, 992, v1
    s_waitcnt lgkmcnt(0)
    s_mov_b32 s12, s18
    s_mov_b32 s13, s19
    s_mov_b32 s14, 2621440
    s_mov_b32 s15, 0x20000
    buffer_load_dwordx4 v[16:19], v8, s[12:15], 0 offen offset:0
    buffer_load_dwordx4 v[20:23], v8, s[12:15], 0 offen offset:1280
    buffer_load_dwordx4 v[24:27], v8, s[12:15], 0 offen offset:2560
    buffer_load_dwordx4 v[28:31], v4, s[12:15], 0 offen offset:0
    buffer_load_dwordx4 v[32:35], v4, s[12:15], 0 offen offset:1280
    buffer_load_dwordx4 v[36:39], v4, s[12:15], 0 offen offset:2560
    buffer_load_dwordx4 v[40:43], v4, s[12:15], 0 offen offset:3840
    s_mov_b32 s48, s22
    s_mov_b32 s49, s23
    s_mov_b32 s50, 5120
    s_mov_b32 s51, 0x20000
    buffer_load_dwordx4 v[60:63], v9, s[48:51], s68 offen offset:0
    buffer_load_dwordx4 v[64:67], v9, s[48:51], s68 offen offset:16
    buffer_load_dwordx4 v[68:71], v9, s[48:51], s68 offen offset:32
    buffer_load_dwordx4 v[72:75], v9, s[48:51], s68 offen offset:48
    s_mov_b32 s44, s20
    s_mov_b32 s45, s21
    s_mov_b32 s46, 2621440
    s_mov_b32 s47, 0x20000
    buffer_load_dwordx4 v[44:47], v4, s[44:47], 0 offen offset:0
    buffer_load_dwordx4 v[48:51], v4, s[44:47], 0 offen offset:1280
    buffer_load_dwordx4 v[52:55], v4, s[44:47], 0 offen offset:2560
    buffer_load_dwordx4 v[56:59], v4, s[44:47], 0 offen offset:3840
    v_mov_b32 v255, 40960
    global_load_dword v255, v255, s[40:41] sc1
    s_load_dword s63, s[26:27], s71
    s_add_u32 s12, s24, s70
    s_addc_u32 s13, s25, 0
    s_mov_b32 s14, 4096
    s_mov_b32 s15, 0x20000
    buffer_load_dwordx4 v[216:219], v10, s[12:15], 0 offen
    buffer_load_dwordx2 v[220:221], v11, s[12:15], 0 offen
    buffer_load_dwordx4 v[224:227], v12, s[12:15], 0 offen offset:0
    buffer_load_dwordx2 v[228:229], v12, s[12:15], 0 offen offset:16
    buffer_load_dwordx4 v[232:235], v12, s[12:15], 0 offen offset:1024
    buffer_load_dwordx2 v[236:237], v12, s[12:15], 0 offen offset:1040
    buffer_load_dwordx4 v[240:243], v12, s[12:15], 0 offen offset:2048
    buffer_load_dwordx2 v[244:245], v12, s[12:15], 0 offen offset:2064
    buffer_load_dwordx4 v[248:251], v12, s[12:15], 0 offen offset:3072
    buffer_load_dwordx2 v[252:253], v12, s[12:15], 0 offen offset:3088
    s_mov_b32 s8, s40
    s_mov_b32 s9, s41
    s_mov_b32 s10, 38338560
    s_mov_b32 s11, 0x20000
    s_lshr_b32 s64, s53, 1
    s_lshl_b32 s64, s64, 2
    s_lshr_b32 s65, s54, 3
    s_add_u32 s55, s64, s65
    s_and_b32 s56, s53, 1
    s_and_b32 s57, s54, 7
    s_lshl_b32 s64, s56, 3
    s_add_u32 s62, s64, s57
    s_lshl_b32 s64, s56, 3
    s_add_u32 s64, s64, s57
    s_lshl_b32 s61, s55, 4
    s_add_u32 s61, s61, s64
    s_cmp_lg_u32 s52, 0
    s_cbranch_scc1 w01
    s_lshl_b32 s72, s58, 8
    s_mov_b64 exec, 0xffff
    v_mov_b32 v196, 0
    v_mov_b32 v197, 0
    v_mov_b32 v198, 0
    v_mov_b32 v199, 0
    buffer_store_dwordx4 v[196:199], v1, s[8:11], s72 offen sc1
    s_mov_b64 exec, -1
w01:
    s_lshl_b32 s72, s52, 12
    v_lshlrev_b32 v13, 9, v3
    v_sub_u32 v13, 3584, v13
    v_lshl_add_u32 v13, v2, 4, v13
    v_add_u32 v13, s72, v13
    v_bfe_u32 v14, v0, 2, 2
    v_lshlrev_b32 v14, 7, v14
    v_lshrrev_b32 v15, 4, v0
    v_lshl_add_u32 v14, v15, 5, v14
    v_and_b32 v15, 3, v0
    v_lshl_add_u32 v14, v15, 3, v14
    v_add_u32 v14, s72, v14
    s_sub_u32 s72, 2016, s66
    s_lshr_b32 s72, s72, 3
    s_mul_i32 s72, s72, 10240
    s_lshl_b32 s73, s59, 10
    s_add_u32 s72, s72, s73
    s_add_u32 s72, s72, 1048576
    s_waitcnt vmcnt(25)
    v_lshlrev_b32 v108, 16, v16
    v_and_b32 v109, s60, v16
    v_lshlrev_b32 v110, 16, v17
    v_and_b32 v111, s60, v17
    v_lshlrev_b32 v112, 16, v18
    v_and_b32 v113, s60, v18
    v_lshlrev_b32 v114, 16, v19
    v_and_b32 v115, s60, v19
    s_waitcnt vmcnt(24)
    v_lshlrev_b32 v116, 16, v20
    v_and_b32 v117, s60, v20
    v_lshlrev_b32 v118, 16, v21
    v_and_b32 v119, s60, v21
    v_lshlrev_b32 v120, 16, v22
    v_and_b32 v121, s60, v22
    v_lshlrev_b32 v122, 16, v23
    v_and_b32 v123, s60, v23
    s_waitcnt vmcnt(23)
    v_lshlrev_b32 v124, 16, v24
    v_and_b32 v125, s60, v24
    v_lshlrev_b32 v126, 16, v25
    v_and_b32 v127, s60, v25
    v_lshlrev_b32 v128, 16, v26
    v_and_b32 v129, s60, v26
    v_lshlrev_b32 v130, 16, v27
    v_and_b32 v131, s60, v27
    s_waitcnt vmcnt(22)
    v_lshlrev_b32 v132, 16, v28
    v_and_b32 v133, s60, v28
    v_lshlrev_b32 v134, 16, v29
    v_and_b32 v135, s60, v29
    v_lshlrev_b32 v136, 16, v30
    v_and_b32 v137, s60, v30
    v_lshlrev_b32 v138, 16, v31
    v_and_b32 v139, s60, v31
    s_waitcnt vmcnt(21)
    v_lshlrev_b32 v140, 16, v32
    v_and_b32 v141, s60, v32
    v_lshlrev_b32 v142, 16, v33
    v_and_b32 v143, s60, v33
    v_lshlrev_b32 v144, 16, v34
    v_and_b32 v145, s60, v34
    v_lshlrev_b32 v146, 16, v35
    v_and_b32 v147, s60, v35
    s_waitcnt vmcnt(20)
    v_lshlrev_b32 v148, 16, v36
    v_and_b32 v149, s60, v36
    v_lshlrev_b32 v150, 16, v37
    v_and_b32 v151, s60, v37
    v_lshlrev_b32 v152, 16, v38
    v_and_b32 v153, s60, v38
    v_lshlrev_b32 v154, 16, v39
    v_and_b32 v155, s60, v39
    s_waitcnt vmcnt(19)
    v_lshlrev_b32 v156, 16, v40
    v_and_b32 v157, s60, v40
    v_lshlrev_b32 v158, 16, v41
    v_and_b32 v159, s60, v41
    v_lshlrev_b32 v160, 16, v42
    v_and_b32 v161, s60, v42
    v_lshlrev_b32 v162, 16, v43
    v_and_b32 v163, s60, v43
    s_waitcnt vmcnt(15)
    v_lshlrev_b32 v76, 16, v60
    v_and_b32 v84, s60, v60
    v_lshlrev_b32 v92, 16, v61
    v_and_b32 v100, s60, v61
    v_lshlrev_b32 v77, 16, v62
    v_and_b32 v85, s60, v62
    v_lshlrev_b32 v93, 16, v63
    v_and_b32 v101, s60, v63
    v_lshlrev_b32 v78, 16, v64
    v_and_b32 v86, s60, v64
    v_lshlrev_b32 v94, 16, v65
    v_and_b32 v102, s60, v65
    v_lshlrev_b32 v79, 16, v66
    v_and_b32 v87, s60, v66
    v_lshlrev_b32 v95, 16, v67
    v_and_b32 v103, s60, v67
    v_lshlrev_b32 v80, 16, v68
    v_and_b32 v88, s60, v68
    v_lshlrev_b32 v96, 16, v69
    v_and_b32 v104, s60, v69
    v_lshlrev_b32 v81, 16, v70
    v_and_b32 v89, s60, v70
    v_lshlrev_b32 v97, 16, v71
    v_and_b32 v105, s60, v71
    v_lshlrev_b32 v82, 16, v72
    v_and_b32 v90, s60, v72
    v_lshlrev_b32 v98, 16, v73
    v_and_b32 v106, s60, v73
    v_lshlrev_b32 v83, 16, v74
    v_and_b32 v91, s60, v74
    v_lshlrev_b32 v99, 16, v75
    v_and_b32 v107, s60, v75
    v_pk_mul_f32 v[164:165], v[132:133], v[76:77]
    v_pk_mul_f32 v[166:167], v[134:135], v[78:79]
    v_pk_mul_f32 v[168:169], v[136:137], v[80:81]
    v_pk_mul_f32 v[170:171], v[138:139], v[82:83]
    v_pk_fma_f32 v[164:165], v[124:125], v[84:85], v[164:165]
    v_pk_fma_f32 v[166:167], v[126:127], v[86:87], v[166:167]
    v_pk_fma_f32 v[168:169], v[128:129], v[88:89], v[168:169]
    v_pk_fma_f32 v[170:171], v[130:131], v[90:91], v[170:171]
    v_pk_fma_f32 v[164:165], v[116:117], v[92:93], v[164:165]
    v_pk_fma_f32 v[166:167], v[118:119], v[94:95], v[166:167]
    v_pk_fma_f32 v[168:169], v[120:121], v[96:97], v[168:169]
    v_pk_fma_f32 v[170:171], v[122:123], v[98:99], v[170:171]
    v_pk_fma_f32 v[164:165], v[108:109], v[100:101], v[164:165]
    v_pk_fma_f32 v[166:167], v[110:111], v[102:103], v[166:167]
    v_pk_fma_f32 v[168:169], v[112:113], v[104:105], v[168:169]
    v_pk_fma_f32 v[170:171], v[114:115], v[106:107], v[170:171]
    s_waitcnt vmcnt(14)
    v_lshlrev_b32 v108, 16, v44
    v_and_b32 v109, s60, v44
    v_lshlrev_b32 v110, 16, v45
    v_and_b32 v111, s60, v45
    v_lshlrev_b32 v112, 16, v46
    v_and_b32 v113, s60, v46
    v_lshlrev_b32 v114, 16, v47
    v_and_b32 v115, s60, v47
    v_pk_mul_f32 v[164:165], v[164:165], v[108:109]
    v_pk_mul_f32 v[166:167], v[166:167], v[110:111]
    v_pk_mul_f32 v[168:169], v[168:169], v[112:113]
    v_pk_mul_f32 v[170:171], v[170:171], v[114:115]
    v_cvt_pk_bf16_f32 v200, v164, v165
    v_cvt_pk_bf16_f32 v201, v166, v167
    v_cvt_pk_bf16_f32 v202, v168, v169
    v_cvt_pk_bf16_f32 v203, v170, v171
    ds_write_b128 v13, v[200:203] offset:384
    v_pk_mul_f32 v[172:173], v[140:141], v[76:77]
    v_pk_mul_f32 v[174:175], v[142:143], v[78:79]
    v_pk_mul_f32 v[176:177], v[144:145], v[80:81]
    v_pk_mul_f32 v[178:179], v[146:147], v[82:83]
    v_pk_fma_f32 v[172:173], v[132:133], v[84:85], v[172:173]
    v_pk_fma_f32 v[174:175], v[134:135], v[86:87], v[174:175]
    v_pk_fma_f32 v[176:177], v[136:137], v[88:89], v[176:177]
    v_pk_fma_f32 v[178:179], v[138:139], v[90:91], v[178:179]
    v_pk_fma_f32 v[172:173], v[124:125], v[92:93], v[172:173]
    v_pk_fma_f32 v[174:175], v[126:127], v[94:95], v[174:175]
    v_pk_fma_f32 v[176:177], v[128:129], v[96:97], v[176:177]
    v_pk_fma_f32 v[178:179], v[130:131], v[98:99], v[178:179]
    v_pk_fma_f32 v[172:173], v[116:117], v[100:101], v[172:173]
    v_pk_fma_f32 v[174:175], v[118:119], v[102:103], v[174:175]
    v_pk_fma_f32 v[176:177], v[120:121], v[104:105], v[176:177]
    v_pk_fma_f32 v[178:179], v[122:123], v[106:107], v[178:179]
    s_waitcnt vmcnt(13)
    v_lshlrev_b32 v116, 16, v48
    v_and_b32 v117, s60, v48
    v_lshlrev_b32 v118, 16, v49
    v_and_b32 v119, s60, v49
    v_lshlrev_b32 v120, 16, v50
    v_and_b32 v121, s60, v50
    v_lshlrev_b32 v122, 16, v51
    v_and_b32 v123, s60, v51
    v_pk_mul_f32 v[172:173], v[172:173], v[116:117]
    v_pk_mul_f32 v[174:175], v[174:175], v[118:119]
    v_pk_mul_f32 v[176:177], v[176:177], v[120:121]
    v_pk_mul_f32 v[178:179], v[178:179], v[122:123]
    v_cvt_pk_bf16_f32 v204, v172, v173
    v_cvt_pk_bf16_f32 v205, v174, v175
    v_cvt_pk_bf16_f32 v206, v176, v177
    v_cvt_pk_bf16_f32 v207, v178, v179
    ds_write_b128 v13, v[204:207] offset:256
    v_pk_mul_f32 v[180:181], v[148:149], v[76:77]
    v_pk_mul_f32 v[182:183], v[150:151], v[78:79]
    v_pk_mul_f32 v[184:185], v[152:153], v[80:81]
    v_pk_mul_f32 v[186:187], v[154:155], v[82:83]
    v_pk_fma_f32 v[180:181], v[140:141], v[84:85], v[180:181]
    v_pk_fma_f32 v[182:183], v[142:143], v[86:87], v[182:183]
    v_pk_fma_f32 v[184:185], v[144:145], v[88:89], v[184:185]
    v_pk_fma_f32 v[186:187], v[146:147], v[90:91], v[186:187]
    v_pk_fma_f32 v[180:181], v[132:133], v[92:93], v[180:181]
    v_pk_fma_f32 v[182:183], v[134:135], v[94:95], v[182:183]
    v_pk_fma_f32 v[184:185], v[136:137], v[96:97], v[184:185]
    v_pk_fma_f32 v[186:187], v[138:139], v[98:99], v[186:187]
    v_pk_fma_f32 v[180:181], v[124:125], v[100:101], v[180:181]
    v_pk_fma_f32 v[182:183], v[126:127], v[102:103], v[182:183]
    v_pk_fma_f32 v[184:185], v[128:129], v[104:105], v[184:185]
    v_pk_fma_f32 v[186:187], v[130:131], v[106:107], v[186:187]
    s_waitcnt vmcnt(12)
    v_lshlrev_b32 v124, 16, v52
    v_and_b32 v125, s60, v52
    v_lshlrev_b32 v126, 16, v53
    v_and_b32 v127, s60, v53
    v_lshlrev_b32 v128, 16, v54
    v_and_b32 v129, s60, v54
    v_lshlrev_b32 v130, 16, v55
    v_and_b32 v131, s60, v55
    v_pk_mul_f32 v[180:181], v[180:181], v[124:125]
    v_pk_mul_f32 v[182:183], v[182:183], v[126:127]
    v_pk_mul_f32 v[184:185], v[184:185], v[128:129]
    v_pk_mul_f32 v[186:187], v[186:187], v[130:131]
    v_cvt_pk_bf16_f32 v208, v180, v181
    v_cvt_pk_bf16_f32 v209, v182, v183
    v_cvt_pk_bf16_f32 v210, v184, v185
    v_cvt_pk_bf16_f32 v211, v186, v187
    ds_write_b128 v13, v[208:211] offset:128
    v_pk_mul_f32 v[188:189], v[156:157], v[76:77]
    v_pk_mul_f32 v[190:191], v[158:159], v[78:79]
    v_pk_mul_f32 v[192:193], v[160:161], v[80:81]
    v_pk_mul_f32 v[194:195], v[162:163], v[82:83]
    v_pk_fma_f32 v[188:189], v[148:149], v[84:85], v[188:189]
    v_pk_fma_f32 v[190:191], v[150:151], v[86:87], v[190:191]
    v_pk_fma_f32 v[192:193], v[152:153], v[88:89], v[192:193]
    v_pk_fma_f32 v[194:195], v[154:155], v[90:91], v[194:195]
    v_pk_fma_f32 v[188:189], v[140:141], v[92:93], v[188:189]
    v_pk_fma_f32 v[190:191], v[142:143], v[94:95], v[190:191]
    v_pk_fma_f32 v[192:193], v[144:145], v[96:97], v[192:193]
    v_pk_fma_f32 v[194:195], v[146:147], v[98:99], v[194:195]
    v_pk_fma_f32 v[188:189], v[132:133], v[100:101], v[188:189]
    v_pk_fma_f32 v[190:191], v[134:135], v[102:103], v[190:191]
    v_pk_fma_f32 v[192:193], v[136:137], v[104:105], v[192:193]
    v_pk_fma_f32 v[194:195], v[138:139], v[106:107], v[194:195]
    s_waitcnt vmcnt(11)
    v_lshlrev_b32 v132, 16, v56
    v_and_b32 v133, s60, v56
    v_lshlrev_b32 v134, 16, v57
    v_and_b32 v135, s60, v57
    v_lshlrev_b32 v136, 16, v58
    v_and_b32 v137, s60, v58
    v_lshlrev_b32 v138, 16, v59
    v_and_b32 v139, s60, v59
    v_pk_mul_f32 v[188:189], v[188:189], v[132:133]
    v_pk_mul_f32 v[190:191], v[190:191], v[134:135]
    v_pk_mul_f32 v[192:193], v[192:193], v[136:137]
    v_pk_mul_f32 v[194:195], v[194:195], v[138:139]
    v_cvt_pk_bf16_f32 v212, v188, v189
    v_cvt_pk_bf16_f32 v213, v190, v191
    v_cvt_pk_bf16_f32 v214, v192, v193
    v_cvt_pk_bf16_f32 v215, v194, v195
    ds_write_b128 v13, v[212:215] offset:0
    ds_read_b64_tr_b16 v[16:17], v14 offset:0
    ds_read_b64_tr_b16 v[18:19], v14 offset:512
    ds_read_b64_tr_b16 v[20:21], v14 offset:1024
    ds_read_b64_tr_b16 v[22:23], v14 offset:1536
    ds_read_b64_tr_b16 v[24:25], v14 offset:2048
    ds_read_b64_tr_b16 v[26:27], v14 offset:2560
    ds_read_b64_tr_b16 v[28:29], v14 offset:3072
    ds_read_b64_tr_b16 v[30:31], v14 offset:3584
    s_waitcnt vmcnt(10)
    v_readfirstlane_b32 s42, v255
    s_waitcnt lgkmcnt(0)
    s_add_u32 s42, s42, 1
    s_not_b32 s43, s42
    buffer_store_dwordx4 v[16:19], v1, s[8:11], s72 offen sc1
    s_add_u32 s72, s72, 10240
    buffer_store_dwordx4 v[20:23], v1, s[8:11], s72 offen sc1
    s_add_u32 s72, s72, 10240
    buffer_store_dwordx4 v[24:27], v1, s[8:11], s72 offen sc1
    s_add_u32 s72, s72, 10240
    buffer_store_dwordx4 v[28:31], v1, s[8:11], s72 offen sc1
    s_mul_i32 s73, s52, 16640
    s_add_u32 s73, s73, 16384
    v_add_u32 v13, s73, v1
    s_waitcnt vmcnt(12)
    v_alignbit_b32 v108, v217, v216, 16
    v_mov_b32 v112, v217
    v_alignbit_b32 v116, v218, v217, 16
    v_alignbit_b32 v109, v218, v217, 16
    v_mov_b32 v113, v218
    v_alignbit_b32 v117, v219, v218, 16
    v_alignbit_b32 v110, v219, v218, 16
    v_mov_b32 v114, v219
    v_alignbit_b32 v118, v220, v219, 16
    v_alignbit_b32 v111, v220, v219, 16
    v_mov_b32 v115, v220
    v_alignbit_b32 v119, v221, v220, 16
    ds_write_b128 v13, v[216:219] offset:0
    ds_write_b128 v13, v[108:111] offset:4160
    ds_write_b128 v13, v[112:115] offset:8320
    ds_write_b128 v13, v[116:119] offset:12480
    s_waitcnt vmcnt(10)
    v_alignbit_b32 v120, v225, v224, 16
    v_mov_b32 v124, v225
    v_alignbit_b32 v128, v226, v225, 16
    v_alignbit_b32 v121, v226, v225, 16
    v_mov_b32 v125, v226
    v_alignbit_b32 v129, v227, v226, 16
    v_alignbit_b32 v122, v227, v226, 16
    v_mov_b32 v126, v227
    v_alignbit_b32 v130, v228, v227, 16
    v_alignbit_b32 v123, v228, v227, 16
    v_mov_b32 v127, v228
    v_alignbit_b32 v131, v229, v228, 16
    ds_write_b128 v13, v[224:227] offset:1024
    ds_write_b128 v13, v[120:123] offset:5184
    ds_write_b128 v13, v[124:127] offset:9344
    ds_write_b128 v13, v[128:131] offset:13504
    s_waitcnt vmcnt(8)
    v_alignbit_b32 v132, v233, v232, 16
    v_mov_b32 v136, v233
    v_alignbit_b32 v140, v234, v233, 16
    v_alignbit_b32 v133, v234, v233, 16
    v_mov_b32 v137, v234
    v_alignbit_b32 v141, v235, v234, 16
    v_alignbit_b32 v134, v235, v234, 16
    v_mov_b32 v138, v235
    v_alignbit_b32 v142, v236, v235, 16
    v_alignbit_b32 v135, v236, v235, 16
    v_mov_b32 v139, v236
    v_alignbit_b32 v143, v237, v236, 16
    ds_write_b128 v13, v[232:235] offset:2048
    ds_write_b128 v13, v[132:135] offset:6208
    ds_write_b128 v13, v[136:139] offset:10368
    ds_write_b128 v13, v[140:143] offset:14528
    s_mov_b64 exec, -1
    s_waitcnt vmcnt(0)
    s_barrier
    s_lshl_b32 s72, s58, 3
    s_add_u32 s72, s72, 41088
    s_cmp_lg_u32 s52, 0
    s_cbranch_scc1 w02
    s_mov_b64 exec, 1
    v_mov_b32 v36, s72
    v_mov_b32 v38, s42
    v_mov_b32 v39, s43
    global_store_dwordx2 v36, v[38:39], s[40:41] sc1
    s_mov_b64 exec, -1
w02:
    v_alignbit_b32 v144, v241, v240, 16
    v_mov_b32 v148, v241
    v_alignbit_b32 v152, v242, v241, 16
    v_alignbit_b32 v145, v242, v241, 16
    v_mov_b32 v149, v242
    v_alignbit_b32 v153, v243, v242, 16
    v_alignbit_b32 v146, v243, v242, 16
    v_mov_b32 v150, v243
    v_alignbit_b32 v154, v244, v243, 16
    v_alignbit_b32 v147, v244, v243, 16
    v_mov_b32 v151, v244
    v_alignbit_b32 v155, v245, v244, 16
    ds_write_b128 v13, v[240:243] offset:3072
    ds_write_b128 v13, v[144:147] offset:7232
    ds_write_b128 v13, v[148:151] offset:11392
    ds_write_b128 v13, v[152:155] offset:15552
    v_alignbit_b32 v156, v249, v248, 16
    v_mov_b32 v160, v249
    v_alignbit_b32 v164, v250, v249, 16
    v_alignbit_b32 v157, v250, v249, 16
    v_mov_b32 v161, v250
    v_alignbit_b32 v165, v251, v250, 16
    v_alignbit_b32 v158, v251, v250, 16
    v_mov_b32 v162, v251
    v_alignbit_b32 v166, v252, v251, 16
    v_alignbit_b32 v159, v252, v251, 16
    v_mov_b32 v163, v252
    v_alignbit_b32 v167, v253, v252, 16
    s_mov_b64 exec, 3
    ds_write_b128 v13, v[248:251] offset:4096
    ds_write_b128 v13, v[156:159] offset:8256
    ds_write_b128 v13, v[160:163] offset:12416
    ds_write_b128 v13, v[164:167] offset:16576
    s_mul_i32 s73, s52, 4640
    s_add_u32 s73, s73, 82944
    s_mov_b64 exec, -1
    v_add_u32 v13, s73, v1
    v_mov_b32 v32, 0
    v_mov_b32 v33, 0
    v_mov_b32 v34, 0
    v_mov_b32 v35, 0
    s_mov_b32 exec_lo, -1
    s_mov_b32 exec_hi, 3
    ds_write_b128 v13, v[32:35] offset:4096
    s_mov_b64 exec, -1
    s_and_b32 s71, s69, 1
    s_lshl_b32 s70, s63, 16
    s_and_b32 s63, s63, s60
    s_cmp_eq_u32 s71, 0
    s_cselect_b32 s63, s70, s63
    v_and_b32 v7, 15, v0
    v_lshlrev_b32 v7, 3, v7
    s_lshl_b32 s72, s59, 7
    s_add_u32 s72, s72, 41088
    v_add_u32 v7, s72, v7
    s_branch L_conv
.p2align 12
L_conv:
    v_lshrrev_b32 v8, 2, v0
    v_and_b32 v9, 3, v0
    v_mul_u32_u24 v10, 10240, v8
    v_lshl_add_u32 v10, v9, 4, v10
    v_mul_u32_u24 v11, 4640, v9
    v_lshl_add_u32 v11, v8, 4, v11
    s_lshl_b32 s64, s52, 10
    s_add_u32 s64, s64, 82944
    v_add_u32 v11, s64, v11
    s_mul_i32 s64, s52, 655360
    s_lshl_b32 s65, s58, 6
    s_add_u32 s64, s64, s65
    s_add_u32 s64, s64, 1048576
    v_and_b32 v8, 15, v0
    v_lshrrev_b32 v9, 4, v0
    v_add_u32 v12, 1, v8
    v_and_b32 v13, 3, v12
    v_sub_u32 v12, v12, v13
    v_mul_u32_u24 v13, 4160, v13
    v_lshl_add_u32 v12, v12, 1, v13
    v_lshl_add_u32 v12, v9, 4, v12
    s_mul_i32 s65, s52, 16640
    s_add_u32 s65, s65, 16384
    v_add_u32 v2, s65, v12
    s_mul_i32 s65, s52, 4640
    s_add_u32 s65, s65, 82944
    v_lshlrev_b32 v12, 5, v8
    v_sub_u32 v12, s65, v12
    v_lshl_add_u32 v3, v9, 4, v12
    v_add_u32 v3, 480, v3
    v_lshlrev_b32 v13, 3, v9
    v_sub_u32 v4, v12, v13
    v_add_u32 v4, 504, v4
    s_cmp_lg_u32 s52, 1
    s_cbranch_scc1 pgw4
    s_getpc_b64 s[96:97]
pc5:
    s_add_u32 s96, s96, L_page1-pc5
    s_addc_u32 s97, s97, (L_page1-pc5)>>32
    s_swappc_b64 s[98:99], s[96:97]
    s_getpc_b64 s[96:97]
pc6:
    s_add_u32 s96, s96, L_page4-pc6
    s_addc_u32 s97, s97, (L_page4-pc6)>>32
    s_swappc_b64 s[98:99], s[96:97]
    s_getpc_b64 s[96:97]
pc7:
    s_add_u32 s96, s96, L_page7-pc7
    s_addc_u32 s97, s97, (L_page7-pc7)>>32
    s_swappc_b64 s[98:99], s[96:97]
    s_getpc_b64 s[96:97]
pc8:
    s_add_u32 s96, s96, L_page10-pc8
    s_addc_u32 s97, s97, (L_page10-pc8)>>32
    s_swappc_b64 s[98:99], s[96:97]
    s_branch pg3
pgw4:
    s_cmp_lg_u32 s52, 2
    s_cbranch_scc1 pgw9
    s_getpc_b64 s[96:97]
pc10:
    s_add_u32 s96, s96, L_page2-pc10
    s_addc_u32 s97, s97, (L_page2-pc10)>>32
    s_swappc_b64 s[98:99], s[96:97]
    s_getpc_b64 s[96:97]
pc11:
    s_add_u32 s96, s96, L_page5-pc11
    s_addc_u32 s97, s97, (L_page5-pc11)>>32
    s_swappc_b64 s[98:99], s[96:97]
    s_getpc_b64 s[96:97]
pc12:
    s_add_u32 s96, s96, L_page8-pc12
    s_addc_u32 s97, s97, (L_page8-pc12)>>32
    s_swappc_b64 s[98:99], s[96:97]
    s_getpc_b64 s[96:97]
pc13:
    s_add_u32 s96, s96, L_page11-pc13
    s_addc_u32 s97, s97, (L_page11-pc13)>>32
    s_swappc_b64 s[98:99], s[96:97]
    s_branch pg3
pgw9:
    s_cmp_lg_u32 s52, 3
    s_cbranch_scc1 pgw14
    s_getpc_b64 s[96:97]
pc15:
    s_add_u32 s96, s96, L_page3-pc15
    s_addc_u32 s97, s97, (L_page3-pc15)>>32
    s_swappc_b64 s[98:99], s[96:97]
    s_getpc_b64 s[96:97]
pc16:
    s_add_u32 s96, s96, L_page6-pc16
    s_addc_u32 s97, s97, (L_page6-pc16)>>32
    s_swappc_b64 s[98:99], s[96:97]
    s_getpc_b64 s[96:97]
pc17:
    s_add_u32 s96, s96, L_page9-pc17
    s_addc_u32 s97, s97, (L_page9-pc17)>>32
    s_swappc_b64 s[98:99], s[96:97]
    s_branch pg3
pgw14:
pg3:
    s_cmp_lg_u32 s52, 0
    s_cbranch_scc1 w018
    s_mov_b32 s84, 0
spin19:
    global_load_dwordx2 v[14:15], v7, s[40:41] sc1
    s_add_u32 s84, s84, 1
    s_cmp_gt_u32 s84, 2000000
    s_cbranch_scc1 spun20
    s_waitcnt vmcnt(0)
    v_xor_b32 v14, s42, v14
    v_xor_b32 v15, s43, v15
    v_or_b32 v14, v14, v15
    v_cmp_ne_u32 vcc, 0, v14
    s_cbranch_vccnz spin19
spun20:
    s_waitcnt vmcnt(0)
w018:
    s_barrier
    buffer_load_dwordx4 v[16:19], v10, s[8:11], s64 offen sc1
    s_add_u32 s64, s64, 163840
    buffer_load_dwordx4 v[20:23], v10, s[8:11], s64 offen sc1
    s_add_u32 s64, s64, 163840
    buffer_load_dwordx4 v[24:27], v10, s[8:11], s64 offen sc1
    s_add_u32 s64, s64, 163840
    buffer_load_dwordx4 v[28:31], v10, s[8:11], s64 offen sc1
    s_or_b32 s66, s54, s52
    s_cmp_lg_u32 s66, 0
    s_cbranch_scc1 go21
    s_lshl_b32 s66, s53, 7
    s_add_u32 s66, s66, 43008
    s_mov_b64 exec, 1
    v_mov_b32 v220, s66
    v_mov_b32 v222, s42
    v_mov_b32 v223, s43
    global_store_dwordx2 v220, v[222:223], s[40:41] sc1
    s_mov_b64 exec, -1
go21:
    s_mov_b32 s48, s16
    s_mov_b32 s49, s17
    s_mov_b32 s50, 2621440
    s_mov_b32 s51, 0x20000
    v_and_b32 v218, 7, v0
    v_lshrrev_b32 v219, 3, v0
    v_mul_u32_u24 v218, 1280, v218
    v_lshl_add_u32 v218, v219, 4, v218
    s_mul_i32 s82, s61, 10240
    s_mul_i32 s83, s52, 320
    s_add_u32 s82, s82, s83
    v_mov_b32 v219, 0x80000000
    v_cmp_gt_u32 vcc, 32, v0
    s_nop 1
    v_cndmask_b32 v219, v219, v218, vcc
    v_add_u32 v216, 41088, v1
    v_and_b32 v217, 0xf0, v1
    v_add_u32 v217, 42112, v217
    s_lshl_b32 s68, s53, 8
    s_add_u32 s68, s68, 2048
    v_min_u32 v224, 5, v0
    v_lshlrev_b32 v224, 12, v224
    v_add_u32 v224, s68, v224
    v_lshrrev_b32 v10, 1, v8
    v_mul_u32_u24 v10, 72, v10
    v_and_b32 v12, 1, v8
    v_lshl_add_u32 v10, v12, 4, v10
    v_lshl_add_u32 v10, v9, 2, v10
    s_mul_i32 s65, s52, 4624
    s_add_u32 s65, s65, 101504
    v_add_u32 v10, s65, v10
    v_lshrrev_b32 v14, 2, v8
    v_mul_u32_u24 v14, 4624, v14
    v_mul_u32_u24 v12, 72, v9
    v_add_u32 v14, v14, v12
    v_and_b32 v12, 3, v8
    v_lshl_add_u32 v14, v12, 3, v14
    s_mul_i32 s65, s52, 1152
    s_add_u32 s65, s65, 101504
    v_add_u32 v14, s65, v14
    v_lshrrev_b32 v12, 3, v0
    v_mul_u32_u24 v12, 20480, v12
    v_and_b32 v13, 7, v0
    v_lshl_add_u32 v12, v13, 4, v12
    s_mul_i32 s64, s52, 655360
    s_lshl_b32 s65, s58, 7
    s_add_u32 s64, s64, s65
    s_add_u32 s64, s64, 3670016
    s_lshl_b32 s65, s59, 12
    s_add_u32 s65, s65, 0
    ds_read_b64 v[112:113], v2 offset:0
    ds_read_b64 v[114:115], v2 offset:8
    ds_read_b64 v[116:117], v2 offset:512
    ds_read_b64 v[118:119], v2 offset:520
    ds_read_b64 v[120:121], v2 offset:1024
    ds_read_b64 v[122:123], v2 offset:1032
    ds_read_b64 v[124:125], v2 offset:1536
    ds_read_b64 v[126:127], v2 offset:1544
    ds_read_b64 v[128:129], v2 offset:2048
    ds_read_b64 v[130:131], v2 offset:2056
    ds_read_b64 v[132:133], v2 offset:2560
    ds_read_b64 v[134:135], v2 offset:2568
    ds_read_b64 v[136:137], v2 offset:3072
    ds_read_b64 v[138:139], v2 offset:3080
    ds_read_b64 v[140:141], v2 offset:3584
    ds_read_b64 v[142:143], v2 offset:3592
    s_waitcnt vmcnt(3)
    ds_write_b128 v11, v[16:19] offset:0
    s_waitcnt vmcnt(2)
    ds_write_b128 v11, v[20:23] offset:256
    s_waitcnt vmcnt(1)
    ds_write_b128 v11, v[24:27] offset:512
    s_waitcnt vmcnt(0)
    ds_write_b128 v11, v[28:31] offset:768
    s_waitcnt lgkmcnt(0)
    s_barrier
    ds_read_b128 v[76:79], v3 offset:0
    ds_read_b128 v[72:75], v3 offset:512
    ds_read_b128 v[68:71], v3 offset:1024
    ds_read_b128 v[64:67], v3 offset:1536
    ds_read_b128 v[60:63], v3 offset:2048
    ds_read_b128 v[56:59], v3 offset:2560
    ds_read_b128 v[52:55], v3 offset:3072
    s_waitcnt lgkmcnt(6)
    v_mfma_f32_16x16x32_bf16 v[44:47], v[112:115], v[76:79], 0
    ds_read_b128 v[48:51], v3 offset:3584
    s_waitcnt lgkmcnt(6)
    v_mfma_f32_16x16x32_bf16 v[40:43], v[112:115], v[72:75], 0
    s_waitcnt lgkmcnt(5)
    v_mfma_f32_16x16x32_bf16 v[36:39], v[112:115], v[68:71], 0
    s_waitcnt lgkmcnt(4)
    v_mfma_f32_16x16x32_bf16 v[32:35], v[112:115], v[64:67], 0
    s_waitcnt lgkmcnt(3)
    v_mfma_f32_16x16x32_bf16 v[28:31], v[112:115], v[60:63], 0
    s_waitcnt lgkmcnt(2)
    v_mfma_f32_16x16x32_bf16 v[24:27], v[112:115], v[56:59], 0
    s_waitcnt lgkmcnt(1)
    v_mfma_f32_16x16x32_bf16 v[20:23], v[112:115], v[52:55], 0
    s_waitcnt lgkmcnt(0)
    v_mfma_f32_16x16x32_bf16 v[16:19], v[112:115], v[48:51], 0
    v_mfma_f32_16x16x32_bf16 v[44:47], v[116:119], v[72:75], v[44:47]
    v_mfma_f32_16x16x32_bf16 v[40:43], v[116:119], v[68:71], v[40:43]
    v_mfma_f32_16x16x32_bf16 v[36:39], v[116:119], v[64:67], v[36:39]
    v_mfma_f32_16x16x32_bf16 v[32:35], v[116:119], v[60:63], v[32:35]
    v_mfma_f32_16x16x32_bf16 v[28:31], v[116:119], v[56:59], v[28:31]
    v_mfma_f32_16x16x32_bf16 v[24:27], v[116:119], v[52:55], v[24:27]
    ds_read_b64 v[112:113], v2 offset:64
    v_mfma_f32_16x16x32_bf16 v[20:23], v[116:119], v[48:51], v[20:23]
    ds_read_b64 v[114:115], v2 offset:72
    v_mfma_f32_16x16x32_bf16 v[44:47], v[120:123], v[68:71], v[44:47]
    ds_read_b128 v[108:111], v3 offset:64
    v_mfma_f32_16x16x32_bf16 v[40:43], v[120:123], v[64:67], v[40:43]
    ds_read_b128 v[104:107], v3 offset:576
    v_mfma_f32_16x16x32_bf16 v[36:39], v[120:123], v[60:63], v[36:39]
    ds_read_b128 v[100:103], v3 offset:1088
    v_mfma_f32_16x16x32_bf16 v[32:35], v[120:123], v[56:59], v[32:35]
    ds_read_b128 v[96:99], v3 offset:1600
    v_mfma_f32_16x16x32_bf16 v[28:31], v[120:123], v[52:55], v[28:31]
    ds_read_b128 v[92:95], v3 offset:2112
    buffer_load_dwordx4 a[240:243], v218, s[48:51], s82 offen
    v_mfma_f32_16x16x32_bf16 v[24:27], v[120:123], v[48:51], v[24:27]
    ds_read_b128 v[88:91], v3 offset:2624
    buffer_load_dwordx4 a[244:247], v218, s[48:51], s82 offen offset:128
    v_mfma_f32_16x16x32_bf16 v[44:47], v[124:127], v[64:67], v[44:47]
    ds_read_b128 v[84:87], v3 offset:3136
    buffer_load_dwordx4 a[248:251], v219, s[48:51], s82 offen offset:256
    v_mfma_f32_16x16x32_bf16 v[40:43], v[124:127], v[60:63], v[40:43]
    ds_read_b128 v[80:83], v3 offset:3648
    v_mfma_f32_16x16x32_bf16 v[36:39], v[124:127], v[56:59], v[36:39]
    ds_read_b64 v[116:117], v2 offset:576
    v_mfma_f32_16x16x32_bf16 v[32:35], v[124:127], v[52:55], v[32:35]
    ds_read_b64 v[118:119], v2 offset:584
    v_mfma_f32_16x16x32_bf16 v[28:31], v[124:127], v[48:51], v[28:31]
    v_mfma_f32_16x16x32_bf16 v[44:47], v[128:131], v[60:63], v[44:47]
    v_mfma_f32_16x16x32_bf16 v[40:43], v[128:131], v[56:59], v[40:43]
    v_mfma_f32_16x16x32_bf16 v[36:39], v[128:131], v[52:55], v[36:39]
    ds_read_b64 v[120:121], v2 offset:1088
    v_mfma_f32_16x16x32_bf16 v[32:35], v[128:131], v[48:51], v[32:35]
    ds_read_b64 v[122:123], v2 offset:1096
    v_mfma_f32_16x16x32_bf16 v[44:47], v[132:135], v[56:59], v[44:47]
    v_mfma_f32_16x16x32_bf16 v[40:43], v[132:135], v[52:55], v[40:43]
    v_mfma_f32_16x16x32_bf16 v[36:39], v[132:135], v[48:51], v[36:39]
    v_mfma_f32_16x16x32_bf16 v[44:47], v[136:139], v[52:55], v[44:47]
    v_mfma_f32_16x16x32_bf16 v[40:43], v[136:139], v[48:51], v[40:43]
    ds_read_b64 v[124:125], v2 offset:1600
    v_mfma_f32_16x16x32_bf16 v[44:47], v[140:143], v[48:51], v[44:47]
    ds_read_b64 v[126:127], v2 offset:1608
    s_waitcnt lgkmcnt(13)
    v_mfma_f32_16x16x32_bf16 v[44:47], v[112:115], v[108:111], v[44:47]
    s_waitcnt lgkmcnt(12)
    v_mfma_f32_16x16x32_bf16 v[40:43], v[112:115], v[104:107], v[40:43]
    s_waitcnt lgkmcnt(11)
    v_mfma_f32_16x16x32_bf16 v[36:39], v[112:115], v[100:103], v[36:39]
    s_waitcnt lgkmcnt(10)
    v_mfma_f32_16x16x32_bf16 v[32:35], v[112:115], v[96:99], v[32:35]
    ds_read_b64 v[128:129], v2 offset:2112
    s_waitcnt lgkmcnt(10)
    v_mfma_f32_16x16x32_bf16 v[28:31], v[112:115], v[92:95], v[28:31]
    ds_read_b64 v[130:131], v2 offset:2120
    s_waitcnt lgkmcnt(10)
    v_mfma_f32_16x16x32_bf16 v[24:27], v[112:115], v[88:91], v[24:27]
    s_waitcnt lgkmcnt(9)
    v_mfma_f32_16x16x32_bf16 v[20:23], v[112:115], v[84:87], v[20:23]
    s_waitcnt lgkmcnt(8)
    v_mfma_f32_16x16x32_bf16 v[16:19], v[112:115], v[80:83], v[16:19]
    ds_read_b64 v[132:133], v2 offset:2624
    s_waitcnt lgkmcnt(7)
    v_mfma_f32_16x16x32_bf16 v[44:47], v[116:119], v[104:107], v[44:47]
    ds_read_b64 v[134:135], v2 offset:2632
    v_mfma_f32_16x16x32_bf16 v[40:43], v[116:119], v[100:103], v[40:43]
    v_mfma_f32_16x16x32_bf16 v[36:39], v[116:119], v[96:99], v[36:39]
    ds_read_b64 v[136:137], v2 offset:3136
    v_mfma_f32_16x16x32_bf16 v[32:35], v[116:119], v[92:95], v[32:35]
    ds_read_b64 v[138:139], v2 offset:3144
    v_mfma_f32_16x16x32_bf16 v[28:31], v[116:119], v[88:91], v[28:31]
    ds_read_b64 v[140:141], v2 offset:3648
    v_mfma_f32_16x16x32_bf16 v[24:27], v[116:119], v[84:87], v[24:27]
    ds_read_b64 v[142:143], v2 offset:3656
    v_mfma_f32_16x16x32_bf16 v[20:23], v[116:119], v[80:83], v[20:23]
    ds_read_b64 v[112:113], v2 offset:128
    s_waitcnt lgkmcnt(11)
    v_mfma_f32_16x16x32_bf16 v[44:47], v[120:123], v[100:103], v[44:47]
    ds_read_b64 v[114:115], v2 offset:136
    v_mfma_f32_16x16x32_bf16 v[40:43], v[120:123], v[96:99], v[40:43]
    ds_read_b128 v[76:79], v3 offset:128
    v_mfma_f32_16x16x32_bf16 v[36:39], v[120:123], v[92:95], v[36:39]
    ds_read_b128 v[72:75], v3 offset:640
    v_mfma_f32_16x16x32_bf16 v[32:35], v[120:123], v[88:91], v[32:35]
    ds_read_b128 v[68:71], v3 offset:1152
    v_mfma_f32_16x16x32_bf16 v[28:31], v[120:123], v[84:87], v[28:31]
    ds_read_b128 v[64:67], v3 offset:1664
    v_mfma_f32_16x16x32_bf16 v[24:27], v[120:123], v[80:83], v[24:27]
    ds_read_b128 v[60:63], v3 offset:2176
    s_waitcnt lgkmcnt(15)
    v_mfma_f32_16x16x32_bf16 v[44:47], v[124:127], v[96:99], v[44:47]
    ds_read_b128 v[56:59], v3 offset:2688
    v_mfma_f32_16x16x32_bf16 v[40:43], v[124:127], v[92:95], v[40:43]
    ds_read_b128 v[52:55], v3 offset:3200
    v_mfma_f32_16x16x32_bf16 v[36:39], v[124:127], v[88:91], v[36:39]
    ds_read_b128 v[48:51], v3 offset:3712
    v_mfma_f32_16x16x32_bf16 v[32:35], v[124:127], v[84:87], v[32:35]
    ds_read_b64 v[116:117], v2 offset:640
    v_mfma_f32_16x16x32_bf16 v[28:31], v[124:127], v[80:83], v[28:31]
    ds_read_b64 v[118:119], v2 offset:648
    s_waitcnt lgkmcnt(15)
    v_mfma_f32_16x16x32_bf16 v[44:47], v[128:131], v[92:95], v[44:47]
    v_mfma_f32_16x16x32_bf16 v[40:43], v[128:131], v[88:91], v[40:43]
    v_mfma_f32_16x16x32_bf16 v[36:39], v[128:131], v[84:87], v[36:39]
    ds_read_b64 v[120:121], v2 offset:1152
    v_mfma_f32_16x16x32_bf16 v[32:35], v[128:131], v[80:83], v[32:35]
    ds_read_b64 v[122:123], v2 offset:1160
    v_mfma_f32_16x16x32_bf16 v[44:47], v[132:135], v[88:91], v[44:47]
    v_mfma_f32_16x16x32_bf16 v[40:43], v[132:135], v[84:87], v[40:43]
    v_mfma_f32_16x16x32_bf16 v[36:39], v[132:135], v[80:83], v[36:39]
    s_waitcnt lgkmcnt(15)
    v_mfma_f32_16x16x32_bf16 v[44:47], v[136:139], v[84:87], v[44:47]
    v_mfma_f32_16x16x32_bf16 v[40:43], v[136:139], v[80:83], v[40:43]
    ds_read_b64 v[124:125], v2 offset:1664
    s_waitcnt lgkmcnt(15)
    v_mfma_f32_16x16x32_bf16 v[44:47], v[140:143], v[80:83], v[44:47]
    ds_read_b64 v[126:127], v2 offset:1672
    s_waitcnt lgkmcnt(13)
    v_mfma_f32_16x16x32_bf16 v[44:47], v[112:115], v[76:79], v[44:47]
    s_waitcnt lgkmcnt(12)
    v_mfma_f32_16x16x32_bf16 v[40:43], v[112:115], v[72:75], v[40:43]
    s_waitcnt lgkmcnt(11)
    v_mfma_f32_16x16x32_bf16 v[36:39], v[112:115], v[68:71], v[36:39]
    s_waitcnt lgkmcnt(10)
    v_mfma_f32_16x16x32_bf16 v[32:35], v[112:115], v[64:67], v[32:35]
    ds_read_b64 v[128:129], v2 offset:2176
    s_waitcnt lgkmcnt(10)
    v_mfma_f32_16x16x32_bf16 v[28:31], v[112:115], v[60:63], v[28:31]
    ds_read_b64 v[130:131], v2 offset:2184
    s_waitcnt lgkmcnt(10)
    v_mfma_f32_16x16x32_bf16 v[24:27], v[112:115], v[56:59], v[24:27]
    s_waitcnt lgkmcnt(9)
    v_mfma_f32_16x16x32_bf16 v[20:23], v[112:115], v[52:55], v[20:23]
    s_waitcnt lgkmcnt(8)
    v_mfma_f32_16x16x32_bf16 v[16:19], v[112:115], v[48:51], v[16:19]
    ds_read_b64 v[132:133], v2 offset:2688
    s_waitcnt lgkmcnt(7)
    v_mfma_f32_16x16x32_bf16 v[44:47], v[116:119], v[72:75], v[44:47]
    ds_read_b64 v[134:135], v2 offset:2696
    v_mfma_f32_16x16x32_bf16 v[40:43], v[116:119], v[68:71], v[40:43]
    v_mfma_f32_16x16x32_bf16 v[36:39], v[116:119], v[64:67], v[36:39]
    ds_read_b64 v[136:137], v2 offset:3200
    v_mfma_f32_16x16x32_bf16 v[32:35], v[116:119], v[60:63], v[32:35]
    ds_read_b64 v[138:139], v2 offset:3208
    v_mfma_f32_16x16x32_bf16 v[28:31], v[116:119], v[56:59], v[28:31]
    ds_read_b64 v[140:141], v2 offset:3712
    v_mfma_f32_16x16x32_bf16 v[24:27], v[116:119], v[52:55], v[24:27]
    ds_read_b64 v[142:143], v2 offset:3720
    v_mfma_f32_16x16x32_bf16 v[20:23], v[116:119], v[48:51], v[20:23]
    ds_read_b64 v[112:113], v2 offset:192
    s_waitcnt lgkmcnt(11)
    v_mfma_f32_16x16x32_bf16 v[44:47], v[120:123], v[68:71], v[44:47]
    ds_read_b64 v[114:115], v2 offset:200
    v_mfma_f32_16x16x32_bf16 v[40:43], v[120:123], v[64:67], v[40:43]
    ds_read_b128 v[108:111], v3 offset:192
    v_mfma_f32_16x16x32_bf16 v[36:39], v[120:123], v[60:63], v[36:39]
    ds_read_b128 v[104:107], v3 offset:704
    v_mfma_f32_16x16x32_bf16 v[32:35], v[120:123], v[56:59], v[32:35]
    ds_read_b128 v[100:103], v3 offset:1216
    v_mfma_f32_16x16x32_bf16 v[28:31], v[120:123], v[52:55], v[28:31]
    ds_read_b128 v[96:99], v3 offset:1728
    v_mfma_f32_16x16x32_bf16 v[24:27], v[120:123], v[48:51], v[24:27]
    ds_read_b128 v[92:95], v3 offset:2240
    s_waitcnt lgkmcnt(15)
    v_mfma_f32_16x16x32_bf16 v[44:47], v[124:127], v[64:67], v[44:47]
    ds_read_b128 v[88:91], v3 offset:2752
    v_mfma_f32_16x16x32_bf16 v[40:43], v[124:127], v[60:63], v[40:43]
    ds_read_b128 v[84:87], v3 offset:3264
    v_mfma_f32_16x16x32_bf16 v[36:39], v[124:127], v[56:59], v[36:39]
    ds_read_b128 v[80:83], v3 offset:3776
    v_mfma_f32_16x16x32_bf16 v[32:35], v[124:127], v[52:55], v[32:35]
    ds_read_b64 v[116:117], v2 offset:704
    v_mfma_f32_16x16x32_bf16 v[28:31], v[124:127], v[48:51], v[28:31]
    ds_read_b64 v[118:119], v2 offset:712
    s_waitcnt lgkmcnt(15)
    v_mfma_f32_16x16x32_bf16 v[44:47], v[128:131], v[60:63], v[44:47]
    v_mfma_f32_16x16x32_bf16 v[40:43], v[128:131], v[56:59], v[40:43]
    v_mfma_f32_16x16x32_bf16 v[36:39], v[128:131], v[52:55], v[36:39]
    ds_read_b64 v[120:121], v2 offset:1216
    v_mfma_f32_16x16x32_bf16 v[32:35], v[128:131], v[48:51], v[32:35]
    ds_read_b64 v[122:123], v2 offset:1224
    v_mfma_f32_16x16x32_bf16 v[44:47], v[132:135], v[56:59], v[44:47]
    v_mfma_f32_16x16x32_bf16 v[40:43], v[132:135], v[52:55], v[40:43]
    v_mfma_f32_16x16x32_bf16 v[36:39], v[132:135], v[48:51], v[36:39]
    s_waitcnt lgkmcnt(15)
    v_mfma_f32_16x16x32_bf16 v[44:47], v[136:139], v[52:55], v[44:47]
    v_mfma_f32_16x16x32_bf16 v[40:43], v[136:139], v[48:51], v[40:43]
    ds_read_b64 v[124:125], v2 offset:1728
    s_waitcnt lgkmcnt(15)
    v_mfma_f32_16x16x32_bf16 v[44:47], v[140:143], v[48:51], v[44:47]
    ds_read_b64 v[126:127], v2 offset:1736
    s_waitcnt lgkmcnt(13)
    v_mfma_f32_16x16x32_bf16 v[44:47], v[112:115], v[108:111], v[44:47]
    s_waitcnt lgkmcnt(12)
    v_mfma_f32_16x16x32_bf16 v[40:43], v[112:115], v[104:107], v[40:43]
    s_waitcnt lgkmcnt(11)
    v_mfma_f32_16x16x32_bf16 v[36:39], v[112:115], v[100:103], v[36:39]
    s_waitcnt lgkmcnt(10)
    v_mfma_f32_16x16x32_bf16 v[32:35], v[112:115], v[96:99], v[32:35]
    ds_read_b64 v[128:129], v2 offset:2240
    s_waitcnt lgkmcnt(10)
    v_mfma_f32_16x16x32_bf16 v[28:31], v[112:115], v[92:95], v[28:31]
    ds_read_b64 v[130:131], v2 offset:2248
    s_waitcnt lgkmcnt(10)
    v_mfma_f32_16x16x32_bf16 v[24:27], v[112:115], v[88:91], v[24:27]
    s_waitcnt lgkmcnt(9)
    v_mfma_f32_16x16x32_bf16 v[20:23], v[112:115], v[84:87], v[20:23]
    s_waitcnt lgkmcnt(8)
    v_mfma_f32_16x16x32_bf16 v[16:19], v[112:115], v[80:83], v[16:19]
    ds_read_b64 v[132:133], v2 offset:2752
    s_waitcnt lgkmcnt(7)
    v_mfma_f32_16x16x32_bf16 v[44:47], v[116:119], v[104:107], v[44:47]
    ds_read_b64 v[134:135], v2 offset:2760
    v_mfma_f32_16x16x32_bf16 v[40:43], v[116:119], v[100:103], v[40:43]
    v_mfma_f32_16x16x32_bf16 v[36:39], v[116:119], v[96:99], v[36:39]
    ds_read_b64 v[136:137], v2 offset:3264
    v_mfma_f32_16x16x32_bf16 v[32:35], v[116:119], v[92:95], v[32:35]
    ds_read_b64 v[138:139], v2 offset:3272
    v_mfma_f32_16x16x32_bf16 v[28:31], v[116:119], v[88:91], v[28:31]
    ds_read_b64 v[140:141], v2 offset:3776
    v_mfma_f32_16x16x32_bf16 v[24:27], v[116:119], v[84:87], v[24:27]
    ds_read_b64 v[142:143], v2 offset:3784
    v_mfma_f32_16x16x32_bf16 v[20:23], v[116:119], v[80:83], v[20:23]
    ds_read_b64 v[112:113], v2 offset:256
    s_waitcnt lgkmcnt(11)
    v_mfma_f32_16x16x32_bf16 v[44:47], v[120:123], v[100:103], v[44:47]
    ds_read_b64 v[114:115], v2 offset:264
    v_mfma_f32_16x16x32_bf16 v[40:43], v[120:123], v[96:99], v[40:43]
    ds_read_b128 v[76:79], v3 offset:256
    v_mfma_f32_16x16x32_bf16 v[36:39], v[120:123], v[92:95], v[36:39]
    ds_read_b128 v[72:75], v3 offset:768
    v_mfma_f32_16x16x32_bf16 v[32:35], v[120:123], v[88:91], v[32:35]
    ds_read_b128 v[68:71], v3 offset:1280
    v_mfma_f32_16x16x32_bf16 v[28:31], v[120:123], v[84:87], v[28:31]
    ds_read_b128 v[64:67], v3 offset:1792
    v_mfma_f32_16x16x32_bf16 v[24:27], v[120:123], v[80:83], v[24:27]
    ds_read_b128 v[60:63], v3 offset:2304
    s_waitcnt lgkmcnt(15)
    v_mfma_f32_16x16x32_bf16 v[44:47], v[124:127], v[96:99], v[44:47]
    ds_read_b128 v[56:59], v3 offset:2816
    v_mfma_f32_16x16x32_bf16 v[40:43], v[124:127], v[92:95], v[40:43]
    ds_read_b128 v[52:55], v3 offset:3328
    v_mfma_f32_16x16x32_bf16 v[36:39], v[124:127], v[88:91], v[36:39]
    ds_read_b128 v[48:51], v3 offset:3840
    v_mfma_f32_16x16x32_bf16 v[32:35], v[124:127], v[84:87], v[32:35]
    ds_read_b64 v[116:117], v2 offset:768
    v_mfma_f32_16x16x32_bf16 v[28:31], v[124:127], v[80:83], v[28:31]
    ds_read_b64 v[118:119], v2 offset:776
    s_waitcnt lgkmcnt(15)
    v_mfma_f32_16x16x32_bf16 v[44:47], v[128:131], v[92:95], v[44:47]
    v_mfma_f32_16x16x32_bf16 v[40:43], v[128:131], v[88:91], v[40:43]
    v_mfma_f32_16x16x32_bf16 v[36:39], v[128:131], v[84:87], v[36:39]
    ds_read_b64 v[120:121], v2 offset:1280
    v_mfma_f32_16x16x32_bf16 v[32:35], v[128:131], v[80:83], v[32:35]
    ds_read_b64 v[122:123], v2 offset:1288
    v_mfma_f32_16x16x32_bf16 v[44:47], v[132:135], v[88:91], v[44:47]
    v_mfma_f32_16x16x32_bf16 v[40:43], v[132:135], v[84:87], v[40:43]
    v_mfma_f32_16x16x32_bf16 v[36:39], v[132:135], v[80:83], v[36:39]
    s_waitcnt lgkmcnt(15)
    v_mfma_f32_16x16x32_bf16 v[44:47], v[136:139], v[84:87], v[44:47]
    v_mfma_f32_16x16x32_bf16 v[40:43], v[136:139], v[80:83], v[40:43]
    ds_read_b64 v[124:125], v2 offset:1792
    s_waitcnt lgkmcnt(15)
    v_mfma_f32_16x16x32_bf16 v[44:47], v[140:143], v[80:83], v[44:47]
    ds_read_b64 v[126:127], v2 offset:1800
    s_waitcnt lgkmcnt(13)
    v_mfma_f32_16x16x32_bf16 v[44:47], v[112:115], v[76:79], v[44:47]
    s_waitcnt lgkmcnt(12)
    v_mfma_f32_16x16x32_bf16 v[40:43], v[112:115], v[72:75], v[40:43]
    s_waitcnt lgkmcnt(11)
    v_mfma_f32_16x16x32_bf16 v[36:39], v[112:115], v[68:71], v[36:39]
    s_waitcnt lgkmcnt(10)
    v_mfma_f32_16x16x32_bf16 v[32:35], v[112:115], v[64:67], v[32:35]
    ds_read_b64 v[128:129], v2 offset:2304
    s_waitcnt lgkmcnt(10)
    v_mfma_f32_16x16x32_bf16 v[28:31], v[112:115], v[60:63], v[28:31]
    ds_read_b64 v[130:131], v2 offset:2312
    s_waitcnt lgkmcnt(10)
    v_mfma_f32_16x16x32_bf16 v[24:27], v[112:115], v[56:59], v[24:27]
    ds_read_b64 v[144:145], v4 offset:3584
    s_waitcnt lgkmcnt(10)
    v_mfma_f32_16x16x32_bf16 v[20:23], v[112:115], v[52:55], v[20:23]
    s_waitcnt lgkmcnt(9)
    v_mfma_f32_16x16x32_bf16 v[16:19], v[112:115], v[48:51], v[16:19]
    ds_read_b64 v[132:133], v2 offset:2816
    s_waitcnt lgkmcnt(8)
    v_mfma_f32_16x16x32_bf16 v[44:47], v[116:119], v[72:75], v[44:47]
    ds_read_b64 v[134:135], v2 offset:2824
    v_mfma_f32_16x16x32_bf16 v[40:43], v[116:119], v[68:71], v[40:43]
    ds_read_b64 v[146:147], v4 offset:3072
    v_mfma_f32_16x16x32_bf16 v[36:39], v[116:119], v[64:67], v[36:39]
    ds_read_b64 v[136:137], v2 offset:3328
    v_mfma_f32_16x16x32_bf16 v[32:35], v[116:119], v[60:63], v[32:35]
    ds_read_b64 v[138:139], v2 offset:3336
    v_mfma_f32_16x16x32_bf16 v[28:31], v[116:119], v[56:59], v[28:31]
    ds_read_b64 v[140:141], v2 offset:3840
    v_mfma_f32_16x16x32_bf16 v[24:27], v[116:119], v[52:55], v[24:27]
    ds_read_b64 v[142:143], v2 offset:3848
    ds_read_b64 v[148:149], v4 offset:2560
    v_mfma_f32_16x16x32_bf16 v[20:23], v[116:119], v[48:51], v[20:23]
    ds_read_b64 v[112:113], v2 offset:320
    s_waitcnt lgkmcnt(14)
    v_mfma_f32_16x16x32_bf16 v[44:47], v[120:123], v[68:71], v[44:47]
    ds_read_b64 v[114:115], v2 offset:328
    v_mfma_f32_16x16x32_bf16 v[40:43], v[120:123], v[64:67], v[40:43]
    ds_read_b128 v[108:111], v3 offset:320
    v_mfma_f32_16x16x32_bf16 v[36:39], v[120:123], v[60:63], v[36:39]
    ds_read_b128 v[104:107], v3 offset:832
    ds_read_b64 v[150:151], v4 offset:2048
    v_mfma_f32_16x16x32_bf16 v[32:35], v[120:123], v[56:59], v[32:35]
    ds_read_b128 v[100:103], v3 offset:1344
    v_mfma_f32_16x16x32_bf16 v[28:31], v[120:123], v[52:55], v[28:31]
    ds_read_b128 v[96:99], v3 offset:1856
    v_mfma_f32_16x16x32_bf16 v[24:27], v[120:123], v[48:51], v[24:27]
    ds_read_b128 v[92:95], v3 offset:2368
    s_waitcnt lgkmcnt(15)
    v_mfma_f32_16x16x32_bf16 v[44:47], v[124:127], v[64:67], v[44:47]
    ds_read_b128 v[88:91], v3 offset:2880
    ds_read_b64 v[152:153], v4 offset:1536
    v_mfma_f32_16x16x32_bf16 v[40:43], v[124:127], v[60:63], v[40:43]
    ds_read_b128 v[84:87], v3 offset:3392
    v_mfma_f32_16x16x32_bf16 v[36:39], v[124:127], v[56:59], v[36:39]
    ds_read_b128 v[80:83], v3 offset:3904
    v_mfma_f32_16x16x32_bf16 v[32:35], v[124:127], v[52:55], v[32:35]
    ds_read_b64 v[116:117], v2 offset:832
    v_mfma_f32_16x16x32_bf16 v[28:31], v[124:127], v[48:51], v[28:31]
    ds_read_b64 v[118:119], v2 offset:840
    ds_read_b64 v[154:155], v4 offset:1024
    v_mfma_f32_16x16x32_bf16 v[44:47], v[128:131], v[60:63], v[44:47]
    v_mfma_f32_16x16x32_bf16 v[40:43], v[128:131], v[56:59], v[40:43]
    v_mfma_f32_16x16x32_bf16 v[36:39], v[128:131], v[52:55], v[36:39]
    ds_read_b64 v[120:121], v2 offset:1344
    v_mfma_f32_16x16x32_bf16 v[32:35], v[128:131], v[48:51], v[32:35]
    ds_read_b64 v[122:123], v2 offset:1352
    s_waitcnt lgkmcnt(15)
    v_mfma_f32_16x16x32_bf16 v[44:47], v[132:135], v[56:59], v[44:47]
    ds_read_b64 v[156:157], v4 offset:512
    v_mfma_f32_16x16x32_bf16 v[40:43], v[132:135], v[52:55], v[40:43]
    v_mfma_f32_16x16x32_bf16 v[36:39], v[132:135], v[48:51], v[36:39]
    v_mfma_f32_16x16x32_bf16 v[44:47], v[136:139], v[52:55], v[44:47]
    ds_read_b64 v[158:159], v4 offset:0
    v_mfma_f32_16x16x32_bf16 v[40:43], v[136:139], v[48:51], v[40:43]
    ds_read_b64 v[124:125], v2 offset:1856
    v_mfma_f32_16x16x32_bf16 v[44:47], v[140:143], v[48:51], v[44:47]
    ds_read_b64 v[126:127], v2 offset:1864
    s_waitcnt lgkmcnt(15)
    v_mfma_f32_16x16x32_bf16 v[44:47], v[112:115], v[108:111], v[44:47]
    v_mfma_f32_16x16x32_bf16 v[40:43], v[112:115], v[104:107], v[40:43]
    v_mfma_f32_16x16x32_bf16 v[36:39], v[112:115], v[100:103], v[36:39]
    s_waitcnt lgkmcnt(14)
    v_mfma_f32_16x16x32_bf16 v[32:35], v[112:115], v[96:99], v[32:35]
    ds_read_b64 v[128:129], v2 offset:2368
    s_waitcnt lgkmcnt(14)
    v_mfma_f32_16x16x32_bf16 v[28:31], v[112:115], v[92:95], v[28:31]
    ds_read_b64 v[130:131], v2 offset:2376
    s_waitcnt lgkmcnt(14)
    v_mfma_f32_16x16x32_bf16 v[24:27], v[112:115], v[88:91], v[24:27]
    s_waitcnt lgkmcnt(12)
    v_mfma_f32_16x16x32_bf16 v[20:23], v[112:115], v[84:87], v[20:23]
    s_waitcnt lgkmcnt(11)
    v_mfma_f32_16x16x32_bf16 v[16:19], v[112:115], v[80:83], v[16:19]
    ds_read_b64 v[132:133], v2 offset:2880
    s_waitcnt lgkmcnt(10)
    v_mfma_f32_16x16x32_bf16 v[44:47], v[116:119], v[104:107], v[44:47]
    ds_read_b64 v[134:135], v2 offset:2888
    v_mfma_f32_16x16x32_bf16 v[40:43], v[116:119], v[100:103], v[40:43]
    v_mfma_f32_16x16x32_bf16 v[36:39], v[116:119], v[96:99], v[36:39]
    ds_read_b64 v[136:137], v2 offset:3392
    v_mfma_f32_16x16x32_bf16 v[32:35], v[116:119], v[92:95], v[32:35]
    ds_read_b64 v[138:139], v2 offset:3400
    v_mfma_f32_16x16x32_bf16 v[28:31], v[116:119], v[88:91], v[28:31]
    ds_read_b64 v[140:141], v2 offset:3904
    v_mfma_f32_16x16x32_bf16 v[24:27], v[116:119], v[84:87], v[24:27]
    ds_read_b64 v[142:143], v2 offset:3912
    s_branch L_past1
L_page1:
    s_setpc_b64 s[98:99]
L_past1:
    v_mfma_f32_16x16x32_bf16 v[20:23], v[116:119], v[80:83], v[20:23]
    ds_read_b64 v[112:113], v2 offset:384
    s_waitcnt lgkmcnt(13)
    v_mfma_f32_16x16x32_bf16 v[44:47], v[120:123], v[100:103], v[44:47]
    ds_read_b64 v[114:115], v2 offset:392
    v_mfma_f32_16x16x32_bf16 v[40:43], v[120:123], v[96:99], v[40:43]
    ds_read_b128 v[76:79], v3 offset:384
    v_mfma_f32_16x16x32_bf16 v[36:39], v[120:123], v[92:95], v[36:39]
    ds_read_b128 v[72:75], v3 offset:896
    v_mfma_f32_16x16x32_bf16 v[32:35], v[120:123], v[88:91], v[32:35]
    ds_read_b128 v[68:71], v3 offset:1408
    v_mfma_f32_16x16x32_bf16 v[28:31], v[120:123], v[84:87], v[28:31]
    ds_read_b128 v[64:67], v3 offset:1920
    global_load_dwordx4 v[208:211], v216, s[40:41] sc1
    v_mfma_f32_16x16x32_bf16 v[24:27], v[120:123], v[80:83], v[24:27]
    ds_read_b128 v[60:63], v3 offset:2432
    s_waitcnt lgkmcnt(15)
    v_mfma_f32_16x16x32_bf16 v[44:47], v[124:127], v[96:99], v[44:47]
    ds_read_b128 v[56:59], v3 offset:2944
    global_load_dwordx4 v[212:215], v217, s[40:41] sc1
    v_mfma_f32_16x16x32_bf16 v[40:43], v[124:127], v[92:95], v[40:43]
    ds_read_b128 v[52:55], v3 offset:3456
    v_mfma_f32_16x16x32_bf16 v[36:39], v[124:127], v[88:91], v[36:39]
    ds_read_b128 v[48:51], v3 offset:3968
    v_mfma_f32_16x16x32_bf16 v[32:35], v[124:127], v[84:87], v[32:35]
    ds_read_b64 v[116:117], v2 offset:896
    v_and_b32 v160, s60, v145
    v_mfma_f32_16x16x32_bf16 v[28:31], v[124:127], v[80:83], v[28:31]
    ds_read_b64 v[118:119], v2 offset:904
    s_waitcnt lgkmcnt(15)
    v_mfma_f32_16x16x32_bf16 v[44:47], v[128:131], v[92:95], v[44:47]
    v_lshlrev_b32 v161, 16, v145
    v_and_b32 v162, s60, v144
    v_mfma_f32_16x16x32_bf16 v[40:43], v[128:131], v[88:91], v[40:43]
    v_lshlrev_b32 v163, 16, v144
    v_and_b32 v164, s60, v147
    v_mfma_f32_16x16x32_bf16 v[36:39], v[128:131], v[84:87], v[36:39]
    ds_read_b64 v[120:121], v2 offset:1408
    v_lshlrev_b32 v165, 16, v147
    v_mfma_f32_16x16x32_bf16 v[32:35], v[128:131], v[80:83], v[32:35]
    ds_read_b64 v[122:123], v2 offset:1416
    v_and_b32 v166, s60, v146
    v_mfma_f32_16x16x32_bf16 v[44:47], v[132:135], v[88:91], v[44:47]
    v_lshlrev_b32 v167, 16, v146
    v_and_b32 v168, s60, v149
    v_mfma_f32_16x16x32_bf16 v[40:43], v[132:135], v[84:87], v[40:43]
    v_lshlrev_b32 v169, 16, v149
    v_and_b32 v170, s60, v148
    v_mfma_f32_16x16x32_bf16 v[36:39], v[132:135], v[80:83], v[36:39]
    v_lshlrev_b32 v171, 16, v148
    s_waitcnt lgkmcnt(15)
    v_mfma_f32_16x16x32_bf16 v[44:47], v[136:139], v[84:87], v[44:47]
    v_and_b32 v172, s60, v151
    v_lshlrev_b32 v173, 16, v151
    v_mfma_f32_16x16x32_bf16 v[40:43], v[136:139], v[80:83], v[40:43]
    ds_read_b64 v[124:125], v2 offset:1920
    s_waitcnt lgkmcnt(15)
    v_mfma_f32_16x16x32_bf16 v[44:47], v[140:143], v[80:83], v[44:47]
    ds_read_b64 v[126:127], v2 offset:1928
    s_waitcnt lgkmcnt(13)
    v_mfma_f32_16x16x32_bf16 v[44:47], v[112:115], v[76:79], v[44:47]
    v_and_b32 v174, s60, v150
    s_waitcnt lgkmcnt(12)
    v_mfma_f32_16x16x32_bf16 v[40:43], v[112:115], v[72:75], v[40:43]
    v_lshlrev_b32 v175, 16, v150
    s_waitcnt lgkmcnt(11)
    v_mfma_f32_16x16x32_bf16 v[36:39], v[112:115], v[68:71], v[36:39]
    v_and_b32 v176, s60, v153
    s_waitcnt lgkmcnt(10)
    v_mfma_f32_16x16x32_bf16 v[32:35], v[112:115], v[64:67], v[32:35]
    ds_read_b64 v[128:129], v2 offset:2432
    s_waitcnt lgkmcnt(10)
    v_mfma_f32_16x16x32_bf16 v[28:31], v[112:115], v[60:63], v[28:31]
    ds_read_b64 v[130:131], v2 offset:2440
    s_waitcnt lgkmcnt(10)
    v_mfma_f32_16x16x32_bf16 v[24:27], v[112:115], v[56:59], v[24:27]
    v_lshlrev_b32 v177, 16, v153
    s_waitcnt lgkmcnt(9)
    v_mfma_f32_16x16x32_bf16 v[20:23], v[112:115], v[52:55], v[20:23]
    v_and_b32 v178, s60, v152
    s_waitcnt lgkmcnt(8)
    v_mfma_f32_16x16x32_bf16 v[16:19], v[112:115], v[48:51], v[16:19]
    ds_read_b64 v[132:133], v2 offset:2944
    s_waitcnt lgkmcnt(7)
    v_mfma_f32_16x16x32_bf16 v[44:47], v[116:119], v[72:75], v[44:47]
    ds_read_b64 v[134:135], v2 offset:2952
    v_lshlrev_b32 v179, 16, v152
    v_mfma_f32_16x16x32_bf16 v[40:43], v[116:119], v[68:71], v[40:43]
    v_and_b32 v180, s60, v155
    v_lshlrev_b32 v181, 16, v155
    v_mfma_f32_16x16x32_bf16 v[36:39], v[116:119], v[64:67], v[36:39]
    ds_read_b64 v[136:137], v2 offset:3456
    v_and_b32 v182, s60, v154
    v_mfma_f32_16x16x32_bf16 v[32:35], v[116:119], v[60:63], v[32:35]
    ds_read_b64 v[138:139], v2 offset:3464
    v_lshlrev_b32 v183, 16, v154
    v_mfma_f32_16x16x32_bf16 v[28:31], v[116:119], v[56:59], v[28:31]
    ds_read_b64 v[140:141], v2 offset:3968
    v_and_b32 v184, s60, v157
    v_mfma_f32_16x16x32_bf16 v[24:27], v[116:119], v[52:55], v[24:27]
    ds_read_b64 v[142:143], v2 offset:3976
    v_lshlrev_b32 v185, 16, v157
    v_mfma_f32_16x16x32_bf16 v[20:23], v[116:119], v[48:51], v[20:23]
    ds_read_b64 v[112:113], v2 offset:448
    s_waitcnt lgkmcnt(11)
    v_mfma_f32_16x16x32_bf16 v[44:47], v[120:123], v[68:71], v[44:47]
    ds_read_b64 v[114:115], v2 offset:456
    v_and_b32 v186, s60, v156
    v_mfma_f32_16x16x32_bf16 v[40:43], v[120:123], v[64:67], v[40:43]
    ds_read_b128 v[108:111], v3 offset:448
    v_lshlrev_b32 v187, 16, v156
    v_mfma_f32_16x16x32_bf16 v[36:39], v[120:123], v[60:63], v[36:39]
    ds_read_b128 v[104:107], v3 offset:960
    v_and_b32 v188, s60, v159
    v_mfma_f32_16x16x32_bf16 v[32:35], v[120:123], v[56:59], v[32:35]
    ds_read_b128 v[100:103], v3 offset:1472
    v_lshlrev_b32 v189, 16, v159
    v_mfma_f32_16x16x32_bf16 v[28:31], v[120:123], v[52:55], v[28:31]
    ds_read_b128 v[96:99], v3 offset:1984
    v_and_b32 v190, s60, v158
    v_mfma_f32_16x16x32_bf16 v[24:27], v[120:123], v[48:51], v[24:27]
    ds_read_b128 v[92:95], v3 offset:2496
    s_waitcnt lgkmcnt(15)
    v_mfma_f32_16x16x32_bf16 v[44:47], v[124:127], v[64:67], v[44:47]
    ds_read_b128 v[88:91], v3 offset:3008
    v_lshlrev_b32 v191, 16, v158
    v_mfma_f32_16x16x32_bf16 v[40:43], v[124:127], v[60:63], v[40:43]
    ds_read_b128 v[84:87], v3 offset:3520
    v_mfma_f32_16x16x32_bf16 v[36:39], v[124:127], v[56:59], v[36:39]
    ds_read_b128 v[80:83], v3 offset:4032
    v_mfma_f32_16x16x32_bf16 v[32:35], v[124:127], v[52:55], v[32:35]
    ds_read_b64 v[116:117], v2 offset:960
    v_mfma_f32_16x16x32_bf16 v[28:31], v[124:127], v[48:51], v[28:31]
    ds_read_b64 v[118:119], v2 offset:968
    s_waitcnt lgkmcnt(15)
    v_mfma_f32_16x16x32_bf16 v[44:47], v[128:131], v[60:63], v[44:47]
    v_mfma_f32_16x16x32_bf16 v[40:43], v[128:131], v[56:59], v[40:43]
    v_mfma_f32_16x16x32_bf16 v[36:39], v[128:131], v[52:55], v[36:39]
    ds_read_b64 v[120:121], v2 offset:1472
    v_mfma_f32_16x16x32_bf16 v[32:35], v[128:131], v[48:51], v[32:35]
    ds_read_b64 v[122:123], v2 offset:1480
    v_mfma_f32_16x16x32_bf16 v[44:47], v[132:135], v[56:59], v[44:47]
    v_mfma_f32_16x16x32_bf16 v[40:43], v[132:135], v[52:55], v[40:43]
    v_mfma_f32_16x16x32_bf16 v[36:39], v[132:135], v[48:51], v[36:39]
    s_waitcnt lgkmcnt(15)
    v_mfma_f32_16x16x32_bf16 v[44:47], v[136:139], v[52:55], v[44:47]
    v_mfma_f32_16x16x32_bf16 v[40:43], v[136:139], v[48:51], v[40:43]
    ds_read_b64 v[124:125], v2 offset:1984
    s_waitcnt lgkmcnt(15)
    v_mfma_f32_16x16x32_bf16 v[44:47], v[140:143], v[48:51], v[44:47]
    ds_read_b64 v[126:127], v2 offset:1992
    s_waitcnt lgkmcnt(13)
    v_mfma_f32_16x16x32_bf16 v[44:47], v[112:115], v[108:111], v[44:47]
    s_waitcnt lgkmcnt(12)
    v_mfma_f32_16x16x32_bf16 v[40:43], v[112:115], v[104:107], v[40:43]
    s_waitcnt lgkmcnt(11)
    v_mfma_f32_16x16x32_bf16 v[36:39], v[112:115], v[100:103], v[36:39]
    s_waitcnt lgkmcnt(10)
    v_mfma_f32_16x16x32_bf16 v[32:35], v[112:115], v[96:99], v[32:35]
    ds_read_b64 v[128:129], v2 offset:2496
    s_waitcnt lgkmcnt(10)
    v_mfma_f32_16x16x32_bf16 v[28:31], v[112:115], v[92:95], v[28:31]
    ds_read_b64 v[130:131], v2 offset:2504
    s_waitcnt lgkmcnt(10)
    v_mfma_f32_16x16x32_bf16 v[24:27], v[112:115], v[88:91], v[24:27]
    s_waitcnt lgkmcnt(9)
    v_mfma_f32_16x16x32_bf16 v[20:23], v[112:115], v[84:87], v[20:23]
    s_waitcnt lgkmcnt(8)
    v_mfma_f32_16x16x32_bf16 v[16:19], v[112:115], v[80:83], v[16:19]
    ds_read_b64 v[132:133], v2 offset:3008
    s_waitcnt lgkmcnt(7)
    v_mfma_f32_16x16x32_bf16 v[44:47], v[116:119], v[104:107], v[44:47]
    ds_read_b64 v[134:135], v2 offset:3016
    v_mfma_f32_16x16x32_bf16 v[40:43], v[116:119], v[100:103], v[40:43]
    v_mfma_f32_16x16x32_bf16 v[36:39], v[116:119], v[96:99], v[36:39]
    ds_read_b64 v[136:137], v2 offset:3520
    v_mfma_f32_16x16x32_bf16 v[32:35], v[116:119], v[92:95], v[32:35]
    ds_read_b64 v[138:139], v2 offset:3528
    v_mfma_f32_16x16x32_bf16 v[28:31], v[116:119], v[88:91], v[28:31]
    ds_read_b64 v[140:141], v2 offset:4032
    v_fmac_f32 v16, s63, v160
    v_fmac_f32 v17, s63, v161
    v_mfma_f32_16x16x32_bf16 v[24:27], v[116:119], v[84:87], v[24:27]
    ds_read_b64 v[142:143], v2 offset:4040
    v_fmac_f32 v18, s63, v162
    v_fmac_f32 v19, s63, v163
    v_mfma_f32_16x16x32_bf16 v[20:23], v[116:119], v[80:83], v[20:23]
    v_cvt_pk_bf16_f32 v192, v16, v18
    v_cvt_pk_bf16_f32 v193, v17, v19
    s_waitcnt lgkmcnt(10)
    v_mfma_f32_16x16x32_bf16 v[44:47], v[120:123], v[100:103], v[44:47]
    ds_write_b32 v10, v192 offset:0
    ds_write_b32 v10, v193 offset:32
    v_mfma_f32_16x16x32_bf16 v[40:43], v[120:123], v[96:99], v[40:43]
    v_mfma_f32_16x16x32_bf16 v[36:39], v[120:123], v[92:95], v[36:39]
    v_mfma_f32_16x16x32_bf16 v[32:35], v[120:123], v[88:91], v[32:35]
    v_mfma_f32_16x16x32_bf16 v[28:31], v[120:123], v[84:87], v[28:31]
    v_fmac_f32 v20, s63, v164
    v_fmac_f32 v21, s63, v165
    v_fmac_f32 v22, s63, v166
    v_mfma_f32_16x16x32_bf16 v[24:27], v[120:123], v[80:83], v[24:27]
    v_fmac_f32 v23, s63, v167
    v_cvt_pk_bf16_f32 v194, v20, v22
    s_waitcnt lgkmcnt(10)
    v_mfma_f32_16x16x32_bf16 v[44:47], v[124:127], v[96:99], v[44:47]
    v_cvt_pk_bf16_f32 v195, v21, v23
    v_mfma_f32_16x16x32_bf16 v[40:43], v[124:127], v[92:95], v[40:43]
    ds_write_b32 v10, v194 offset:576
    ds_write_b32 v10, v195 offset:608
    v_mfma_f32_16x16x32_bf16 v[36:39], v[124:127], v[88:91], v[36:39]
    v_mfma_f32_16x16x32_bf16 v[32:35], v[124:127], v[84:87], v[32:35]
    v_mfma_f32_16x16x32_bf16 v[28:31], v[124:127], v[80:83], v[28:31]
    v_fmac_f32 v24, s63, v168
    v_fmac_f32 v25, s63, v169
    s_waitcnt lgkmcnt(10)
    v_mfma_f32_16x16x32_bf16 v[44:47], v[128:131], v[92:95], v[44:47]
    v_fmac_f32 v26, s63, v170
    v_fmac_f32 v27, s63, v171
    v_cvt_pk_bf16_f32 v196, v24, v26
    v_mfma_f32_16x16x32_bf16 v[40:43], v[128:131], v[88:91], v[40:43]
    v_cvt_pk_bf16_f32 v197, v25, v27
    v_mfma_f32_16x16x32_bf16 v[36:39], v[128:131], v[84:87], v[36:39]
    ds_write_b32 v10, v196 offset:1152
    ds_write_b32 v10, v197 offset:1184
    v_mfma_f32_16x16x32_bf16 v[32:35], v[128:131], v[80:83], v[32:35]
    s_waitcnt lgkmcnt(10)
    v_mfma_f32_16x16x32_bf16 v[44:47], v[132:135], v[88:91], v[44:47]
    v_fmac_f32 v28, s63, v172
    v_fmac_f32 v29, s63, v173
    v_fmac_f32 v30, s63, v174
    v_mfma_f32_16x16x32_bf16 v[40:43], v[132:135], v[84:87], v[40:43]
    v_fmac_f32 v31, s63, v175
    v_cvt_pk_bf16_f32 v198, v28, v30
    v_cvt_pk_bf16_f32 v199, v29, v31
    v_mfma_f32_16x16x32_bf16 v[36:39], v[132:135], v[80:83], v[36:39]
    ds_write_b32 v10, v198 offset:1728
    ds_write_b32 v10, v199 offset:1760
    s_waitcnt lgkmcnt(10)
    v_mfma_f32_16x16x32_bf16 v[44:47], v[136:139], v[84:87], v[44:47]
    v_mfma_f32_16x16x32_bf16 v[40:43], v[136:139], v[80:83], v[40:43]
    v_fmac_f32 v32, s63, v176
    v_fmac_f32 v33, s63, v177
    s_waitcnt lgkmcnt(8)
    v_mfma_f32_16x16x32_bf16 v[44:47], v[140:143], v[80:83], v[44:47]
    v_fmac_f32 v34, s63, v178
    v_fmac_f32 v35, s63, v179
    v_cvt_pk_bf16_f32 v200, v32, v34
    v_cvt_pk_bf16_f32 v201, v33, v35
    ds_write_b32 v10, v200 offset:2304
    ds_write_b32 v10, v201 offset:2336
    v_fmac_f32 v36, s63, v180
    v_fmac_f32 v37, s63, v181
    v_fmac_f32 v38, s63, v182
    v_fmac_f32 v39, s63, v183
    v_cvt_pk_bf16_f32 v202, v36, v38
    v_cvt_pk_bf16_f32 v203, v37, v39
    ds_write_b32 v10, v202 offset:2880
    ds_write_b32 v10, v203 offset:2912
    v_fmac_f32 v40, s63, v184
    v_fmac_f32 v41, s63, v185
    v_fmac_f32 v42, s63, v186
    v_fmac_f32 v43, s63, v187
    v_cvt_pk_bf16_f32 v204, v40, v42
    v_cvt_pk_bf16_f32 v205, v41, v43
    ds_write_b32 v10, v204 offset:3456
    ds_write_b32 v10, v205 offset:3488
    v_fmac_f32 v44, s63, v188
    v_fmac_f32 v45, s63, v189
    v_fmac_f32 v46, s63, v190
    v_fmac_f32 v47, s63, v191
    v_cvt_pk_bf16_f32 v206, v44, v46
    v_cvt_pk_bf16_f32 v207, v45, v47
    ds_write_b32 v10, v206 offset:4032
    ds_write_b32 v10, v207 offset:4064
    s_waitcnt lgkmcnt(0)
    s_barrier
    ds_read_b64_tr_b16 v[48:49], v14 offset:0
    ds_read_b64_tr_b16 v[50:51], v14 offset:32
    ds_read_b64_tr_b16 v[52:53], v14 offset:288
    ds_read_b64_tr_b16 v[54:55], v14 offset:320
    ds_read_b64_tr_b16 v[56:57], v14 offset:576
    ds_read_b64_tr_b16 v[58:59], v14 offset:608
    ds_read_b64_tr_b16 v[60:61], v14 offset:864
    ds_read_b64_tr_b16 v[62:63], v14 offset:896
    s_waitcnt lgkmcnt(6)
    buffer_store_dwordx4 v[48:51], v12, s[8:11], s64 offen sc1
    s_add_u32 s64, s64, 163840
    s_waitcnt lgkmcnt(4)
    buffer_store_dwordx4 v[52:55], v12, s[8:11], s64 offen sc1
    s_add_u32 s64, s64, 163840
    s_waitcnt lgkmcnt(2)
    buffer_store_dwordx4 v[56:59], v12, s[8:11], s64 offen sc1
    s_add_u32 s64, s64, 163840
    s_waitcnt lgkmcnt(0)
    buffer_store_dwordx4 v[60:63], v12, s[8:11], s64 offen sc1
    s_waitcnt vmcnt(0)
    s_barrier
    s_cmp_lg_u32 s52, 0
    s_cbranch_scc1 w022
    s_mov_b64 exec, 0xff
    v_lshlrev_b32 v6, 8, v0
    v_add_u32 v6, s65, v6
    v_mov_b32 v7, 1
    global_atomic_add v6, v7, s[40:41] sc1
    s_mov_b64 exec, -1
w022:
    v_xor_b32 v208, s42, v208
    v_xor_b32 v209, s43, v209
    v_or_b32 v208, v208, v209
    v_xor_b32 v210, s42, v210
    v_xor_b32 v211, s43, v211
    v_or3_b32 v208, v208, v210, v211
    v_xor_b32 v212, s42, v212
    v_xor_b32 v213, s43, v213
    v_or3_b32 v208, v208, v212, v213
    v_xor_b32 v214, s42, v214
    v_xor_b32 v215, s43, v215
    v_or3_b32 v208, v208, v214, v215
    v_cmp_ne_u32 vcc, 0, v208
    s_cbranch_vccz allok23
    s_mov_b32 s84, 0
spin24:
    global_load_dwordx4 v[208:211], v216, s[40:41] sc1
    global_load_dwordx4 v[212:215], v217, s[40:41] sc1
    s_add_u32 s84, s84, 1
    s_cmp_gt_u32 s84, 2000000
    s_cbranch_scc1 spun25
    s_waitcnt vmcnt(0)
    v_xor_b32 v208, s42, v208
    v_xor_b32 v209, s43, v209
    v_or_b32 v208, v208, v209
    v_xor_b32 v210, s42, v210
    v_xor_b32 v211, s43, v211
    v_or3_b32 v208, v208, v210, v211
    v_xor_b32 v212, s42, v212
    v_xor_b32 v213, s43, v213
    v_or3_b32 v208, v208, v212, v213
    v_xor_b32 v214, s42, v214
    v_xor_b32 v215, s43, v215
    v_or3_b32 v208, v208, v214, v215
    v_cmp_ne_u32 vcc, 0, v208
    s_cbranch_vccnz spin24
spun25:
    s_waitcnt vmcnt(0)
allok23:
    global_load_dword v225, v224, s[40:41] sc1
    s_waitcnt vmcnt(0) lgkmcnt(0)
    v_cmp_gt_u32 vcc, 16, v225
    s_cbranch_vccz shufok26
    s_mov_b32 s84, 0
spin27:
    global_load_dword v225, v224, s[40:41] sc1
    s_add_u32 s84, s84, 1
    s_cmp_gt_u32 s84, 2000000
    s_cbranch_scc1 spun28
    s_waitcnt vmcnt(0)
    v_cmp_gt_u32 vcc, 16, v225
    s_cbranch_vccnz spin27
spun28:
    s_waitcnt vmcnt(0)
shufok26:
    s_branch L_r1
L_shuf:
    s_sub_u32 s58, s2, 160
    s_waitcnt lgkmcnt(0)
    v_mov_b32 v255, 40960
    global_load_dword v255, v255, s[40:41] sc1
    s_mov_b32 s8, s40
    s_mov_b32 s9, s41
    s_mov_b32 s10, 38338560
    s_mov_b32 s11, 0x20000
    s_lshr_b32 s64, s53, 1
    s_lshl_b32 s64, s64, 2
    s_lshr_b32 s65, s54, 3
    s_add_u32 s55, s64, s65
    s_and_b32 s56, s53, 1
    s_and_b32 s57, s54, 7
    s_lshl_b32 s64, s56, 3
    s_add_u32 s62, s64, s57
    s_lshl_b32 s64, s56, 3
    s_add_u32 s64, s64, s57
    s_lshl_b32 s61, s55, 4
    s_add_u32 s61, s61, s64
    s_mov_b32 s48, s16
    s_mov_b32 s49, s17
    s_mov_b32 s50, 2621440
    s_mov_b32 s51, 0x20000
    v_and_b32 v8, 7, v0
    v_lshrrev_b32 v9, 3, v0
    v_mul_u32_u24 v8, 1280, v8
    v_lshl_add_u32 v8, v9, 4, v8
    s_mul_i32 s82, s61, 10240
    s_mul_i32 s83, s52, 320
    s_add_u32 s82, s82, s83
    v_mov_b32 v9, 0x80000000
    v_cmp_gt_u32 vcc, 32, v0
    s_nop 1
    v_cndmask_b32 v9, v9, v8, vcc
    buffer_load_dwordx4 a[240:243], v8, s[48:51], s82 offen
    buffer_load_dwordx4 a[244:247], v8, s[48:51], s82 offen offset:128
    buffer_load_dwordx4 a[248:251], v9, s[48:51], s82 offen offset:256
    s_lshl_b32 s64, s58, 2
    s_add_u32 s64, s64, s52
    s_cmp_ge_u32 s64, 160
    s_cbranch_scc1 nz29
    s_mul_i32 s65, s64, 1639
    s_lshr_b32 s65, s65, 16
    s_mul_i32 s66, s65, 40
    s_sub_u32 s66, s64, s66
    s_lshl_b32 s66, s66, 10
    s_mul_i32 s67, s65, 286720
    s_add_u32 s67, s67, s66
    s_add_u32 s67, s67, 35143680
    v_mov_b32 v16, 0
    v_mov_b32 v17, 0
    v_mov_b32 v18, 0
    v_mov_b32 v19, 0
    buffer_store_dwordx4 v[16:19], v1, s[8:11], s67 offen sc1
nz29:
    s_waitcnt vmcnt(3)
    v_readfirstlane_b32 s42, v255
    s_waitcnt lgkmcnt(0)
    s_add_u32 s42, s42, 1
    s_not_b32 s43, s42
    s_mul_i32 s65, s52, 20992
    v_lshrrev_b32 v2, 3, v0
    v_and_b32 v3, 7, v0
    v_lshrrev_b32 v8, 4, v0
    v_bfe_u32 v9, v0, 2, 2
    v_and_b32 v10, 3, v0
    v_lshl_add_u32 v8, v8, 3, v9
    s_waitcnt vmcnt(0) lgkmcnt(0)
    s_cmp_lg_u32 s52, 1
    s_cbranch_scc1 pgw31
    s_getpc_b64 s[96:97]
pc32:
    s_add_u32 s96, s96, L_page1-pc32
    s_addc_u32 s97, s97, (L_page1-pc32)>>32
    s_swappc_b64 s[98:99], s[96:97]
    s_getpc_b64 s[96:97]
pc33:
    s_add_u32 s96, s96, L_page4-pc33
    s_addc_u32 s97, s97, (L_page4-pc33)>>32
    s_swappc_b64 s[98:99], s[96:97]
    s_getpc_b64 s[96:97]
pc34:
    s_add_u32 s96, s96, L_page7-pc34
    s_addc_u32 s97, s97, (L_page7-pc34)>>32
    s_swappc_b64 s[98:99], s[96:97]
    s_getpc_b64 s[96:97]
pc35:
    s_add_u32 s96, s96, L_page10-pc35
    s_addc_u32 s97, s97, (L_page10-pc35)>>32
    s_swappc_b64 s[98:99], s[96:97]
    s_branch pg30
pgw31:
    s_cmp_lg_u32 s52, 2
    s_cbranch_scc1 pgw36
    s_getpc_b64 s[96:97]
pc37:
    s_add_u32 s96, s96, L_page2-pc37
    s_addc_u32 s97, s97, (L_page2-pc37)>>32
    s_swappc_b64 s[98:99], s[96:97]
    s_getpc_b64 s[96:97]
pc38:
    s_add_u32 s96, s96, L_page5-pc38
    s_addc_u32 s97, s97, (L_page5-pc38)>>32
    s_swappc_b64 s[98:99], s[96:97]
    s_getpc_b64 s[96:97]
pc39:
    s_add_u32 s96, s96, L_page8-pc39
    s_addc_u32 s97, s97, (L_page8-pc39)>>32
    s_swappc_b64 s[98:99], s[96:97]
    s_getpc_b64 s[96:97]
pc40:
    s_add_u32 s96, s96, L_page11-pc40
    s_addc_u32 s97, s97, (L_page11-pc40)>>32
    s_swappc_b64 s[98:99], s[96:97]
    s_branch pg30
pgw36:
    s_cmp_lg_u32 s52, 3
    s_cbranch_scc1 pgw41
    s_getpc_b64 s[96:97]
pc42:
    s_add_u32 s96, s96, L_page3-pc42
    s_addc_u32 s97, s97, (L_page3-pc42)>>32
    s_swappc_b64 s[98:99], s[96:97]
    s_getpc_b64 s[96:97]
pc43:
    s_add_u32 s96, s96, L_page6-pc43
    s_addc_u32 s97, s97, (L_page6-pc43)>>32
    s_swappc_b64 s[98:99], s[96:97]
    s_getpc_b64 s[96:97]
pc44:
    s_add_u32 s96, s96, L_page9-pc44
    s_addc_u32 s97, s97, (L_page9-pc44)>>32
    s_swappc_b64 s[98:99], s[96:97]
    s_branch pg30
pgw41:
pg30:
    s_cmp_ge_u32 s64, 272
    s_cbranch_scc1 L_shuf_wd
    s_cmp_ge_u32 s64, 270
    s_cbranch_scc1 L_shuf_go
    s_mov_b32 s12, s30
    s_mov_b32 s13, s31
    s_mov_b32 s14, 2211840
    s_mov_b32 s15, 0x20000
    s_mov_b32 s44, s32
    s_mov_b32 s45, s33
    s_mov_b32 s46, 2211840
    s_mov_b32 s47, 0x20000
    s_mul_i32 s66, s64, 6554
    s_lshr_b32 s66, s66, 16
    s_mul_i32 s67, s66, 10
    s_sub_u32 s67, s64, s67
    s_mul_i32 s68, s67, 221184
    s_lshl_b32 s69, s66, 7
    s_add_u32 s68, s68, s69
    v_mul_u32_u24 v4, 3456, v2
    v_lshl_add_u32 v4, v3, 4, v4
    buffer_load_dwordx4 v[16:19], v4, s[12:15], s68 offen
    buffer_load_dwordx4 v[20:23], v4, s[44:47], s68 offen
    s_add_u32 s68, s68, 27648
    buffer_load_dwordx4 v[24:27], v4, s[12:15], s68 offen
    buffer_load_dwordx4 v[28:31], v4, s[44:47], s68 offen
    s_add_u32 s68, s68, 27648
    buffer_load_dwordx4 v[32:35], v4, s[12:15], s68 offen
    buffer_load_dwordx4 v[36:39], v4, s[44:47], s68 offen
    s_add_u32 s68, s68, 27648
    buffer_load_dwordx4 v[40:43], v4, s[12:15], s68 offen
    buffer_load_dwordx4 v[44:47], v4, s[44:47], s68 offen
    s_add_u32 s68, s68, 27648
    buffer_load_dwordx4 v[48:51], v4, s[12:15], s68 offen
    buffer_load_dwordx4 v[52:55], v4, s[44:47], s68 offen
    s_add_u32 s68, s68, 27648
    buffer_load_dwordx4 v[56:59], v4, s[12:15], s68 offen
    buffer_load_dwordx4 v[60:63], v4, s[44:47], s68 offen
    s_add_u32 s68, s68, 27648
    buffer_load_dwordx4 v[64:67], v4, s[12:15], s68 offen
    buffer_load_dwordx4 v[68:71], v4, s[44:47], s68 offen
    s_add_u32 s68, s68, 27648
    buffer_load_dwordx4 v[72:75], v4, s[12:15], s68 offen
    buffer_load_dwordx4 v[76:79], v4, s[44:47], s68 offen
    v_mul_u32_u24 v11, 272, v2
    v_lshl_add_u32 v11, v3, 4, v11
    v_add_u32 v11, s65, v11
    v_mul_u32_u24 v12, 272, v8
    v_add_u32 v12, s65, v12
    s_cmp_lt_u32 s66, 24
    s_cselect_b32 s68, 4, 3
    v_lshlrev_b32 v10, s68, v10
    v_add_u32 v12, v12, v10
    s_cselect_b32 s68, 8, 32
    v_add_u32 v13, s68, v12
    v_add_u32 v14, 64, v12
    v_add_u32 v15, 64, v13
    s_cselect_b32 s72, 4, 2
    s_lshl_b32 s72, s72, 10
    s_waitcnt vmcnt(14)
    ds_write_b128 v11, v[16:19] offset:0
    ds_write_b128 v11, v[20:23] offset:128
    s_waitcnt vmcnt(12)
    ds_write_b128 v11, v[24:27] offset:2176
    ds_write_b128 v11, v[28:31] offset:2304
    s_waitcnt vmcnt(10)
    ds_write_b128 v11, v[32:35] offset:4352
    ds_write_b128 v11, v[36:39] offset:4480
    s_waitcnt vmcnt(8)
    ds_write_b128 v11, v[40:43] offset:6528
    ds_write_b128 v11, v[44:47] offset:6656
    s_waitcnt vmcnt(6)
    ds_write_b128 v11, v[48:51] offset:8704
    ds_write_b128 v11, v[52:55] offset:8832
    s_waitcnt vmcnt(4)
    ds_write_b128 v11, v[56:59] offset:10880
    ds_write_b128 v11, v[60:63] offset:11008
    s_waitcnt vmcnt(2)
    ds_write_b128 v11, v[64:67] offset:13056
    ds_write_b128 v11, v[68:71] offset:13184
    s_waitcnt vmcnt(0)
    ds_write_b128 v11, v[72:75] offset:15232
    ds_write_b128 v11, v[76:79] offset:15360
    s_waitcnt lgkmcnt(0)
    s_lshl_b32 s74, s53, 7
    s_add_u32 s74, s74, 43008
    v_mov_b32 v220, s74
    s_waitcnt vmcnt(0) lgkmcnt(0)
    s_mov_b32 s84, 0
spin45:
    global_load_dwordx2 v[222:223], v220, s[40:41] sc1
    s_sleep 2
    s_add_u32 s84, s84, 1
    s_cmp_gt_u32 s84, 2000000
    s_cbranch_scc1 spun46
    s_waitcnt vmcnt(0)
    v_xor_b32 v222, s42, v222
    v_xor_b32 v223, s43, v223
    v_or_b32 v222, v222, v223
    v_cmp_ne_u32 vcc, 0, v222
    s_cbranch_vccnz spin45
spun46:
    s_waitcnt vmcnt(0)
    ds_read_b64_tr_b16 v[16:17], v12 offset:0
    ds_read_b64_tr_b16 v[18:19], v12 offset:1088
    ds_read_b64_tr_b16 v[20:21], v12 offset:128
    ds_read_b64_tr_b16 v[22:23], v12 offset:1216
    ds_read_b64_tr_b16 v[24:25], v12 offset:8704
    ds_read_b64_tr_b16 v[26:27], v12 offset:9792
    ds_read_b64_tr_b16 v[28:29], v12 offset:8832
    ds_read_b64_tr_b16 v[30:31], v12 offset:9920
    s_lshl_b32 s68, s66, 1
    s_add_u32 s68, s68, 0
    s_mul_i32 s69, s68, 21846
    s_lshr_b32 s69, s69, 16
    s_mul_i32 s70, s69, 3
    s_sub_u32 s70, s68, s70
    s_mul_i32 s70, s70, 80
    s_add_u32 s70, s70, 0
    s_lshl_b32 s68, s66, 2
    s_sub_u32 s68, s68, 96
    s_cmp_lt_u32 s66, 24
    s_cselect_b32 s69, s69, s68
    s_cselect_b32 s70, s70, 240
    s_mul_i32 s69, s69, 286720
    s_lshl_b32 s70, s70, 10
    s_add_u32 s71, s69, s70
    s_lshl_b32 s73, s67, 1
    s_mul_i32 s73, s73, s72
    s_add_u32 s71, s71, s73
    s_add_u32 s71, s71, 31457280
    s_waitcnt lgkmcnt(0)
    buffer_store_dwordx4 v[16:19], v1, s[8:11], s71 offen offset:0 sc1
    buffer_store_dwordx4 v[20:23], v1, s[8:11], s71 offen offset:1024 sc1
    s_add_u32 s71, s71, s72
    buffer_store_dwordx4 v[24:27], v1, s[8:11], s71 offen offset:0 sc1
    buffer_store_dwordx4 v[28:31], v1, s[8:11], s71 offen offset:1024 sc1
    ds_read_b64_tr_b16 v[32:33], v13 offset:0
    ds_read_b64_tr_b16 v[34:35], v13 offset:1088
    ds_read_b64_tr_b16 v[36:37], v13 offset:128
    ds_read_b64_tr_b16 v[38:39], v13 offset:1216
    ds_read_b64_tr_b16 v[40:41], v13 offset:8704
    ds_read_b64_tr_b16 v[42:43], v13 offset:9792
    ds_read_b64_tr_b16 v[44:45], v13 offset:8832
    ds_read_b64_tr_b16 v[46:47], v13 offset:9920
    s_lshl_b32 s68, s66, 1
    s_add_u32 s68, s68, 0
    s_mul_i32 s69, s68, 21846
    s_lshr_b32 s69, s69, 16
    s_mul_i32 s70, s69, 3
    s_sub_u32 s70, s68, s70
    s_mul_i32 s70, s70, 80
    s_add_u32 s70, s70, 2
    s_lshl_b32 s68, s66, 2
    s_sub_u32 s68, s68, 95
    s_cmp_lt_u32 s66, 24
    s_cselect_b32 s69, s69, s68
    s_cselect_b32 s70, s70, 240
    s_mul_i32 s69, s69, 286720
    s_lshl_b32 s70, s70, 10
    s_add_u32 s71, s69, s70
    s_lshl_b32 s73, s67, 1
    s_mul_i32 s73, s73, s72
    s_add_u32 s71, s71, s73
    s_add_u32 s71, s71, 31457280
    s_waitcnt lgkmcnt(0)
    buffer_store_dwordx4 v[32:35], v1, s[8:11], s71 offen offset:0 sc1
    buffer_store_dwordx4 v[36:39], v1, s[8:11], s71 offen offset:1024 sc1
    s_add_u32 s71, s71, s72
    buffer_store_dwordx4 v[40:43], v1, s[8:11], s71 offen offset:0 sc1
    buffer_store_dwordx4 v[44:47], v1, s[8:11], s71 offen offset:1024 sc1
    ds_read_b64_tr_b16 v[48:49], v14 offset:0
    ds_read_b64_tr_b16 v[50:51], v14 offset:1088
    ds_read_b64_tr_b16 v[52:53], v14 offset:128
    ds_read_b64_tr_b16 v[54:55], v14 offset:1216
    ds_read_b64_tr_b16 v[56:57], v14 offset:8704
    ds_read_b64_tr_b16 v[58:59], v14 offset:9792
    ds_read_b64_tr_b16 v[60:61], v14 offset:8832
    ds_read_b64_tr_b16 v[62:63], v14 offset:9920
    s_lshl_b32 s68, s66, 1
    s_add_u32 s68, s68, 1
    s_mul_i32 s69, s68, 21846
    s_lshr_b32 s69, s69, 16
    s_mul_i32 s70, s69, 3
    s_sub_u32 s70, s68, s70
    s_mul_i32 s70, s70, 80
    s_add_u32 s70, s70, 0
    s_lshl_b32 s68, s66, 2
    s_sub_u32 s68, s68, 94
    s_cmp_lt_u32 s66, 24
    s_cselect_b32 s69, s69, s68
    s_cselect_b32 s70, s70, 240
    s_mul_i32 s69, s69, 286720
    s_branch L_past2
L_page2:
    s_setpc_b64 s[98:99]
L_past2:
    s_lshl_b32 s70, s70, 10
    s_add_u32 s71, s69, s70
    s_lshl_b32 s73, s67, 1
    s_mul_i32 s73, s73, s72
    s_add_u32 s71, s71, s73
    s_add_u32 s71, s71, 31457280
    s_waitcnt lgkmcnt(0)
    buffer_store_dwordx4 v[48:51], v1, s[8:11], s71 offen offset:0 sc1
    buffer_store_dwordx4 v[52:55], v1, s[8:11], s71 offen offset:1024 sc1
    s_add_u32 s71, s71, s72
    buffer_store_dwordx4 v[56:59], v1, s[8:11], s71 offen offset:0 sc1
    buffer_store_dwordx4 v[60:63], v1, s[8:11], s71 offen offset:1024 sc1
    ds_read_b64_tr_b16 v[64:65], v15 offset:0
    ds_read_b64_tr_b16 v[66:67], v15 offset:1088
    ds_read_b64_tr_b16 v[68:69], v15 offset:128
    ds_read_b64_tr_b16 v[70:71], v15 offset:1216
    ds_read_b64_tr_b16 v[72:73], v15 offset:8704
    ds_read_b64_tr_b16 v[74:75], v15 offset:9792
    ds_read_b64_tr_b16 v[76:77], v15 offset:8832
    ds_read_b64_tr_b16 v[78:79], v15 offset:9920
    s_lshl_b32 s68, s66, 1
    s_add_u32 s68, s68, 1
    s_mul_i32 s69, s68, 21846
    s_lshr_b32 s69, s69, 16
    s_mul_i32 s70, s69, 3
    s_sub_u32 s70, s68, s70
    s_mul_i32 s70, s70, 80
    s_add_u32 s70, s70, 2
    s_lshl_b32 s68, s66, 2
    s_sub_u32 s68, s68, 93
    s_cmp_lt_u32 s66, 24
    s_cselect_b32 s69, s69, s68
    s_cselect_b32 s70, s70, 240
    s_mul_i32 s69, s69, 286720
    s_lshl_b32 s70, s70, 10
    s_add_u32 s71, s69, s70
    s_lshl_b32 s73, s67, 1
    s_mul_i32 s73, s73, s72
    s_add_u32 s71, s71, s73
    s_add_u32 s71, s71, 31457280
    s_waitcnt lgkmcnt(0)
    buffer_store_dwordx4 v[64:67], v1, s[8:11], s71 offen offset:0 sc1
    buffer_store_dwordx4 v[68:71], v1, s[8:11], s71 offen offset:1024 sc1
    s_add_u32 s71, s71, s72
    buffer_store_dwordx4 v[72:75], v1, s[8:11], s71 offen offset:0 sc1
    buffer_store_dwordx4 v[76:79], v1, s[8:11], s71 offen offset:1024 sc1
    s_branch L_shuf_end
L_shuf_wd:
    s_mov_b32 s12, s34
    s_mov_b32 s13, s35
    s_mov_b32 s14, 2211840
    s_mov_b32 s15, 0x20000
    s_sub_u32 s66, s64, 272
    s_and_b32 s67, s66, 1
    s_lshr_b32 s66, s66, 1
    s_mul_i32 s68, s66, 4682
    s_lshr_b32 s68, s68, 16
    s_mul_i32 s69, s68, 14
    s_sub_u32 s69, s66, s69
    s_and_b32 s70, s69, 3
    s_lshl_b32 s73, s68, 2
    s_add_u32 s71, s73, s70
    s_mul_i32 s71, s71, 3
    s_lshr_b32 s72, s69, 2
    s_add_u32 s71, s71, s72
    s_lshl_b32 s72, s68, 1
    s_add_u32 s72, s72, s70
    s_add_u32 s72, s72, 48
    s_cmp_ge_u32 s69, 12
    s_cselect_b32 s71, s72, s71
    s_mul_i32 s70, s71, 40960
    s_mul_i32 s73, s67, 640
    s_add_u32 s70, s70, s73
    v_mul_u32_u24 v4, 1280, v2
    v_lshl_add_u32 v4, v3, 4, v4
    v_add_u32 v11, s70, v4
    v_add_u32 v12, 10240, v11
    v_add_u32 v13, 20480, v11
    v_add_u32 v14, 30720, v11
    buffer_load_dwordx4 v[16:19], v11, s[12:15], 0 offen offset:0
    buffer_load_dwordx4 v[20:23], v11, s[12:15], 0 offen offset:128
    buffer_load_dwordx4 v[24:27], v11, s[12:15], 0 offen offset:256
    buffer_load_dwordx4 v[28:31], v11, s[12:15], 0 offen offset:384
    buffer_load_dwordx4 v[32:35], v11, s[12:15], 0 offen offset:512
    buffer_load_dwordx4 v[36:39], v12, s[12:15], 0 offen offset:0
    buffer_load_dwordx4 v[40:43], v12, s[12:15], 0 offen offset:128
    buffer_load_dwordx4 v[44:47], v12, s[12:15], 0 offen offset:256
    buffer_load_dwordx4 v[48:51], v12, s[12:15], 0 offen offset:384
    buffer_load_dwordx4 v[52:55], v12, s[12:15], 0 offen offset:512
    buffer_load_dwordx4 v[56:59], v13, s[12:15], 0 offen offset:0
    buffer_load_dwordx4 v[60:63], v13, s[12:15], 0 offen offset:128
    buffer_load_dwordx4 v[64:67], v13, s[12:15], 0 offen offset:256
    buffer_load_dwordx4 v[68:71], v13, s[12:15], 0 offen offset:384
    buffer_load_dwordx4 v[72:75], v13, s[12:15], 0 offen offset:512
    buffer_load_dwordx4 v[76:79], v14, s[12:15], 0 offen offset:0
    buffer_load_dwordx4 v[80:83], v14, s[12:15], 0 offen offset:128
    buffer_load_dwordx4 v[84:87], v14, s[12:15], 0 offen offset:256
    buffer_load_dwordx4 v[88:91], v14, s[12:15], 0 offen offset:384
    buffer_load_dwordx4 v[92:95], v14, s[12:15], 0 offen offset:512
    v_mul_u32_u24 v4, 656, v2
    v_lshl_add_u32 v4, v3, 4, v4
    v_add_u32 v4, s65, v4
    v_mul_u32_u24 v15, 656, v8
    v_add_u32 v15, s65, v15
    v_lshl_add_u32 v2, v10, 4, v15
    v_lshl_add_u32 v3, v10, 3, v15
    s_mul_i32 s70, s67, 1146880
    s_mul_i32 s71, s68, 71680
    s_add_u32 s70, s70, s71
    s_mul_i32 s71, s69, 5120
    s_add_u32 s70, s70, s71
    s_add_u32 s70, s70, 36044800
    s_waitcnt vmcnt(15)
    ds_write_b128 v4, v[16:19] offset:0
    ds_write_b128 v4, v[20:23] offset:128
    ds_write_b128 v4, v[24:27] offset:256
    ds_write_b128 v4, v[28:31] offset:384
    ds_write_b128 v4, v[32:35] offset:512
    s_waitcnt vmcnt(10)
    ds_write_b128 v4, v[36:39] offset:5248
    ds_write_b128 v4, v[40:43] offset:5376
    ds_write_b128 v4, v[44:47] offset:5504
    ds_write_b128 v4, v[48:51] offset:5632
    ds_write_b128 v4, v[52:55] offset:5760
    s_waitcnt vmcnt(5)
    ds_write_b128 v4, v[56:59] offset:10496
    ds_write_b128 v4, v[60:63] offset:10624
    ds_write_b128 v4, v[64:67] offset:10752
    ds_write_b128 v4, v[68:71] offset:10880
    ds_write_b128 v4, v[72:75] offset:11008
    s_waitcnt vmcnt(0)
    ds_write_b128 v4, v[76:79] offset:15744
    ds_write_b128 v4, v[80:83] offset:15872
    ds_write_b128 v4, v[84:87] offset:16000
    ds_write_b128 v4, v[88:91] offset:16128
    ds_write_b128 v4, v[92:95] offset:16256
    s_waitcnt lgkmcnt(0)
    s_lshl_b32 s74, s53, 7
    s_add_u32 s74, s74, 43008
    v_mov_b32 v220, s74
    s_waitcnt vmcnt(0) lgkmcnt(0)
    s_mov_b32 s84, 0
spin47:
    global_load_dwordx2 v[222:223], v220, s[40:41] sc1
    s_sleep 2
    s_add_u32 s84, s84, 1
    s_cmp_gt_u32 s84, 2000000
    s_cbranch_scc1 spun48
    s_waitcnt vmcnt(0)
    v_xor_b32 v222, s42, v222
    v_xor_b32 v223, s43, v223
    v_or_b32 v222, v222, v223
    v_cmp_ne_u32 vcc, 0, v222
    s_cbranch_vccnz spin47
spun48:
    s_waitcnt vmcnt(0)
    ds_read_b64_tr_b16 v[16:17], v2 offset:0
    ds_read_b64_tr_b16 v[18:19], v2 offset:2624
    ds_read_b64_tr_b16 v[20:21], v2 offset:8
    ds_read_b64_tr_b16 v[22:23], v2 offset:2632
    ds_read_b64_tr_b16 v[24:25], v2 offset:64
    ds_read_b64_tr_b16 v[26:27], v2 offset:2688
    ds_read_b64_tr_b16 v[28:29], v2 offset:72
    ds_read_b64_tr_b16 v[30:31], v2 offset:2696
    ds_read_b64_tr_b16 v[32:33], v3 offset:128
    ds_read_b64_tr_b16 v[34:35], v3 offset:2752
    s_waitcnt lgkmcnt(0)
    buffer_store_dwordx4 v[16:19], v1, s[8:11], s70 offen offset:0 sc1
    buffer_store_dwordx4 v[20:23], v1, s[8:11], s70 offen offset:1024 sc1
    buffer_store_dwordx4 v[24:27], v1, s[8:11], s70 offen offset:2048 sc1
    buffer_store_dwordx4 v[28:31], v1, s[8:11], s70 offen offset:3072 sc1
    s_add_u32 s71, s70, 4096
    buffer_store_dwordx4 v[32:35], v1, s[8:11], s71 offen sc1
    s_add_u32 s70, s70, 286720
    ds_read_b64_tr_b16 v[36:37], v2 offset:160
    ds_read_b64_tr_b16 v[38:39], v2 offset:2784
    ds_read_b64_tr_b16 v[40:41], v2 offset:168
    ds_read_b64_tr_b16 v[42:43], v2 offset:2792
    ds_read_b64_tr_b16 v[44:45], v2 offset:224
    ds_read_b64_tr_b16 v[46:47], v2 offset:2848
    ds_read_b64_tr_b16 v[48:49], v2 offset:232
    ds_read_b64_tr_b16 v[50:51], v2 offset:2856
    ds_read_b64_tr_b16 v[52:53], v3 offset:288
    ds_read_b64_tr_b16 v[54:55], v3 offset:2912
    s_waitcnt lgkmcnt(0)
    buffer_store_dwordx4 v[36:39], v1, s[8:11], s70 offen offset:0 sc1
    buffer_store_dwordx4 v[40:43], v1, s[8:11], s70 offen offset:1024 sc1
    buffer_store_dwordx4 v[44:47], v1, s[8:11], s70 offen offset:2048 sc1
    buffer_store_dwordx4 v[48:51], v1, s[8:11], s70 offen offset:3072 sc1
    s_add_u32 s71, s70, 4096
    buffer_store_dwordx4 v[52:55], v1, s[8:11], s71 offen sc1
    s_add_u32 s70, s70, 286720
    ds_read_b64_tr_b16 v[56:57], v2 offset:320
    ds_read_b64_tr_b16 v[58:59], v2 offset:2944
    ds_read_b64_tr_b16 v[60:61], v2 offset:328
    ds_read_b64_tr_b16 v[62:63], v2 offset:2952
    ds_read_b64_tr_b16 v[64:65], v2 offset:384
    ds_read_b64_tr_b16 v[66:67], v2 offset:3008
    ds_read_b64_tr_b16 v[68:69], v2 offset:392
    ds_read_b64_tr_b16 v[70:71], v2 offset:3016
    ds_read_b64_tr_b16 v[72:73], v3 offset:448
    ds_read_b64_tr_b16 v[74:75], v3 offset:3072
    s_waitcnt lgkmcnt(0)
    buffer_store_dwordx4 v[56:59], v1, s[8:11], s70 offen offset:0 sc1
    buffer_store_dwordx4 v[60:63], v1, s[8:11], s70 offen offset:1024 sc1
    buffer_store_dwordx4 v[64:67], v1, s[8:11], s70 offen offset:2048 sc1
    buffer_store_dwordx4 v[68:71], v1, s[8:11], s70 offen offset:3072 sc1
    s_add_u32 s71, s70, 4096
    buffer_store_dwordx4 v[72:75], v1, s[8:11], s71 offen sc1
    s_add_u32 s70, s70, 286720
    ds_read_b64_tr_b16 v[76:77], v2 offset:480
    ds_read_b64_tr_b16 v[78:79], v2 offset:3104
    ds_read_b64_tr_b16 v[80:81], v2 offset:488
    ds_read_b64_tr_b16 v[82:83], v2 offset:3112
    ds_read_b64_tr_b16 v[84:85], v2 offset:544
    ds_read_b64_tr_b16 v[86:87], v2 offset:3168
    ds_read_b64_tr_b16 v[88:89], v2 offset:552
    ds_read_b64_tr_b16 v[90:91], v2 offset:3176
    ds_read_b64_tr_b16 v[92:93], v3 offset:608
    ds_read_b64_tr_b16 v[94:95], v3 offset:3232
    s_waitcnt lgkmcnt(0)
    buffer_store_dwordx4 v[76:79], v1, s[8:11], s70 offen offset:0 sc1
    buffer_store_dwordx4 v[80:83], v1, s[8:11], s70 offen offset:1024 sc1
    buffer_store_dwordx4 v[84:87], v1, s[8:11], s70 offen offset:2048 sc1
    buffer_store_dwordx4 v[88:91], v1, s[8:11], s70 offen offset:3072 sc1
    s_add_u32 s71, s70, 4096
    buffer_store_dwordx4 v[92:95], v1, s[8:11], s71 offen sc1
    s_add_u32 s70, s70, 286720
L_shuf_go:
    s_lshl_b32 s74, s53, 7
    s_add_u32 s74, s74, 43008
    v_mov_b32 v220, s74
    s_waitcnt vmcnt(0) lgkmcnt(0)
    s_mov_b32 s84, 0
spin49:
    global_load_dwordx2 v[222:223], v220, s[40:41] sc1
    s_sleep 2
    s_add_u32 s84, s84, 1
    s_cmp_gt_u32 s84, 2000000
    s_cbranch_scc1 spun50
    s_waitcnt vmcnt(0)
    v_xor_b32 v222, s42, v222
    v_xor_b32 v223, s43, v223
    v_or_b32 v222, v222, v223
    v_cmp_ne_u32 vcc, 0, v222
    s_cbranch_vccnz spin49
spun50:
    s_waitcnt vmcnt(0)
L_shuf_end:
    v_add_u32 v216, 41088, v1
    v_and_b32 v217, 0xf0, v1
    v_add_u32 v217, 42112, v217
    global_load_dwordx4 v[208:211], v216, s[40:41] sc1
    global_load_dwordx4 v[212:215], v217, s[40:41] sc1
    s_waitcnt vmcnt(0)
    v_xor_b32 v208, s42, v208
    v_xor_b32 v209, s43, v209
    v_or_b32 v208, v208, v209
    v_xor_b32 v210, s42, v210
    v_xor_b32 v211, s43, v211
    v_or3_b32 v208, v208, v210, v211
    v_xor_b32 v212, s42, v212
    v_xor_b32 v213, s43, v213
    v_or3_b32 v208, v208, v212, v213
    v_xor_b32 v214, s42, v214
    v_xor_b32 v215, s43, v215
    v_or3_b32 v208, v208, v214, v215
    v_cmp_ne_u32 vcc, 0, v208
    s_cbranch_vccz allok51
    s_mov_b32 s84, 0
spin52:
    global_load_dwordx4 v[208:211], v216, s[40:41] sc1
    global_load_dwordx4 v[212:215], v217, s[40:41] sc1
    s_add_u32 s84, s84, 1
    s_cmp_gt_u32 s84, 2000000
    s_cbranch_scc1 spun53
    s_waitcnt vmcnt(0)
    v_xor_b32 v208, s42, v208
    v_xor_b32 v209, s43, v209
    v_or_b32 v208, v208, v209
    v_xor_b32 v210, s42, v210
    v_xor_b32 v211, s43, v211
    v_or3_b32 v208, v208, v210, v211
    v_xor_b32 v212, s42, v212
    v_xor_b32 v213, s43, v213
    v_or3_b32 v208, v208, v212, v213
    v_xor_b32 v214, s42, v214
    v_xor_b32 v215, s43, v215
    v_or3_b32 v208, v208, v214, v215
    v_cmp_ne_u32 vcc, 0, v208
    s_cbranch_vccnz spin52
spun53:
    s_waitcnt vmcnt(0)
allok51:
    s_waitcnt vmcnt(0) lgkmcnt(0)
    s_barrier
    s_lshr_b32 s65, s58, 4
    s_lshl_b32 s65, s65, 12
    s_add_u32 s65, s65, 2048
    s_cmp_lg_u32 s52, 0
    s_cbranch_scc1 w054
    s_mov_b64 exec, 0xff
    v_lshlrev_b32 v6, 8, v0
    v_add_u32 v6, s65, v6
    v_mov_b32 v7, 1
    global_atomic_add v6, v7, s[40:41] sc1
    s_mov_b64 exec, -1
w054:
    s_lshl_b32 s68, s53, 8
    s_add_u32 s68, s68, 2048
    v_min_u32 v7, 5, v0
    v_lshlrev_b32 v7, 12, v7
    v_add_u32 v7, s68, v7
    s_cmp_lg_u32 s52, 0
    s_cbranch_scc1 w055
    s_mov_b32 s84, 0
spin56:
    global_load_dword v6, v7, s[40:41] sc1
    s_add_u32 s84, s84, 1
    s_cmp_gt_u32 s84, 2000000
    s_cbranch_scc1 spun57
    s_waitcnt vmcnt(0)
    v_cmp_gt_u32 vcc, 16, v6
    s_cbranch_vccnz spin56
spun57:
    s_waitcnt vmcnt(0)
w055:
    s_barrier
L_r1:
    s_mul_i32 s85, s62, 286720
    s_lshl_b32 s87, s52, 12
    s_add_u32 s85, s85, s87
    s_add_u32 s85, s85, 31457280
    s_mul_i32 s94, s57, 286720
    s_mul_i32 s64, s52, 71680
    s_add_u32 s94, s94, s64
    s_add_u32 s94, s94, 36044800
    v_and_b32 v8, 7, v0
    v_lshrrev_b32 v9, 3, v0
    s_mul_i32 s64, s52, 20
    v_add_u32 v9, s64, v9
    v_lshlrev_b32 v10, 8, v9
    v_lshl_add_u32 v10, v8, 4, v10
    v_add_u32 v11, 2048, v10
    v_add_u32 v12, 4096, v10
    v_mov_b32 v15, 0x80000000
    v_cmp_gt_u32 vcc, 32, v0
    s_nop 1
    v_cndmask_b32 v12, v15, v12, vcc
    v_lshlrev_b32 v14, 5, v8
    v_add_u32 v14, 155648, v14
    s_lshl_b32 s64, s52, 3
    v_add_u32 v13, s64, v14
    s_lshr_b32 s65, s61, 1
    s_mul_i32 s65, s65, 20480
    s_and_b32 s66, s61, 1
    s_lshl_b32 s66, s66, 7
    s_add_u32 s65, s65, s66
    s_lshl_b32 s66, s52, 10
    v_add_u32 v4, s66, v1
    s_waitcnt vmcnt(0) lgkmcnt(0)
    v_add_u32 v4, 131072, v4
    v_lshlrev_b32 v2, 8, v9
    v_lshl_add_u32 v2, v8, 3, v2
    v_add_u32 v3, 4096, v2
    v_cmp_gt_u32 vcc, 32, v0
    s_nop 1
    v_cndmask_b32 v3, v15, v3, vcc
    s_lshr_b32 s67, s61, 1
    s_mul_i32 s67, s67, 20480
    s_and_b32 s68, s61, 1
    s_lshl_b32 s68, s68, 6
    s_add_u32 s67, s67, s68
    s_add_u32 s67, s67, 3670016
    s_add_u32 s86, s85, 0
    s_add_u32 m0, s87, 0
    v_accvgpr_read_b32 v64, a240
    v_accvgpr_read_b32 v65, a241
    v_accvgpr_read_b32 v66, a242
    v_accvgpr_read_b32 v67, a243
    v_accvgpr_read_b32 v68, a244
    buffer_load_dwordx4 v1, s[8:11], s86 offen offset:0 sc1 lds
    v_accvgpr_read_b32 v69, a245
    v_accvgpr_read_b32 v70, a246
    v_accvgpr_read_b32 v71, a247
    v_accvgpr_read_b32 v72, a248
    v_accvgpr_read_b32 v73, a249
    buffer_load_dwordx4 v1, s[8:11], s86 offen offset:1024 sc1 lds
    v_accvgpr_read_b32 v74, a250
    v_accvgpr_read_b32 v75, a251
    v_lshlrev_b32 v16, 16, v64
    v_and_b32 v17, s60, v64
    v_lshlrev_b32 v18, 16, v65
    buffer_load_dwordx4 v1, s[8:11], s86 offen offset:2048 sc1 lds
    v_and_b32 v19, s60, v65
    v_lshlrev_b32 v20, 16, v66
    v_and_b32 v21, s60, v66
    v_lshlrev_b32 v22, 16, v67
    v_and_b32 v23, s60, v67
    buffer_load_dwordx4 v1, s[8:11], s86 offen offset:3072 sc1 lds
    s_add_u32 s86, s85, 16384
    s_add_u32 m0, s87, 16384
    v_lshlrev_b32 v24, 16, v68
    v_and_b32 v25, s60, v68
    v_lshlrev_b32 v26, 16, v69
    v_and_b32 v27, s60, v69
    v_lshlrev_b32 v28, 16, v70
    buffer_load_dwordx4 v1, s[8:11], s86 offen offset:0 sc1 lds
    v_and_b32 v29, s60, v70
    v_lshlrev_b32 v30, 16, v71
    v_and_b32 v31, s60, v71
    v_lshlrev_b32 v32, 16, v72
    v_and_b32 v33, s60, v72
    buffer_load_dwordx4 v1, s[8:11], s86 offen offset:1024 sc1 lds
    v_lshlrev_b32 v34, 16, v73
    v_and_b32 v35, s60, v73
    v_lshlrev_b32 v36, 16, v74
    v_and_b32 v37, s60, v74
    v_lshlrev_b32 v38, 16, v75
    buffer_load_dwordx4 v1, s[8:11], s86 offen offset:2048 sc1 lds
    v_and_b32 v39, s60, v75
    v_pk_add_f32 v[112:113], v[16:17], v[18:19]
    v_pk_mul_f32 v[114:115], v[16:17], v[16:17]
    v_pk_fma_f32 v[114:115], v[18:19], v[18:19], v[114:115]
    v_pk_add_f32 v[112:113], v[112:113], v[20:21]
    buffer_load_dwordx4 v1, s[8:11], s86 offen offset:3072 sc1 lds
    s_add_u32 s86, s85, 32768
    s_add_u32 m0, s87, 32768
    v_pk_fma_f32 v[114:115], v[20:21], v[20:21], v[114:115]
    v_pk_add_f32 v[112:113], v[112:113], v[22:23]
    v_pk_fma_f32 v[114:115], v[22:23], v[22:23], v[114:115]
    v_pk_add_f32 v[112:113], v[112:113], v[24:25]
    v_pk_fma_f32 v[114:115], v[24:25], v[24:25], v[114:115]
    buffer_load_dwordx4 v1, s[8:11], s86 offen offset:0 sc1 lds
    v_pk_add_f32 v[112:113], v[112:113], v[26:27]
    v_pk_fma_f32 v[114:115], v[26:27], v[26:27], v[114:115]
    v_pk_add_f32 v[112:113], v[112:113], v[28:29]
    v_pk_fma_f32 v[114:115], v[28:29], v[28:29], v[114:115]
    v_pk_add_f32 v[112:113], v[112:113], v[30:31]
    buffer_load_dwordx4 v1, s[8:11], s86 offen offset:1024 sc1 lds
    v_pk_fma_f32 v[114:115], v[30:31], v[30:31], v[114:115]
    v_pk_add_f32 v[112:113], v[112:113], v[32:33]
    v_pk_fma_f32 v[114:115], v[32:33], v[32:33], v[114:115]
    v_pk_add_f32 v[112:113], v[112:113], v[34:35]
    v_pk_fma_f32 v[114:115], v[34:35], v[34:35], v[114:115]
    buffer_load_dwordx4 v1, s[8:11], s86 offen offset:2048 sc1 lds
    v_pk_add_f32 v[112:113], v[112:113], v[36:37]
    v_pk_fma_f32 v[114:115], v[36:37], v[36:37], v[114:115]
    v_pk_add_f32 v[112:113], v[112:113], v[38:39]
    v_pk_fma_f32 v[114:115], v[38:39], v[38:39], v[114:115]
    v_add_f32 v112, v112, v113
    buffer_load_dwordx4 v1, s[8:11], s86 offen offset:3072 sc1 lds
    v_add_f32 v113, v114, v115
    v_add_f32_dpp v112, v112, v112 row_ror:8 row_mask:0xf bank_mask:0xf
    s_nop 0
    v_add_f32_dpp v113, v113, v113 row_ror:8 row_mask:0xf bank_mask:0xf
    v_mov_b32 v114, v112
    v_mov_b32 v115, v113
    s_nop 0
    v_permlane16_swap_b32 v112, v114
    v_permlane16_swap_b32 v113, v115
    v_add_f32 v112, v112, v114
    v_add_f32 v113, v113, v115
    v_mov_b32 v114, v112
    v_mov_b32 v115, v113
    s_nop 0
    v_permlane32_swap_b32 v112, v114
    v_permlane32_swap_b32 v113, v115
    v_add_f32 v112, v112, v114
    v_add_f32 v113, v113, v115
    s_mov_b64 exec, 0xff
    ds_write_b64 v13, v[112:113] offset:0
    s_mov_b64 exec, -1
    s_waitcnt lgkmcnt(0)
    s_barrier
    ds_read_b128 v[112:115], v14 offset:0
    ds_read_b128 v[116:119], v14 offset:16
    s_waitcnt lgkmcnt(0)
    v_pk_add_f32 v[112:113], v[112:113], v[114:115]
    v_pk_add_f32 v[116:117], v[116:117], v[118:119]
    v_pk_add_f32 v[112:113], v[112:113], v[116:117]
    v_mul_f32 v112, 0x3acccccd, v112
    v_mul_f32 v113, 0x3acccccd, v113
    v_fma_f32 v113, -v112, v112, v113
    v_max_f32 v113, 0, v113
    v_add_f32 v113, 0x3727c5ac, v113
    v_rsq_f32 v120, v113
    s_nop 0
    v_mul_f32_e64 v121, -v112, v120
    v_pk_fma_f32 v[88:89], v[16:17], v[120:121], v[120:121] op_sel:[0,0,1] op_sel_hi:[1,0,1]
    v_pk_fma_f32 v[90:91], v[18:19], v[120:121], v[120:121] op_sel:[0,0,1] op_sel_hi:[1,0,1]
    v_pk_fma_f32 v[92:93], v[20:21], v[120:121], v[120:121] op_sel:[0,0,1] op_sel_hi:[1,0,1]
    v_pk_fma_f32 v[94:95], v[22:23], v[120:121], v[120:121] op_sel:[0,0,1] op_sel_hi:[1,0,1]
    v_pk_fma_f32 v[96:97], v[24:25], v[120:121], v[120:121] op_sel:[0,0,1] op_sel_hi:[1,0,1]
    v_pk_fma_f32 v[98:99], v[26:27], v[120:121], v[120:121] op_sel:[0,0,1] op_sel_hi:[1,0,1]
    v_pk_fma_f32 v[100:101], v[28:29], v[120:121], v[120:121] op_sel:[0,0,1] op_sel_hi:[1,0,1]
    v_pk_fma_f32 v[102:103], v[30:31], v[120:121], v[120:121] op_sel:[0,0,1] op_sel_hi:[1,0,1]
    v_pk_fma_f32 v[104:105], v[32:33], v[120:121], v[120:121] op_sel:[0,0,1] op_sel_hi:[1,0,1]
    v_pk_fma_f32 v[106:107], v[34:35], v[120:121], v[120:121] op_sel:[0,0,1] op_sel_hi:[1,0,1]
    v_pk_fma_f32 v[108:109], v[36:37], v[120:121], v[120:121] op_sel:[0,0,1] op_sel_hi:[1,0,1]
    v_pk_fma_f32 v[110:111], v[38:39], v[120:121], v[120:121] op_sel:[0,0,1] op_sel_hi:[1,0,1]
    s_lshl_b32 s68, s53, 8
    s_add_u32 s68, s68, 0
    v_and_b32 v7, 15, v0
    v_lshlrev_b32 v6, 12, v7
    v_subrev_u32 v122, 38912, v6
    v_cmp_gt_u32 vcc, 10, v7
    s_nop 1
    v_cndmask_b32 v7, v122, v6, vcc
    v_add_u32 v7, s68, v7
    s_cmp_lg_u32 s52, 0
    s_cbranch_scc1 w058
    s_mov_b32 s84, 0
spin59:
    global_load_dword v6, v7, s[40:41] sc1
    s_add_u32 s84, s84, 1
    s_cmp_gt_u32 s84, 2000000
    s_cbranch_scc1 spun60
    s_waitcnt vmcnt(0)
    v_cmp_gt_u32 vcc, 16, v6
    s_cbranch_vccnz spin59
spun60:
    s_waitcnt vmcnt(0)
w058:
    s_barrier
    buffer_load_dwordx2 v[64:65], v2, s[8:11], s67 offen offset:0 sc1
    buffer_load_dwordx2 v[66:67], v2, s[8:11], s67 offen offset:128 sc1
    buffer_load_dwordx2 v[68:69], v2, s[8:11], s67 offen offset:2048 sc1
    buffer_load_dwordx2 v[70:71], v2, s[8:11], s67 offen offset:2176 sc1
    buffer_load_dwordx2 v[72:73], v3, s[8:11], s67 offen offset:0 sc1
    buffer_load_dwordx2 v[74:75], v3, s[8:11], s67 offen offset:128 sc1
    s_add_u32 s86, s85, 49152
    s_add_u32 m0, s87, 49152
    s_nop 0
    buffer_load_dwordx4 v1, s[8:11], s86 offen offset:0 sc1 lds
    buffer_load_dwordx4 v1, s[8:11], s86 offen offset:1024 sc1 lds
    buffer_load_dwordx4 v1, s[8:11], s86 offen offset:2048 sc1 lds
    buffer_load_dwordx4 v1, s[8:11], s86 offen offset:3072 sc1 lds
    s_waitcnt vmcnt(4)
    v_lshlrev_b32 v40, 16, v64
    v_and_b32 v41, s60, v64
    v_lshlrev_b32 v42, 16, v65
    v_and_b32 v43, s60, v65
    v_lshlrev_b32 v44, 16, v66
    v_and_b32 v45, s60, v66
    v_lshlrev_b32 v46, 16, v67
    v_and_b32 v47, s60, v67
    s_add_u32 s86, s85, 65536
    s_add_u32 m0, s87, 65536
    v_lshlrev_b32 v48, 16, v68
    v_and_b32 v49, s60, v68
    v_lshlrev_b32 v50, 16, v69
    v_and_b32 v51, s60, v69
    v_lshlrev_b32 v52, 16, v70
    v_and_b32 v53, s60, v70
    v_lshlrev_b32 v54, 16, v71
    v_and_b32 v55, s60, v71
    buffer_load_dwordx4 v1, s[8:11], s86 offen offset:0 sc1 lds
    v_lshlrev_b32 v56, 16, v72
    v_and_b32 v57, s60, v72
    v_lshlrev_b32 v58, 16, v73
    v_and_b32 v59, s60, v73
    v_lshlrev_b32 v60, 16, v74
    v_and_b32 v61, s60, v74
    v_lshlrev_b32 v62, 16, v75
    v_and_b32 v63, s60, v75
    buffer_load_dwordx4 v1, s[8:11], s86 offen offset:1024 sc1 lds
    v_pk_fma_f32 v[16:17], v[88:89], v[40:41], v[16:17]
    v_pk_fma_f32 v[18:19], v[90:91], v[42:43], v[18:19]
    v_pk_fma_f32 v[20:21], v[92:93], v[44:45], v[20:21]
    v_pk_fma_f32 v[22:23], v[94:95], v[46:47], v[22:23]
    v_pk_fma_f32 v[24:25], v[96:97], v[48:49], v[24:25]
    v_pk_fma_f32 v[26:27], v[98:99], v[50:51], v[26:27]
    v_pk_fma_f32 v[28:29], v[100:101], v[52:53], v[28:29]
    v_pk_fma_f32 v[30:31], v[102:103], v[54:55], v[30:31]
    buffer_load_dwordx4 v1, s[8:11], s86 offen offset:2048 sc1 lds
    v_pk_fma_f32 v[32:33], v[104:105], v[56:57], v[32:33]
    v_pk_fma_f32 v[34:35], v[106:107], v[58:59], v[34:35]
    v_pk_fma_f32 v[36:37], v[108:109], v[60:61], v[36:37]
    v_pk_fma_f32 v[38:39], v[110:111], v[62:63], v[38:39]
    ds_write_b128 v4, v[64:67] offset:12288
    ds_write_b128 v4, v[68:71] offset:16384
    ds_write_b128 v4, v[72:75] offset:20480
    v_pk_add_f32 v[112:113], v[16:17], v[18:19]
    v_pk_mul_f32 v[114:115], v[16:17], v[16:17]
    v_pk_fma_f32 v[114:115], v[18:19], v[18:19], v[114:115]
    v_pk_add_f32 v[112:113], v[112:113], v[20:21]
    buffer_load_dwordx4 v1, s[8:11], s86 offen offset:3072 sc1 lds
    v_pk_fma_f32 v[114:115], v[20:21], v[20:21], v[114:115]
    v_pk_add_f32 v[112:113], v[112:113], v[22:23]
    v_pk_fma_f32 v[114:115], v[22:23], v[22:23], v[114:115]
    v_pk_add_f32 v[112:113], v[112:113], v[24:25]
    v_pk_fma_f32 v[114:115], v[24:25], v[24:25], v[114:115]
    v_pk_add_f32 v[112:113], v[112:113], v[26:27]
    v_pk_fma_f32 v[114:115], v[26:27], v[26:27], v[114:115]
    v_pk_add_f32 v[112:113], v[112:113], v[28:29]
    v_pk_fma_f32 v[114:115], v[28:29], v[28:29], v[114:115]
    v_pk_add_f32 v[112:113], v[112:113], v[30:31]
    v_pk_fma_f32 v[114:115], v[30:31], v[30:31], v[114:115]
    v_pk_add_f32 v[112:113], v[112:113], v[32:33]
    v_pk_fma_f32 v[114:115], v[32:33], v[32:33], v[114:115]
    v_pk_add_f32 v[112:113], v[112:113], v[34:35]
    v_pk_fma_f32 v[114:115], v[34:35], v[34:35], v[114:115]
    v_pk_add_f32 v[112:113], v[112:113], v[36:37]
    v_pk_fma_f32 v[114:115], v[36:37], v[36:37], v[114:115]
    v_pk_add_f32 v[112:113], v[112:113], v[38:39]
    v_pk_fma_f32 v[114:115], v[38:39], v[38:39], v[114:115]
    v_add_f32 v112, v112, v113
    v_add_f32 v113, v114, v115
    s_nop 0
    v_add_f32_dpp v112, v112, v112 row_ror:8 row_mask:0xf bank_mask:0xf
    v_add_f32_dpp v113, v113, v113 row_ror:8 row_mask:0xf bank_mask:0xf
    v_mov_b32 v114, v112
    v_mov_b32 v115, v113
    s_nop 0
    v_permlane16_swap_b32 v112, v114
    v_permlane16_swap_b32 v113, v115
    v_add_f32 v112, v112, v114
    v_add_f32 v113, v113, v115
    v_mov_b32 v114, v112
    v_mov_b32 v115, v113
    s_nop 0
    v_permlane32_swap_b32 v112, v114
    v_permlane32_swap_b32 v113, v115
    v_add_f32 v112, v112, v114
    v_add_f32 v113, v113, v115
    s_mov_b64 exec, 0xff
    ds_write_b64 v13, v[112:113] offset:256
    s_mov_b64 exec, -1
    s_waitcnt lgkmcnt(0)
    s_barrier
    ds_read_b128 v[112:115], v14 offset:256
    ds_read_b128 v[116:119], v14 offset:272
    s_waitcnt lgkmcnt(0)
    v_pk_add_f32 v[112:113], v[112:113], v[114:115]
    v_pk_add_f32 v[116:117], v[116:117], v[118:119]
    v_pk_add_f32 v[112:113], v[112:113], v[116:117]
    v_mul_f32 v112, 0x3acccccd, v112
    v_mul_f32 v113, 0x3acccccd, v113
    v_fma_f32 v113, -v112, v112, v113
    v_max_f32 v113, 0, v113
    v_add_f32 v113, 0x3727c5ac, v113
    v_rsq_f32 v120, v113
    s_nop 0
    v_mul_f32 v120, 0x3eeff558, v120
    v_mul_f32_e64 v121, -v112, v120
    v_pk_fma_f32 v[88:89], v[16:17], v[120:121], v[120:121] op_sel:[0,0,1] op_sel_hi:[1,0,1]
    v_pk_fma_f32 v[90:91], v[18:19], v[120:121], v[120:121] op_sel:[0,0,1] op_sel_hi:[1,0,1]
    v_pk_fma_f32 v[92:93], v[20:21], v[120:121], v[120:121] op_sel:[0,0,1] op_sel_hi:[1,0,1]
    v_pk_fma_f32 v[94:95], v[22:23], v[120:121], v[120:121] op_sel:[0,0,1] op_sel_hi:[1,0,1]
    v_pk_fma_f32 v[96:97], v[24:25], v[120:121], v[120:121] op_sel:[0,0,1] op_sel_hi:[1,0,1]
    v_pk_fma_f32 v[98:99], v[26:27], v[120:121], v[120:121] op_sel:[0,0,1] op_sel_hi:[1,0,1]
    v_pk_fma_f32 v[100:101], v[28:29], v[120:121], v[120:121] op_sel:[0,0,1] op_sel_hi:[1,0,1]
    v_pk_fma_f32 v[102:103], v[30:31], v[120:121], v[120:121] op_sel:[0,0,1] op_sel_hi:[1,0,1]
    v_pk_fma_f32 v[104:105], v[32:33], v[120:121], v[120:121] op_sel:[0,0,1] op_sel_hi:[1,0,1]
    v_pk_fma_f32 v[106:107], v[34:35], v[120:121], v[120:121] op_sel:[0,0,1] op_sel_hi:[1,0,1]
    v_pk_fma_f32 v[108:109], v[36:37], v[120:121], v[120:121] op_sel:[0,0,1] op_sel_hi:[1,0,1]
    v_pk_fma_f32 v[110:111], v[38:39], v[120:121], v[120:121] op_sel:[0,0,1] op_sel_hi:[1,0,1]
    s_add_u32 s66, s65, 6291456
    v_cvt_pk_bf16_f32 v64, v88, v89
    v_cvt_pk_bf16_f32 v65, v90, v91
    v_cvt_pk_bf16_f32 v66, v92, v93
    v_cvt_pk_bf16_f32 v67, v94, v95
    buffer_store_dwordx4 v[64:67], v10, s[8:11], s66 offen sc1
    v_cvt_pk_bf16_f32 v68, v96, v97
    v_cvt_pk_bf16_f32 v69, v98, v99
    v_cvt_pk_bf16_f32 v70, v100, v101
    v_cvt_pk_bf16_f32 v71, v102, v103
    buffer_store_dwordx4 v[68:71], v11, s[8:11], s66 offen sc1
    v_cvt_pk_bf16_f32 v72, v104, v105
    v_cvt_pk_bf16_f32 v73, v106, v107
    s_branch L_past3
L_page3:
    s_setpc_b64 s[98:99]
L_past3:
    v_cvt_pk_bf16_f32 v74, v108, v109
    v_cvt_pk_bf16_f32 v75, v110, v111
    buffer_store_dwordx4 v[72:75], v12, s[8:11], s66 offen sc1
    v_cvt_pk_bf16_f32 v76, v16, v17
    v_cvt_pk_bf16_f32 v77, v18, v19
    v_cvt_pk_bf16_f32 v78, v20, v21
    v_cvt_pk_bf16_f32 v79, v22, v23
    v_cvt_pk_bf16_f32 v80, v24, v25
    v_cvt_pk_bf16_f32 v81, v26, v27
    v_cvt_pk_bf16_f32 v82, v28, v29
    v_cvt_pk_bf16_f32 v83, v30, v31
    v_cvt_pk_bf16_f32 v84, v32, v33
    v_cvt_pk_bf16_f32 v85, v34, v35
    v_cvt_pk_bf16_f32 v86, v36, v37
    v_cvt_pk_bf16_f32 v87, v38, v39
    ds_write_b128 v4, v[76:79] offset:0
    ds_write_b128 v4, v[80:83] offset:4096
    ds_write_b128 v4, v[84:87] offset:8192
    s_lshl_b32 s64, s55, 8
    s_add_u32 s64, s64, 128
    s_waitcnt vmcnt(0)
    s_barrier
    s_cmp_lg_u32 s52, 0
    s_cbranch_scc1 w061
    s_mov_b64 exec, 1
    v_mov_b32 v6, s64
    v_mov_b32 v7, 1
    global_atomic_add v6, v7, s[40:41] sc1
    s_mov_b64 exec, -1
w061:
    v_mov_b32 v7, s64
    s_add_u32 s86, s85, 81920
    s_add_u32 m0, s87, 81920
    s_nop 0
    buffer_load_dwordx4 v1, s[8:11], s86 offen offset:0 sc1 lds
    buffer_load_dwordx4 v1, s[8:11], s86 offen offset:1024 sc1 lds
    buffer_load_dwordx4 v1, s[8:11], s86 offen offset:2048 sc1 lds
    buffer_load_dwordx4 v1, s[8:11], s86 offen offset:3072 sc1 lds
    s_add_u32 s86, s85, 98304
    s_add_u32 m0, s87, 98304
    s_nop 0
    buffer_load_dwordx4 v1, s[8:11], s86 offen offset:0 sc1 lds
    buffer_load_dwordx4 v1, s[8:11], s86 offen offset:1024 sc1 lds
    buffer_load_dwordx4 v1, s[8:11], s86 offen offset:2048 sc1 lds
    buffer_load_dwordx4 v1, s[8:11], s86 offen offset:3072 sc1 lds
    s_add_u32 s86, s85, 114688
    s_add_u32 m0, s87, 114688
    s_nop 0
    buffer_load_dwordx4 v1, s[8:11], s86 offen offset:0 sc1 lds
    buffer_load_dwordx4 v1, s[8:11], s86 offen offset:1024 sc1 lds
    buffer_load_dwordx4 v1, s[8:11], s86 offen offset:2048 sc1 lds
    buffer_load_dwordx4 v1, s[8:11], s86 offen offset:3072 sc1 lds
    v_add_u32 v2, 0x10000, v1
    v_mov_b32 v4, 0x409d30fc
    v_bfe_u32 v8, v0, 4, 1
    v_mul_u32_u24 v3, 57344, v8
    v_lshrrev_b32 v8, 5, v0
    v_lshl_add_u32 v3, v8, 8, v3
    v_and_b32 v8, 15, v0
    v_lshl_add_u32 v3, v8, 4, v3
    s_lshl_b32 s64, s55, 3
    s_lshl_b32 s65, s52, 1
    s_add_u32 s65, s65, s64
    s_mul_i32 s74, s65, 20480
    s_add_u32 s74, s74, 6291456
    s_add_u32 s75, s74, 20480
    s_mul_i32 s65, s65, 57344
    s_lshr_b32 s66, s62, 2
    s_mul_i32 s66, s66, 14336
    s_add_u32 s65, s65, s66
    s_add_u32 s65, s65, 16777216
    s_and_b32 s66, s62, 3
    s_lshl_b32 s67, s66, 10
    s_add_u32 s92, s65, s67
    s_add_u32 s80, s92, 57344
    s_lshl_b32 s67, s66, 9
    s_add_u32 s93, s65, s67
    s_add_u32 s93, s93, 12288
    s_lshl_b32 s65, s56, 2
    s_add_u32 s64, s64, s65
    s_mul_i32 s66, s52, 14336
    s_add_u32 s66, s66, 16777216
    s_add_u32 s65, s52, 0
    s_and_b32 s65, s65, 3
    s_add_u32 s65, s65, s64
    s_mul_i32 s65, s65, 57344
    s_add_u32 s88, s65, s66
    s_add_u32 s65, s52, 1
    s_and_b32 s65, s65, 3
    s_add_u32 s65, s65, s64
    s_mul_i32 s65, s65, 57344
    s_add_u32 s89, s65, s66
    s_add_u32 s65, s52, 2
    s_and_b32 s65, s65, 3
    s_add_u32 s65, s65, s64
    s_mul_i32 s65, s65, 57344
    s_add_u32 s90, s65, s66
    s_add_u32 s65, s52, 3
    s_and_b32 s65, s65, 3
    s_add_u32 s65, s65, s64
    s_mul_i32 s65, s65, 57344
    s_add_u32 s91, s65, s66
    s_and_b32 s65, s57, 1
    s_lshl_b32 s65, s65, 1
    s_add_u32 s65, s65, s64
    s_lshr_b32 s66, s52, 1
    s_add_u32 s65, s65, s66
    s_mul_i32 s79, s65, 57344
    s_lshr_b32 s65, s57, 1
    s_mul_i32 s65, s65, 14336
    s_add_u32 s79, s79, s65
    s_add_u32 s79, s79, 16777216
    s_and_b32 s65, s52, 1
    s_lshl_b32 s66, s65, 11
    v_lshlrev_b32 v250, 7, v8
    v_and_b32 v251, 0x380, v250
    v_add_u32 v250, s66, v250
    s_lshl_b32 s66, s65, 10
    v_add_u32 v251, s66, v251
    s_mul_i32 s76, s55, 3
    s_lshl_b32 s76, s76, 8
    s_add_u32 s76, s76, 16512
    v_mov_b32 v244, s76
    v_add_u32 v245, 64, v244
    v_add_u32 v246, 256, v244
    v_add_u32 v248, 512, v244
    s_cmp_lg_u32 s52, 0
    s_cbranch_scc1 w062
    s_mov_b32 s84, 0
spin63:
    global_load_dword v6, v7, s[40:41] sc1
    s_add_u32 s84, s84, 1
    s_cmp_gt_u32 s84, 2000000
    s_cbranch_scc1 spun64
    s_waitcnt vmcnt(0)
    v_cmp_gt_u32 vcc, 16, v6
    s_cbranch_vccnz spin63
spun64:
    s_waitcnt vmcnt(0)
w062:
    s_barrier
    buffer_load_dwordx4 v[16:19], v1, s[8:11], s74 offen offset:0 sc1
    buffer_load_dwordx4 v[20:23], v1, s[8:11], s75 offen offset:0 sc1
    buffer_load_dwordx4 v[24:27], v1, s[8:11], s74 offen offset:1024 sc1
    buffer_load_dwordx4 v[28:31], v1, s[8:11], s75 offen offset:1024 sc1
    buffer_load_dwordx4 v[32:35], v1, s[8:11], s74 offen offset:2048 sc1
    buffer_load_dwordx4 v[36:39], v1, s[8:11], s75 offen offset:2048 sc1
    buffer_load_dwordx4 v[40:43], v1, s[8:11], s74 offen offset:3072 sc1
    s_add_u32 s74, s74, 4096
    buffer_load_dwordx4 v[44:47], v1, s[8:11], s75 offen offset:3072 sc1
    s_add_u32 s75, s75, 4096
    buffer_load_dwordx4 v[48:51], v1, s[8:11], s74 offen offset:0 sc1
    buffer_load_dwordx4 v[52:55], v1, s[8:11], s75 offen offset:0 sc1
    s_barrier
    ds_read_b128 a[220:223], v1 offset:0
    ds_read_b128 a[224:227], v1 offset:1024
    ds_read_b128 a[228:231], v1 offset:2048
    ds_read_b128 a[232:235], v1 offset:3072
    ds_read_b128 a[236:239], v1 offset:4096
    ds_read_b128 a[240:243], v1 offset:5120
    ds_read_b128 a[244:247], v1 offset:6144
    ds_read_b128 a[248:251], v1 offset:7168
    ds_read_b128 a[252:255], v1 offset:8192
    s_waitcnt vmcnt(8) lgkmcnt(5)
    v_mfma_f32_16x16x32_bf16 v[176:179], a[220:223], v[16:19], 0
    buffer_load_dwordx4 v[56:59], v1, s[8:11], s74 offen offset:1024 sc1
    v_mfma_f32_16x16x32_bf16 v[192:195], a[220:223], v[20:23], 0
    ds_read_b128 a[220:223], v1 offset:9216
    v_mfma_f32_16x16x32_bf16 v[184:187], a[224:227], v[16:19], 0
    v_mfma_f32_16x16x32_bf16 v[200:203], a[224:227], v[20:23], 0
    ds_read_b128 a[224:227], v1 offset:10240
    v_mfma_f32_16x16x32_bf16 v[180:183], a[228:231], v[16:19], 0
    buffer_load_dwordx4 v[60:63], v1, s[8:11], s75 offen offset:1024 sc1
    v_mfma_f32_16x16x32_bf16 v[196:199], a[228:231], v[20:23], 0
    ds_read_b128 a[228:231], v1 offset:11264
    v_mfma_f32_16x16x32_bf16 v[188:191], a[232:235], v[16:19], 0
    v_mfma_f32_16x16x32_bf16 v[204:207], a[232:235], v[20:23], 0
    ds_read_b128 a[232:235], v1 offset:12288
    s_waitcnt vmcnt(8) lgkmcnt(5)
    v_mfma_f32_16x16x32_bf16 v[176:179], a[236:239], v[24:27], v[176:179]
    buffer_load_dwordx4 v[64:67], v1, s[8:11], s74 offen offset:2048 sc1
    v_mfma_f32_16x16x32_bf16 v[192:195], a[236:239], v[28:31], v[192:195]
    ds_read_b128 a[236:239], v1 offset:13312
    s_add_u32 s77, s94, 0
    v_mfma_f32_16x16x32_bf16 v[184:187], a[240:243], v[24:27], v[184:187]
    buffer_load_dwordx4 a[0:3], v1, s[8:11], s77 offen offset:0 sc1
    v_mfma_f32_16x16x32_bf16 v[200:203], a[240:243], v[28:31], v[200:203]
    ds_read_b128 a[240:243], v1 offset:14336
    v_mfma_f32_16x16x32_bf16 v[180:183], a[244:247], v[24:27], v[180:183]
    buffer_load_dwordx4 v[68:71], v1, s[8:11], s75 offen offset:2048 sc1
    v_mfma_f32_16x16x32_bf16 v[196:199], a[244:247], v[28:31], v[196:199]
    ds_read_b128 a[244:247], v1 offset:15360
    v_mfma_f32_16x16x32_bf16 v[188:191], a[248:251], v[24:27], v[188:191]
    v_mfma_f32_16x16x32_bf16 v[204:207], a[248:251], v[28:31], v[204:207]
    ds_read_b128 a[248:251], v1 offset:16384
    s_waitcnt vmcnt(9) lgkmcnt(5)
    v_mfma_f32_16x16x32_bf16 v[176:179], a[252:255], v[32:35], v[176:179]
    buffer_load_dwordx4 v[72:75], v1, s[8:11], s74 offen offset:3072 sc1
    s_add_u32 s74, s74, 4096
    v_mfma_f32_16x16x32_bf16 v[192:195], a[252:255], v[36:39], v[192:195]
    ds_read_b128 a[252:255], v1 offset:17408
    v_mfma_f32_16x16x32_bf16 v[184:187], a[220:223], v[32:35], v[184:187]
    v_mfma_f32_16x16x32_bf16 v[200:203], a[220:223], v[36:39], v[200:203]
    ds_read_b128 a[220:223], v1 offset:18432
    buffer_load_dwordx4 a[4:7], v1, s[8:11], s77 offen offset:1024 sc1
    v_mfma_f32_16x16x32_bf16 v[180:183], a[224:227], v[32:35], v[180:183]
    buffer_load_dwordx4 v[76:79], v1, s[8:11], s75 offen offset:3072 sc1
    s_add_u32 s75, s75, 4096
    v_mfma_f32_16x16x32_bf16 v[196:199], a[224:227], v[36:39], v[196:199]
    ds_read_b128 a[224:227], v1 offset:19456
    v_mfma_f32_16x16x32_bf16 v[188:191], a[228:231], v[32:35], v[188:191]
    v_mfma_f32_16x16x32_bf16 v[204:207], a[228:231], v[36:39], v[204:207]
    ds_read_b128 a[228:231], v1 offset:20480
    s_waitcnt vmcnt(10) lgkmcnt(5)
    v_mfma_f32_16x16x32_bf16 v[176:179], a[232:235], v[40:43], v[176:179]
    buffer_load_dwordx4 v[80:83], v1, s[8:11], s74 offen offset:0 sc1
    v_mfma_f32_16x16x32_bf16 v[192:195], a[232:235], v[44:47], v[192:195]
    ds_read_b128 a[232:235], v1 offset:21504
    v_mfma_f32_16x16x32_bf16 v[184:187], a[236:239], v[40:43], v[184:187]
    v_mfma_f32_16x16x32_bf16 v[200:203], a[236:239], v[44:47], v[200:203]
    ds_read_b128 a[236:239], v1 offset:22528
    v_mfma_f32_16x16x32_bf16 v[180:183], a[240:243], v[40:43], v[180:183]
    buffer_load_dwordx4 v[84:87], v1, s[8:11], s75 offen offset:0 sc1
    v_mfma_f32_16x16x32_bf16 v[196:199], a[240:243], v[44:47], v[196:199]
    ds_read_b128 a[240:243], v1 offset:23552
    v_mfma_f32_16x16x32_bf16 v[188:191], a[244:247], v[40:43], v[188:191]
    buffer_load_dwordx4 a[8:11], v1, s[8:11], s77 offen offset:2048 sc1
    v_mfma_f32_16x16x32_bf16 v[204:207], a[244:247], v[44:47], v[204:207]
    ds_read_b128 a[244:247], v1 offset:24576
    s_waitcnt vmcnt(11) lgkmcnt(5)
    v_mfma_f32_16x16x32_bf16 v[176:179], a[248:251], v[48:51], v[176:179]
    buffer_load_dwordx4 v[88:91], v1, s[8:11], s74 offen offset:1024 sc1
    v_mfma_f32_16x16x32_bf16 v[192:195], a[248:251], v[52:55], v[192:195]
    ds_read_b128 a[248:251], v1 offset:25600
    v_mfma_f32_16x16x32_bf16 v[184:187], a[252:255], v[48:51], v[184:187]
    v_mfma_f32_16x16x32_bf16 v[200:203], a[252:255], v[52:55], v[200:203]
    ds_read_b128 a[252:255], v1 offset:26624
    v_mfma_f32_16x16x32_bf16 v[180:183], a[220:223], v[48:51], v[180:183]
    buffer_load_dwordx4 v[92:95], v1, s[8:11], s75 offen offset:1024 sc1
    v_mfma_f32_16x16x32_bf16 v[196:199], a[220:223], v[52:55], v[196:199]
    ds_read_b128 a[220:223], v1 offset:27648
    v_mfma_f32_16x16x32_bf16 v[188:191], a[224:227], v[48:51], v[188:191]
    v_mfma_f32_16x16x32_bf16 v[204:207], a[224:227], v[52:55], v[204:207]
    ds_read_b128 a[224:227], v1 offset:28672
    s_waitcnt vmcnt(11) lgkmcnt(5)
    v_mfma_f32_16x16x32_bf16 v[176:179], a[228:231], v[56:59], v[176:179]
    buffer_load_dwordx4 v[96:99], v1, s[8:11], s74 offen offset:2048 sc1
    v_mfma_f32_16x16x32_bf16 v[192:195], a[228:231], v[60:63], v[192:195]
    ds_read_b128 a[228:231], v1 offset:29696
    buffer_load_dwordx4 a[12:15], v1, s[8:11], s77 offen offset:3072 sc1
    v_mfma_f32_16x16x32_bf16 v[184:187], a[232:235], v[56:59], v[184:187]
    v_mfma_f32_16x16x32_bf16 v[200:203], a[232:235], v[60:63], v[200:203]
    ds_read_b128 a[232:235], v1 offset:30720
    v_mfma_f32_16x16x32_bf16 v[180:183], a[236:239], v[56:59], v[180:183]
    buffer_load_dwordx4 v[100:103], v1, s[8:11], s75 offen offset:2048 sc1
    v_mfma_f32_16x16x32_bf16 v[196:199], a[236:239], v[60:63], v[196:199]
    ds_read_b128 a[236:239], v1 offset:31744
    v_mfma_f32_16x16x32_bf16 v[188:191], a[240:243], v[56:59], v[188:191]
    v_mfma_f32_16x16x32_bf16 v[204:207], a[240:243], v[60:63], v[204:207]
    s_barrier
    ds_read_b128 a[240:243], v1 offset:32768
    s_waitcnt vmcnt(11) lgkmcnt(5)
    v_mfma_f32_16x16x32_bf16 v[176:179], a[244:247], v[64:67], v[176:179]
    buffer_load_dwordx4 v[104:107], v1, s[8:11], s74 offen offset:3072 sc1
    s_add_u32 s74, s74, 4096
    v_mfma_f32_16x16x32_bf16 v[192:195], a[244:247], v[68:71], v[192:195]
    ds_read_b128 a[244:247], v1 offset:33792
    v_mfma_f32_16x16x32_bf16 v[184:187], a[248:251], v[64:67], v[184:187]
    v_mfma_f32_16x16x32_bf16 v[200:203], a[248:251], v[68:71], v[200:203]
    ds_read_b128 a[248:251], v1 offset:34816
    s_add_u32 s77, s94, 4096
    v_mfma_f32_16x16x32_bf16 v[180:183], a[252:255], v[64:67], v[180:183]
    buffer_load_dwordx4 a[16:19], v1, s[8:11], s77 offen offset:0 sc1
    buffer_load_dwordx4 v[108:111], v1, s[8:11], s75 offen offset:3072 sc1
    v_mfma_f32_16x16x32_bf16 v[196:199], a[252:255], v[68:71], v[196:199]
    ds_read_b128 a[252:255], v1 offset:35840
    s_add_u32 s75, s75, 4096
    v_mfma_f32_16x16x32_bf16 v[188:191], a[220:223], v[64:67], v[188:191]
    v_mfma_f32_16x16x32_bf16 v[204:207], a[220:223], v[68:71], v[204:207]
    ds_read_b128 a[220:223], v1 offset:36864
    s_waitcnt vmcnt(11) lgkmcnt(5)
    v_mfma_f32_16x16x32_bf16 v[176:179], a[224:227], v[72:75], v[176:179]
    buffer_load_dwordx4 v[112:115], v1, s[8:11], s74 offen offset:0 sc1
    v_mfma_f32_16x16x32_bf16 v[192:195], a[224:227], v[76:79], v[192:195]
    ds_read_b128 a[224:227], v1 offset:37888
    v_mfma_f32_16x16x32_bf16 v[184:187], a[228:231], v[72:75], v[184:187]
    v_mfma_f32_16x16x32_bf16 v[200:203], a[228:231], v[76:79], v[200:203]
    ds_read_b128 a[228:231], v1 offset:38912
    v_mfma_f32_16x16x32_bf16 v[180:183], a[232:235], v[72:75], v[180:183]
    buffer_load_dwordx4 v[116:119], v1, s[8:11], s75 offen offset:0 sc1
    v_mfma_f32_16x16x32_bf16 v[196:199], a[232:235], v[76:79], v[196:199]
    ds_read_b128 a[232:235], v1 offset:39936
    v_mfma_f32_16x16x32_bf16 v[188:191], a[236:239], v[72:75], v[188:191]
    buffer_load_dwordx4 a[20:23], v1, s[8:11], s77 offen offset:1024 sc1
    v_mfma_f32_16x16x32_bf16 v[204:207], a[236:239], v[76:79], v[204:207]
    ds_read_b128 a[236:239], v1 offset:40960
    s_waitcnt vmcnt(12) lgkmcnt(5)
    v_mfma_f32_16x16x32_bf16 v[176:179], a[240:243], v[80:83], v[176:179]
    buffer_load_dwordx4 v[120:123], v1, s[8:11], s74 offen offset:1024 sc1
    v_mfma_f32_16x16x32_bf16 v[192:195], a[240:243], v[84:87], v[192:195]
    ds_read_b128 a[240:243], v1 offset:41984
    v_mfma_f32_16x16x32_bf16 v[184:187], a[244:247], v[80:83], v[184:187]
    v_mfma_f32_16x16x32_bf16 v[200:203], a[244:247], v[84:87], v[200:203]
    ds_read_b128 a[244:247], v1 offset:43008
    v_mfma_f32_16x16x32_bf16 v[180:183], a[248:251], v[80:83], v[180:183]
    buffer_load_dwordx4 v[124:127], v1, s[8:11], s75 offen offset:1024 sc1
    v_mfma_f32_16x16x32_bf16 v[196:199], a[248:251], v[84:87], v[196:199]
    ds_read_b128 a[248:251], v1 offset:44032
    v_mfma_f32_16x16x32_bf16 v[188:191], a[252:255], v[80:83], v[188:191]
    v_mfma_f32_16x16x32_bf16 v[204:207], a[252:255], v[84:87], v[204:207]
    ds_read_b128 a[252:255], v1 offset:45056
    s_waitcnt vmcnt(11) lgkmcnt(5)
    v_mfma_f32_16x16x32_bf16 v[176:179], a[220:223], v[88:91], v[176:179]
    buffer_load_dwordx4 v[128:131], v1, s[8:11], s74 offen offset:2048 sc1
    v_mfma_f32_16x16x32_bf16 v[192:195], a[220:223], v[92:95], v[192:195]
    ds_read_b128 a[220:223], v1 offset:46080
    buffer_load_dwordx4 a[24:27], v1, s[8:11], s77 offen offset:2048 sc1
    v_mfma_f32_16x16x32_bf16 v[184:187], a[224:227], v[88:91], v[184:187]
    v_mfma_f32_16x16x32_bf16 v[200:203], a[224:227], v[92:95], v[200:203]
    ds_read_b128 a[224:227], v1 offset:47104
    v_mfma_f32_16x16x32_bf16 v[180:183], a[228:231], v[88:91], v[180:183]
    buffer_load_dwordx4 v[132:135], v1, s[8:11], s75 offen offset:2048 sc1
    v_mfma_f32_16x16x32_bf16 v[196:199], a[228:231], v[92:95], v[196:199]
    ds_read_b128 a[228:231], v1 offset:48128
    v_mfma_f32_16x16x32_bf16 v[188:191], a[232:235], v[88:91], v[188:191]
    v_mfma_f32_16x16x32_bf16 v[204:207], a[232:235], v[92:95], v[204:207]
    ds_read_b128 a[232:235], v1 offset:49152
    s_waitcnt vmcnt(11) lgkmcnt(5)
    v_mfma_f32_16x16x32_bf16 v[176:179], a[236:239], v[96:99], v[176:179]
    buffer_load_dwordx4 v[136:139], v1, s[8:11], s74 offen offset:3072 sc1
    s_add_u32 s74, s74, 4096
    v_mfma_f32_16x16x32_bf16 v[192:195], a[236:239], v[100:103], v[192:195]
    ds_read_b128 a[236:239], v1 offset:50176
    v_mfma_f32_16x16x32_bf16 v[184:187], a[240:243], v[96:99], v[184:187]
    v_mfma_f32_16x16x32_bf16 v[200:203], a[240:243], v[100:103], v[200:203]
    ds_read_b128 a[240:243], v1 offset:51200
    v_mfma_f32_16x16x32_bf16 v[180:183], a[244:247], v[96:99], v[180:183]
    buffer_load_dwordx4 v[140:143], v1, s[8:11], s75 offen offset:3072 sc1
    s_add_u32 s75, s75, 4096
    v_mfma_f32_16x16x32_bf16 v[196:199], a[244:247], v[100:103], v[196:199]
    ds_read_b128 a[244:247], v1 offset:52224
    buffer_load_dwordx4 a[28:31], v1, s[8:11], s77 offen offset:3072 sc1
    v_mfma_f32_16x16x32_bf16 v[188:191], a[248:251], v[96:99], v[188:191]
    v_mfma_f32_16x16x32_bf16 v[204:207], a[248:251], v[100:103], v[204:207]
    ds_read_b128 a[248:251], v1 offset:53248
    s_waitcnt vmcnt(11) lgkmcnt(5)
    v_mfma_f32_16x16x32_bf16 v[176:179], a[252:255], v[104:107], v[176:179]
    buffer_load_dwordx4 v[144:147], v1, s[8:11], s74 offen offset:0 sc1
    v_mfma_f32_16x16x32_bf16 v[192:195], a[252:255], v[108:111], v[192:195]
    ds_read_b128 a[252:255], v1 offset:54272
    v_mfma_f32_16x16x32_bf16 v[184:187], a[220:223], v[104:107], v[184:187]
    v_mfma_f32_16x16x32_bf16 v[200:203], a[220:223], v[108:111], v[200:203]
    ds_read_b128 a[220:223], v1 offset:55296
    v_mfma_f32_16x16x32_bf16 v[180:183], a[224:227], v[104:107], v[180:183]
    buffer_load_dwordx4 v[148:151], v1, s[8:11], s75 offen offset:0 sc1
    v_mfma_f32_16x16x32_bf16 v[196:199], a[224:227], v[108:111], v[196:199]
    ds_read_b128 a[224:227], v1 offset:56320
    v_mfma_f32_16x16x32_bf16 v[188:191], a[228:231], v[104:107], v[188:191]
    s_add_u32 s77, s94, 8192
    buffer_load_dwordx4 a[32:35], v1, s[8:11], s77 offen offset:0 sc1
    v_mfma_f32_16x16x32_bf16 v[204:207], a[228:231], v[108:111], v[204:207]
    ds_read_b128 a[228:231], v1 offset:57344
    s_waitcnt vmcnt(12) lgkmcnt(5)
    v_mfma_f32_16x16x32_bf16 v[176:179], a[232:235], v[112:115], v[176:179]
    buffer_load_dwordx4 v[152:155], v1, s[8:11], s74 offen offset:1024 sc1
    v_mfma_f32_16x16x32_bf16 v[192:195], a[232:235], v[116:119], v[192:195]
    ds_read_b128 a[232:235], v1 offset:58368
    v_mfma_f32_16x16x32_bf16 v[184:187], a[236:239], v[112:115], v[184:187]
    v_mfma_f32_16x16x32_bf16 v[200:203], a[236:239], v[116:119], v[200:203]
    ds_read_b128 a[236:239], v1 offset:59392
    v_mfma_f32_16x16x32_bf16 v[180:183], a[240:243], v[112:115], v[180:183]
    buffer_load_dwordx4 v[156:159], v1, s[8:11], s75 offen offset:1024 sc1
    v_mfma_f32_16x16x32_bf16 v[196:199], a[240:243], v[116:119], v[196:199]
    ds_read_b128 a[240:243], v1 offset:60416
    v_mfma_f32_16x16x32_bf16 v[188:191], a[244:247], v[112:115], v[188:191]
    v_mfma_f32_16x16x32_bf16 v[204:207], a[244:247], v[116:119], v[204:207]
    ds_read_b128 a[244:247], v1 offset:61440
    s_waitcnt vmcnt(11) lgkmcnt(5)
    v_mfma_f32_16x16x32_bf16 v[176:179], a[248:251], v[120:123], v[176:179]
    buffer_load_dwordx4 v[160:163], v1, s[8:11], s74 offen offset:2048 sc1
    v_mfma_f32_16x16x32_bf16 v[192:195], a[248:251], v[124:127], v[192:195]
    ds_read_b128 a[248:251], v1 offset:62464
    buffer_load_dwordx4 a[36:39], v1, s[8:11], s77 offen offset:1024 sc1
    v_mfma_f32_16x16x32_bf16 v[184:187], a[252:255], v[120:123], v[184:187]
    v_mfma_f32_16x16x32_bf16 v[200:203], a[252:255], v[124:127], v[200:203]
    ds_read_b128 a[252:255], v1 offset:63488
    v_mfma_f32_16x16x32_bf16 v[180:183], a[220:223], v[120:123], v[180:183]
    buffer_load_dwordx4 v[164:167], v1, s[8:11], s75 offen offset:2048 sc1
    v_mfma_f32_16x16x32_bf16 v[196:199], a[220:223], v[124:127], v[196:199]
    ds_read_b128 a[220:223], v1 offset:64512
    v_mfma_f32_16x16x32_bf16 v[188:191], a[224:227], v[120:123], v[188:191]
    v_mfma_f32_16x16x32_bf16 v[204:207], a[224:227], v[124:127], v[204:207]
    s_barrier
    ds_read_b128 a[224:227], v2 offset:0
    s_waitcnt vmcnt(11) lgkmcnt(5)
    v_mfma_f32_16x16x32_bf16 v[176:179], a[228:231], v[128:131], v[176:179]
    buffer_load_dwordx4 v[168:171], v1, s[8:11], s74 offen offset:3072 sc1
    v_mfma_f32_16x16x32_bf16 v[192:195], a[228:231], v[132:135], v[192:195]
    ds_read_b128 a[228:231], v2 offset:1024
    v_mfma_f32_16x16x32_bf16 v[184:187], a[232:235], v[128:131], v[184:187]
    v_mfma_f32_16x16x32_bf16 v[200:203], a[232:235], v[132:135], v[200:203]
    ds_read_b128 a[232:235], v2 offset:2048
    v_mfma_f32_16x16x32_bf16 v[180:183], a[236:239], v[128:131], v[180:183]
    buffer_load_dwordx4 v[172:175], v1, s[8:11], s75 offen offset:3072 sc1
    buffer_load_dwordx4 a[40:43], v1, s[8:11], s77 offen offset:2048 sc1
    v_mfma_f32_16x16x32_bf16 v[196:199], a[236:239], v[132:135], v[196:199]
    ds_read_b128 a[236:239], v2 offset:3072
    v_mfma_f32_16x16x32_bf16 v[188:191], a[240:243], v[128:131], v[188:191]
    v_mfma_f32_16x16x32_bf16 v[204:207], a[240:243], v[132:135], v[204:207]
    ds_read_b128 a[240:243], v2 offset:4096
    s_waitcnt vmcnt(12) lgkmcnt(5)
    v_mfma_f32_16x16x32_bf16 v[176:179], a[244:247], v[136:139], v[176:179]
    v_mfma_f32_16x16x32_bf16 v[192:195], a[244:247], v[140:143], v[192:195]
    ds_read_b128 a[244:247], v2 offset:5120
    v_mfma_f32_16x16x32_bf16 v[184:187], a[248:251], v[136:139], v[184:187]
    s_add_u32 s86, s85, 131072
    s_add_u32 m0, s87, 0
    v_mfma_f32_16x16x32_bf16 v[200:203], a[248:251], v[140:143], v[200:203]
    ds_read_b128 a[248:251], v2 offset:6144
    v_mfma_f32_16x16x32_bf16 v[180:183], a[252:255], v[136:139], v[180:183]
    buffer_load_dwordx4 v1, s[8:11], s86 offen offset:0 sc1 lds
    v_mfma_f32_16x16x32_bf16 v[196:199], a[252:255], v[140:143], v[196:199]
    ds_read_b128 a[252:255], v2 offset:7168
    v_mfma_f32_16x16x32_bf16 v[188:191], a[220:223], v[136:139], v[188:191]
    v_mfma_f32_16x16x32_bf16 v[204:207], a[220:223], v[140:143], v[204:207]
    ds_read_b128 a[220:223], v2 offset:8192
    s_waitcnt vmcnt(10) lgkmcnt(5)
    v_mfma_f32_16x16x32_bf16 v[176:179], a[224:227], v[144:147], v[176:179]
    buffer_load_dwordx4 a[44:47], v1, s[8:11], s77 offen offset:3072 sc1
    v_mfma_f32_16x16x32_bf16 v[192:195], a[224:227], v[148:151], v[192:195]
    ds_read_b128 a[224:227], v2 offset:9216
    v_mfma_f32_16x16x32_bf16 v[184:187], a[228:231], v[144:147], v[184:187]
    v_mfma_f32_16x16x32_bf16 v[200:203], a[228:231], v[148:151], v[200:203]
    ds_read_b128 a[228:231], v2 offset:10240
    buffer_load_dwordx4 v1, s[8:11], s86 offen offset:1024 sc1 lds
    v_mfma_f32_16x16x32_bf16 v[180:183], a[232:235], v[144:147], v[180:183]
    v_mfma_f32_16x16x32_bf16 v[196:199], a[232:235], v[148:151], v[196:199]
    ds_read_b128 a[232:235], v2 offset:11264
    v_mfma_f32_16x16x32_bf16 v[188:191], a[236:239], v[144:147], v[188:191]
    v_mfma_f32_16x16x32_bf16 v[204:207], a[236:239], v[148:151], v[204:207]
    ds_read_b128 a[236:239], v2 offset:12288
    s_waitcnt vmcnt(9) lgkmcnt(5)
    v_mfma_f32_16x16x32_bf16 v[176:179], a[240:243], v[152:155], v[176:179]
    v_mfma_f32_16x16x32_bf16 v[192:195], a[240:243], v[156:159], v[192:195]
    ds_read_b128 a[240:243], v2 offset:13312
    s_add_u32 s77, s94, 12288
    v_mfma_f32_16x16x32_bf16 v[184:187], a[244:247], v[152:155], v[184:187]
    buffer_load_dwordx4 a[48:51], v1, s[8:11], s77 offen offset:0 sc1
    buffer_load_dwordx4 v1, s[8:11], s86 offen offset:2048 sc1 lds
    v_mfma_f32_16x16x32_bf16 v[200:203], a[244:247], v[156:159], v[200:203]
    ds_read_b128 a[244:247], v2 offset:14336
    v_mfma_f32_16x16x32_bf16 v[180:183], a[248:251], v[152:155], v[180:183]
    v_mfma_f32_16x16x32_bf16 v[196:199], a[248:251], v[156:159], v[196:199]
    ds_read_b128 a[248:251], v2 offset:15360
    v_mfma_f32_16x16x32_bf16 v[188:191], a[252:255], v[152:155], v[188:191]
    v_mfma_f32_16x16x32_bf16 v[204:207], a[252:255], v[156:159], v[204:207]
    ds_read_b128 a[252:255], v2 offset:16384
    s_waitcnt vmcnt(8) lgkmcnt(5)
    v_mfma_f32_16x16x32_bf16 v[176:179], a[220:223], v[160:163], v[176:179]
    v_mfma_f32_16x16x32_bf16 v[192:195], a[220:223], v[164:167], v[192:195]
    ds_read_b128 a[220:223], v2 offset:17408
    buffer_load_dwordx4 v1, s[8:11], s86 offen offset:3072 sc1 lds
    v_mfma_f32_16x16x32_bf16 v[184:187], a[224:227], v[160:163], v[184:187]
    v_mfma_f32_16x16x32_bf16 v[200:203], a[224:227], v[164:167], v[200:203]
    ds_read_b128 a[224:227], v2 offset:18432
    v_mfma_f32_16x16x32_bf16 v[180:183], a[228:231], v[160:163], v[180:183]
    buffer_load_dwordx4 a[52:55], v1, s[8:11], s77 offen offset:1024 sc1
    v_mfma_f32_16x16x32_bf16 v[196:199], a[228:231], v[164:167], v[196:199]
    ds_read_b128 a[228:231], v2 offset:19456
    v_mfma_f32_16x16x32_bf16 v[188:191], a[232:235], v[160:163], v[188:191]
    s_add_u32 s86, s85, 147456
    s_add_u32 m0, s87, 16384
    v_mfma_f32_16x16x32_bf16 v[204:207], a[232:235], v[164:167], v[204:207]
    ds_read_b128 a[232:235], v2 offset:20480
    s_waitcnt vmcnt(8) lgkmcnt(5)
    v_mfma_f32_16x16x32_bf16 v[176:179], a[236:239], v[168:171], v[176:179]
    buffer_load_dwordx4 v1, s[8:11], s86 offen offset:0 sc1 lds
    v_mfma_f32_16x16x32_bf16 v[192:195], a[236:239], v[172:175], v[192:195]
    ds_read_b128 a[236:239], v2 offset:21504
    v_mfma_f32_16x16x32_bf16 v[184:187], a[240:243], v[168:171], v[184:187]
    v_mfma_f32_16x16x32_bf16 v[200:203], a[240:243], v[172:175], v[200:203]
    ds_read_b128 a[240:243], v2 offset:22528
    v_mfma_f32_16x16x32_bf16 v[180:183], a[244:247], v[168:171], v[180:183]
    v_mfma_f32_16x16x32_bf16 v[196:199], a[244:247], v[172:175], v[196:199]
    ds_read_b128 a[244:247], v2 offset:23552
    v_mfma_f32_16x16x32_bf16 v[188:191], a[248:251], v[168:171], v[188:191]
    v_mfma_f32_16x16x32_bf16 v[204:207], a[248:251], v[172:175], v[204:207]
    ds_read_b128 a[248:251], v2 offset:24576
    s_waitcnt lgkmcnt(5)
    v_mfma_f32_16x16x32_bf16 v[208:211], a[252:255], v[16:19], 0
    buffer_load_dwordx4 a[56:59], v1, s[8:11], s77 offen offset:2048 sc1
    buffer_load_dwordx4 v1, s[8:11], s86 offen offset:1024 sc1 lds
    v_mfma_f32_16x16x32_bf16 v[224:227], a[252:255], v[20:23], 0
    ds_read_b128 a[252:255], v2 offset:25600
    v_mfma_f32_16x16x32_bf16 v[216:219], a[220:223], v[16:19], 0
    v_mfma_f32_16x16x32_bf16 v[232:235], a[220:223], v[20:23], 0
    ds_read_b128 a[220:223], v2 offset:26624
    v_fma_f32 v8, v176, v176, v4
    v_mfma_f32_16x16x32_bf16 v[212:215], a[224:227], v[16:19], 0
    v_mul_f32 v184, v176, v184
    v_mul_f32_e64 v176, -v176, v8
    v_mfma_f32_16x16x32_bf16 v[228:231], a[224:227], v[20:23], 0
    ds_read_b128 a[224:227], v2 offset:27648
    v_fma_f32 v9, v177, v177, v4
    v_mfma_f32_16x16x32_bf16 v[220:223], a[228:231], v[16:19], 0
    buffer_load_dwordx4 v1, s[8:11], s86 offen offset:2048 sc1 lds
    v_mul_f32 v185, v177, v185
    v_mfma_f32_16x16x32_bf16 v[236:239], a[228:231], v[20:23], 0
    ds_read_b128 a[228:231], v2 offset:28672
    s_waitcnt lgkmcnt(5)
    v_mfma_f32_16x16x32_bf16 v[208:211], a[232:235], v[24:27], v[208:211]
    v_exp_f32 v176, v176
    v_mfma_f32_16x16x32_bf16 v[224:227], a[232:235], v[28:31], v[224:227]
    ds_read_b128 a[232:235], v2 offset:29696
    buffer_load_dwordx4 a[60:63], v1, s[8:11], s77 offen offset:3072 sc1
    v_mfma_f32_16x16x32_bf16 v[216:219], a[236:239], v[24:27], v[216:219]
    v_add_f32 v176, 1.0, v176
    v_mul_f32_e64 v177, -v177, v9
    v_mfma_f32_16x16x32_bf16 v[232:235], a[236:239], v[28:31], v[232:235]
    ds_read_b128 a[236:239], v2 offset:30720
    v_fma_f32 v10, v178, v178, v4
    v_mfma_f32_16x16x32_bf16 v[212:215], a[240:243], v[24:27], v[212:215]
    v_rcp_f32 v176, v176
    v_mfma_f32_16x16x32_bf16 v[228:231], a[240:243], v[28:31], v[228:231]
    ds_read_b128 a[240:243], v2 offset:31744
    buffer_load_dwordx4 v1, s[8:11], s86 offen offset:3072 sc1 lds
    v_mfma_f32_16x16x32_bf16 v[220:223], a[244:247], v[24:27], v[220:223]
    v_mul_f32 v184, v184, v176
    v_mul_f32 v186, v178, v186
    v_mfma_f32_16x16x32_bf16 v[236:239], a[244:247], v[28:31], v[236:239]
    s_barrier
    ds_read_b128 a[244:247], v2 offset:32768
    s_waitcnt lgkmcnt(5)
    v_mfma_f32_16x16x32_bf16 v[208:211], a[248:251], v[32:35], v[208:211]
    v_exp_f32 v177, v177
    v_mfma_f32_16x16x32_bf16 v[224:227], a[248:251], v[36:39], v[224:227]
    ds_read_b128 a[248:251], v2 offset:33792
    v_add_f32 v177, 1.0, v177
    v_mfma_f32_16x16x32_bf16 v[216:219], a[252:255], v[32:35], v[216:219]
    s_add_u32 s86, s85, 163840
    s_add_u32 m0, s87, 32768
    v_mfma_f32_16x16x32_bf16 v[232:235], a[252:255], v[36:39], v[232:235]
    ds_read_b128 a[252:255], v2 offset:34816
    v_mul_f32_e64 v178, -v178, v10
    v_mfma_f32_16x16x32_bf16 v[212:215], a[220:223], v[32:35], v[212:215]
    s_add_u32 s77, s94, 16384
    buffer_load_dwordx4 a[64:67], v1, s[8:11], s77 offen offset:0 sc1
    v_mfma_f32_16x16x32_bf16 v[228:231], a[220:223], v[36:39], v[228:231]
    ds_read_b128 a[220:223], v2 offset:35840
    buffer_load_dwordx4 v1, s[8:11], s86 offen offset:0 sc1 lds
    v_mfma_f32_16x16x32_bf16 v[220:223], a[224:227], v[32:35], v[220:223]
    v_rcp_f32 v177, v177
    v_mfma_f32_16x16x32_bf16 v[236:239], a[224:227], v[36:39], v[236:239]
    ds_read_b128 a[224:227], v2 offset:36864
    s_waitcnt lgkmcnt(5)
    v_mfma_f32_16x16x32_bf16 v[208:211], a[228:231], v[40:43], v[208:211]
    v_mul_f32 v185, v185, v177
    v_cvt_pk_bf16_f32 v12, v184, v185
    v_mfma_f32_16x16x32_bf16 v[224:227], a[228:231], v[44:47], v[224:227]
    ds_read_b128 a[228:231], v2 offset:37888
    v_fma_f32 v11, v179, v179, v4
    v_mfma_f32_16x16x32_bf16 v[216:219], a[232:235], v[40:43], v[216:219]
    v_exp_f32 v178, v178
    v_mfma_f32_16x16x32_bf16 v[232:235], a[232:235], v[44:47], v[232:235]
    ds_read_b128 a[232:235], v2 offset:38912
    buffer_load_dwordx4 v1, s[8:11], s86 offen offset:1024 sc1 lds
    v_mfma_f32_16x16x32_bf16 v[212:215], a[236:239], v[40:43], v[212:215]
    v_add_f32 v178, 1.0, v178
    v_mul_f32 v187, v179, v187
    v_mfma_f32_16x16x32_bf16 v[228:231], a[236:239], v[44:47], v[228:231]
    ds_read_b128 a[236:239], v2 offset:39936
    v_mul_f32_e64 v179, -v179, v11
    s_branch L_past4
L_page4:
    s_setpc_b64 s[98:99]
L_past4:
    v_mfma_f32_16x16x32_bf16 v[220:223], a[240:243], v[40:43], v[220:223]
    v_rcp_f32 v178, v178
    v_mfma_f32_16x16x32_bf16 v[236:239], a[240:243], v[44:47], v[236:239]
    ds_read_b128 a[240:243], v2 offset:40960
    s_waitcnt lgkmcnt(5)
    v_mfma_f32_16x16x32_bf16 v[208:211], a[244:247], v[48:51], v[208:211]
    buffer_load_dwordx4 a[68:71], v1, s[8:11], s77 offen offset:1024 sc1
    v_mul_f32 v186, v186, v178
    v_mfma_f32_16x16x32_bf16 v[224:227], a[244:247], v[52:55], v[224:227]
    ds_read_b128 a[244:247], v2 offset:41984
    v_fma_f32 v8, v180, v180, v4
    v_mfma_f32_16x16x32_bf16 v[216:219], a[248:251], v[48:51], v[216:219]
    buffer_load_dwordx4 v1, s[8:11], s86 offen offset:2048 sc1 lds
    v_mul_f32 v188, v180, v188
    v_mfma_f32_16x16x32_bf16 v[232:235], a[248:251], v[52:55], v[232:235]
    ds_read_b128 a[248:251], v2 offset:43008
    v_mul_f32_e64 v180, -v180, v8
    v_mfma_f32_16x16x32_bf16 v[212:215], a[252:255], v[48:51], v[212:215]
    v_exp_f32 v179, v179
    v_mfma_f32_16x16x32_bf16 v[228:231], a[252:255], v[52:55], v[228:231]
    ds_read_b128 a[252:255], v2 offset:44032
    v_add_f32 v179, 1.0, v179
    v_mfma_f32_16x16x32_bf16 v[220:223], a[220:223], v[48:51], v[220:223]
    v_rcp_f32 v179, v179
    v_mfma_f32_16x16x32_bf16 v[236:239], a[220:223], v[52:55], v[236:239]
    ds_read_b128 a[220:223], v2 offset:45056
    s_waitcnt lgkmcnt(5)
    v_mfma_f32_16x16x32_bf16 v[208:211], a[224:227], v[56:59], v[208:211]
    v_mul_f32 v187, v187, v179
    v_cvt_pk_bf16_f32 v13, v186, v187
    v_mfma_f32_16x16x32_bf16 v[224:227], a[224:227], v[60:63], v[224:227]
    ds_read_b128 a[224:227], v2 offset:46080
    buffer_load_dwordx4 v1, s[8:11], s86 offen offset:3072 sc1 lds
    v_mfma_f32_16x16x32_bf16 v[216:219], a[228:231], v[56:59], v[216:219]
    buffer_load_dwordx4 a[72:75], v1, s[8:11], s77 offen offset:2048 sc1
    v_fma_f32 v9, v181, v181, v4
    v_mfma_f32_16x16x32_bf16 v[232:235], a[228:231], v[60:63], v[232:235]
    ds_read_b128 a[228:231], v2 offset:47104
    v_mul_f32 v189, v181, v189
    v_mfma_f32_16x16x32_bf16 v[212:215], a[232:235], v[56:59], v[212:215]
    v_exp_f32 v180, v180
    v_mfma_f32_16x16x32_bf16 v[228:231], a[232:235], v[60:63], v[228:231]
    ds_read_b128 a[232:235], v2 offset:48128
    v_add_f32 v180, 1.0, v180
    v_mfma_f32_16x16x32_bf16 v[220:223], a[236:239], v[56:59], v[220:223]
    s_add_u32 s86, s85, 180224
    s_add_u32 m0, s87, 49152
    v_mfma_f32_16x16x32_bf16 v[236:239], a[236:239], v[60:63], v[236:239]
    ds_read_b128 a[236:239], v2 offset:49152
    s_waitcnt lgkmcnt(5)
    v_mfma_f32_16x16x32_bf16 v[208:211], a[240:243], v[64:67], v[208:211]
    buffer_load_dwordx4 v1, s[8:11], s86 offen offset:0 sc1 lds
    v_mul_f32_e64 v181, -v181, v9
    v_mfma_f32_16x16x32_bf16 v[224:227], a[240:243], v[68:71], v[224:227]
    ds_read_b128 a[240:243], v2 offset:50176
    v_fma_f32 v10, v182, v182, v4
    v_mfma_f32_16x16x32_bf16 v[216:219], a[244:247], v[64:67], v[216:219]
    v_rcp_f32 v180, v180
    v_mfma_f32_16x16x32_bf16 v[232:235], a[244:247], v[68:71], v[232:235]
    ds_read_b128 a[244:247], v2 offset:51200
    v_mul_f32 v188, v188, v180
    v_mfma_f32_16x16x32_bf16 v[212:215], a[248:251], v[64:67], v[212:215]
    buffer_load_dwordx4 a[76:79], v1, s[8:11], s77 offen offset:3072 sc1
    v_mul_f32 v190, v182, v190
    v_mfma_f32_16x16x32_bf16 v[228:231], a[248:251], v[68:71], v[228:231]
    ds_read_b128 a[248:251], v2 offset:52224
    v_mul_f32_e64 v182, -v182, v10
    v_mfma_f32_16x16x32_bf16 v[220:223], a[252:255], v[64:67], v[220:223]
    v_exp_f32 v181, v181
    v_mfma_f32_16x16x32_bf16 v[236:239], a[252:255], v[68:71], v[236:239]
    ds_read_b128 a[252:255], v2 offset:53248
    s_waitcnt lgkmcnt(5)
    v_mfma_f32_16x16x32_bf16 v[208:211], a[220:223], v[72:75], v[208:211]
    buffer_load_dwordx4 v1, s[8:11], s86 offen offset:1024 sc1 lds
    v_add_f32 v181, 1.0, v181
    v_mfma_f32_16x16x32_bf16 v[224:227], a[220:223], v[76:79], v[224:227]
    ds_read_b128 a[220:223], v2 offset:54272
    v_fma_f32 v11, v183, v183, v4
    v_mfma_f32_16x16x32_bf16 v[216:219], a[224:227], v[72:75], v[216:219]
    v_rcp_f32 v181, v181
    v_mfma_f32_16x16x32_bf16 v[232:235], a[224:227], v[76:79], v[232:235]
    ds_read_b128 a[224:227], v2 offset:55296
    v_mul_f32 v189, v189, v181
    v_mfma_f32_16x16x32_bf16 v[212:215], a[228:231], v[72:75], v[212:215]
    v_cvt_pk_bf16_f32 v14, v188, v189
    v_mul_f32 v191, v183, v191
    v_mfma_f32_16x16x32_bf16 v[228:231], a[228:231], v[76:79], v[228:231]
    ds_read_b128 a[228:231], v2 offset:56320
    v_mul_f32_e64 v183, -v183, v11
    v_mfma_f32_16x16x32_bf16 v[220:223], a[232:235], v[72:75], v[220:223]
    buffer_load_dwordx4 v1, s[8:11], s86 offen offset:2048 sc1 lds
    v_fma_f32 v8, v192, v192, v4
    v_mfma_f32_16x16x32_bf16 v[236:239], a[232:235], v[76:79], v[236:239]
    ds_read_b128 a[232:235], v2 offset:57344
    s_waitcnt lgkmcnt(5)
    v_mfma_f32_16x16x32_bf16 v[208:211], a[236:239], v[80:83], v[208:211]
    s_add_u32 s77, s94, 20480
    buffer_load_dwordx4 a[80:83], v1, s[8:11], s77 offen offset:0 sc1
    v_mfma_f32_16x16x32_bf16 v[224:227], a[236:239], v[84:87], v[224:227]
    ds_read_b128 a[236:239], v2 offset:58368
    v_mul_f32 v200, v192, v200
    v_mfma_f32_16x16x32_bf16 v[216:219], a[240:243], v[80:83], v[216:219]
    v_exp_f32 v182, v182
    v_mfma_f32_16x16x32_bf16 v[232:235], a[240:243], v[84:87], v[232:235]
    ds_read_b128 a[240:243], v2 offset:59392
    v_add_f32 v182, 1.0, v182
    v_mfma_f32_16x16x32_bf16 v[212:215], a[244:247], v[80:83], v[212:215]
    v_rcp_f32 v182, v182
    v_mfma_f32_16x16x32_bf16 v[228:231], a[244:247], v[84:87], v[228:231]
    ds_read_b128 a[244:247], v2 offset:60416
    buffer_load_dwordx4 v1, s[8:11], s86 offen offset:3072 sc1 lds
    v_mfma_f32_16x16x32_bf16 v[220:223], a[248:251], v[80:83], v[220:223]
    v_mul_f32 v190, v190, v182
    v_mul_f32_e64 v192, -v192, v8
    v_mfma_f32_16x16x32_bf16 v[236:239], a[248:251], v[84:87], v[236:239]
    ds_read_b128 a[248:251], v2 offset:61440
    s_waitcnt lgkmcnt(5)
    v_mfma_f32_16x16x32_bf16 v[208:211], a[252:255], v[88:91], v[208:211]
    v_exp_f32 v183, v183
    v_mfma_f32_16x16x32_bf16 v[224:227], a[252:255], v[92:95], v[224:227]
    ds_read_b128 a[252:255], v2 offset:62464
    v_add_f32 v183, 1.0, v183
    v_mfma_f32_16x16x32_bf16 v[216:219], a[220:223], v[88:91], v[216:219]
    buffer_load_dwordx4 a[84:87], v1, s[8:11], s77 offen offset:1024 sc1
    v_fma_f32 v9, v193, v193, v4
    v_mfma_f32_16x16x32_bf16 v[232:235], a[220:223], v[92:95], v[232:235]
    ds_read_b128 a[220:223], v2 offset:63488
    v_mul_f32 v201, v193, v201
    v_mfma_f32_16x16x32_bf16 v[212:215], a[224:227], v[88:91], v[212:215]
    v_rcp_f32 v183, v183
    v_mfma_f32_16x16x32_bf16 v[228:231], a[224:227], v[92:95], v[228:231]
    ds_read_b128 a[224:227], v2 offset:64512
    v_mul_f32 v191, v191, v183
    v_mfma_f32_16x16x32_bf16 v[220:223], a[228:231], v[88:91], v[220:223]
    v_cvt_pk_bf16_f32 v15, v190, v191
    v_mul_f32_e64 v193, -v193, v9
    v_mfma_f32_16x16x32_bf16 v[236:239], a[228:231], v[92:95], v[236:239]
    s_waitcnt vmcnt(14)
    s_barrier
    ds_read_b128 a[228:231], v1 offset:0
    s_waitcnt lgkmcnt(5)
    v_mfma_f32_16x16x32_bf16 v[208:211], a[232:235], v[96:99], v[208:211]
    s_add_u32 s86, s85, 196608
    s_add_u32 m0, s87, 65536
    v_mfma_f32_16x16x32_bf16 v[224:227], a[232:235], v[100:103], v[224:227]
    ds_read_b128 a[232:235], v1 offset:1024
    buffer_store_dwordx4 v[12:15], v1, s[8:11], s92 offen sc1
    v_mfma_f32_16x16x32_bf16 v[216:219], a[236:239], v[96:99], v[216:219]
    buffer_load_dwordx4 v1, s[8:11], s86 offen offset:0 sc1 lds
    v_fma_f32 v10, v194, v194, v4
    v_mfma_f32_16x16x32_bf16 v[232:235], a[236:239], v[100:103], v[232:235]
    ds_read_b128 a[236:239], v1 offset:2048
    v_mul_f32 v202, v194, v202
    v_mfma_f32_16x16x32_bf16 v[212:215], a[240:243], v[96:99], v[212:215]
    v_exp_f32 v192, v192
    v_mfma_f32_16x16x32_bf16 v[228:231], a[240:243], v[100:103], v[228:231]
    ds_read_b128 a[240:243], v1 offset:3072
    buffer_load_dwordx4 a[88:91], v1, s[8:11], s77 offen offset:2048 sc1
    v_mfma_f32_16x16x32_bf16 v[220:223], a[244:247], v[96:99], v[220:223]
    v_add_f32 v192, 1.0, v192
    v_mul_f32_e64 v194, -v194, v10
    v_mfma_f32_16x16x32_bf16 v[236:239], a[244:247], v[100:103], v[236:239]
    ds_read_b128 a[244:247], v1 offset:4096
    s_waitcnt lgkmcnt(5)
    v_mfma_f32_16x16x32_bf16 v[208:211], a[248:251], v[104:107], v[208:211]
    v_rcp_f32 v192, v192
    v_mfma_f32_16x16x32_bf16 v[224:227], a[248:251], v[108:111], v[224:227]
    ds_read_b128 a[248:251], v1 offset:5120
    buffer_load_dwordx4 v1, s[8:11], s86 offen offset:1024 sc1 lds
    v_mfma_f32_16x16x32_bf16 v[216:219], a[252:255], v[104:107], v[216:219]
    v_mul_f32 v200, v200, v192
    v_fma_f32 v11, v195, v195, v4
    v_mfma_f32_16x16x32_bf16 v[232:235], a[252:255], v[108:111], v[232:235]
    ds_read_b128 a[252:255], v1 offset:6144
    v_mul_f32 v203, v195, v203
    v_mfma_f32_16x16x32_bf16 v[212:215], a[220:223], v[104:107], v[212:215]
    v_exp_f32 v193, v193
    v_mfma_f32_16x16x32_bf16 v[228:231], a[220:223], v[108:111], v[228:231]
    ds_read_b128 a[220:223], v1 offset:7168
    v_add_f32 v193, 1.0, v193
    v_mfma_f32_16x16x32_bf16 v[220:223], a[224:227], v[104:107], v[220:223]
    v_rcp_f32 v193, v193
    v_mfma_f32_16x16x32_bf16 v[236:239], a[224:227], v[108:111], v[236:239]
    ds_read_b128 a[224:227], v1 offset:8192
    s_waitcnt lgkmcnt(5)
    v_mfma_f32_16x16x32_bf16 v[208:211], a[228:231], v[112:115], v[208:211]
    buffer_load_dwordx4 a[92:95], v1, s[8:11], s77 offen offset:3072 sc1
    buffer_load_dwordx4 v1, s[8:11], s86 offen offset:2048 sc1 lds
    v_mfma_f32_16x16x32_bf16 v[224:227], a[228:231], v[116:119], v[224:227]
    ds_read_b128 a[228:231], v1 offset:9216
    v_mul_f32 v201, v201, v193
    v_mfma_f32_16x16x32_bf16 v[216:219], a[232:235], v[112:115], v[216:219]
    v_cvt_pk_bf16_f32 v240, v200, v201
    v_mul_f32_e64 v195, -v195, v11
    v_mfma_f32_16x16x32_bf16 v[232:235], a[232:235], v[116:119], v[232:235]
    ds_read_b128 a[232:235], v1 offset:10240
    v_fma_f32 v8, v196, v196, v4
    v_mfma_f32_16x16x32_bf16 v[212:215], a[236:239], v[112:115], v[212:215]
    v_exp_f32 v194, v194
    v_mfma_f32_16x16x32_bf16 v[228:231], a[236:239], v[116:119], v[228:231]
    ds_read_b128 a[236:239], v1 offset:11264
    v_add_f32 v194, 1.0, v194
    v_mfma_f32_16x16x32_bf16 v[220:223], a[240:243], v[112:115], v[220:223]
    v_rcp_f32 v194, v194
    v_mfma_f32_16x16x32_bf16 v[236:239], a[240:243], v[116:119], v[236:239]
    ds_read_b128 a[240:243], v1 offset:12288
    s_waitcnt lgkmcnt(5)
    v_mfma_f32_16x16x32_bf16 v[208:211], a[244:247], v[120:123], v[208:211]
    buffer_load_dwordx4 v1, s[8:11], s86 offen offset:3072 sc1 lds
    v_mul_f32 v202, v202, v194
    v_mfma_f32_16x16x32_bf16 v[224:227], a[244:247], v[124:127], v[224:227]
    ds_read_b128 a[244:247], v1 offset:13312
    v_mul_f32 v204, v196, v204
    v_mfma_f32_16x16x32_bf16 v[216:219], a[248:251], v[120:123], v[216:219]
    s_add_u32 s77, s94, 24576
    buffer_load_dwordx4 a[96:99], v1, s[8:11], s77 offen offset:0 sc1
    v_mfma_f32_16x16x32_bf16 v[232:235], a[248:251], v[124:127], v[232:235]
    ds_read_b128 a[248:251], v1 offset:14336
    v_mul_f32_e64 v196, -v196, v8
    v_mfma_f32_16x16x32_bf16 v[212:215], a[252:255], v[120:123], v[212:215]
    s_add_u32 s86, s85, 212992
    s_add_u32 m0, s87, 81920
    v_mfma_f32_16x16x32_bf16 v[228:231], a[252:255], v[124:127], v[228:231]
    ds_read_b128 a[252:255], v1 offset:15360
    v_fma_f32 v9, v197, v197, v4
    v_mfma_f32_16x16x32_bf16 v[220:223], a[220:223], v[120:123], v[220:223]
    buffer_load_dwordx4 v1, s[8:11], s86 offen offset:0 sc1 lds
    v_mul_f32 v205, v197, v205
    v_mfma_f32_16x16x32_bf16 v[236:239], a[220:223], v[124:127], v[236:239]
    ds_read_b128 a[220:223], v1 offset:16384
    s_waitcnt lgkmcnt(5)
    v_mfma_f32_16x16x32_bf16 v[208:211], a[224:227], v[128:131], v[208:211]
    v_exp_f32 v195, v195
    v_mfma_f32_16x16x32_bf16 v[224:227], a[224:227], v[132:135], v[224:227]
    ds_read_b128 a[224:227], v1 offset:17408
    v_add_f32 v195, 1.0, v195
    v_mfma_f32_16x16x32_bf16 v[216:219], a[228:231], v[128:131], v[216:219]
    v_rcp_f32 v195, v195
    v_mfma_f32_16x16x32_bf16 v[232:235], a[228:231], v[132:135], v[232:235]
    ds_read_b128 a[228:231], v1 offset:18432
    v_mul_f32 v203, v203, v195
    v_mfma_f32_16x16x32_bf16 v[212:215], a[232:235], v[128:131], v[212:215]
    v_cvt_pk_bf16_f32 v241, v202, v203
    v_mul_f32_e64 v197, -v197, v9
    v_mfma_f32_16x16x32_bf16 v[228:231], a[232:235], v[132:135], v[228:231]
    ds_read_b128 a[232:235], v1 offset:19456
    buffer_load_dwordx4 a[100:103], v1, s[8:11], s77 offen offset:1024 sc1
    v_mfma_f32_16x16x32_bf16 v[220:223], a[236:239], v[128:131], v[220:223]
    buffer_load_dwordx4 v1, s[8:11], s86 offen offset:1024 sc1 lds
    v_fma_f32 v10, v198, v198, v4
    v_mfma_f32_16x16x32_bf16 v[236:239], a[236:239], v[132:135], v[236:239]
    ds_read_b128 a[236:239], v1 offset:20480
    s_waitcnt lgkmcnt(5)
    v_mfma_f32_16x16x32_bf16 v[208:211], a[240:243], v[136:139], v[208:211]
    v_exp_f32 v196, v196
    v_mfma_f32_16x16x32_bf16 v[224:227], a[240:243], v[140:143], v[224:227]
    ds_read_b128 a[240:243], v1 offset:21504
    v_add_f32 v196, 1.0, v196
    v_mfma_f32_16x16x32_bf16 v[216:219], a[244:247], v[136:139], v[216:219]
    v_rcp_f32 v196, v196
    v_mfma_f32_16x16x32_bf16 v[232:235], a[244:247], v[140:143], v[232:235]
    ds_read_b128 a[244:247], v1 offset:22528
    v_mul_f32 v204, v204, v196
    v_mfma_f32_16x16x32_bf16 v[212:215], a[248:251], v[136:139], v[212:215]
    buffer_load_dwordx4 v1, s[8:11], s86 offen offset:2048 sc1 lds
    v_mul_f32 v206, v198, v206
    v_mfma_f32_16x16x32_bf16 v[228:231], a[248:251], v[140:143], v[228:231]
    ds_read_b128 a[248:251], v1 offset:23552
    v_mul_f32_e64 v198, -v198, v10
    v_mfma_f32_16x16x32_bf16 v[220:223], a[252:255], v[136:139], v[220:223]
    v_exp_f32 v197, v197
    v_mfma_f32_16x16x32_bf16 v[236:239], a[252:255], v[140:143], v[236:239]
    ds_read_b128 a[252:255], v1 offset:24576
    s_waitcnt lgkmcnt(5)
    v_mfma_f32_16x16x32_bf16 v[208:211], a[220:223], v[144:147], v[208:211]
    buffer_load_dwordx4 a[104:107], v1, s[8:11], s77 offen offset:2048 sc1
    v_add_f32 v197, 1.0, v197
    v_mfma_f32_16x16x32_bf16 v[224:227], a[220:223], v[148:151], v[224:227]
    ds_read_b128 a[220:223], v1 offset:25600
    v_fma_f32 v11, v199, v199, v4
    v_mfma_f32_16x16x32_bf16 v[216:219], a[224:227], v[144:147], v[216:219]
    v_rcp_f32 v197, v197
    v_mfma_f32_16x16x32_bf16 v[232:235], a[224:227], v[148:151], v[232:235]
    ds_read_b128 a[224:227], v1 offset:26624
    buffer_load_dwordx4 v1, s[8:11], s86 offen offset:3072 sc1 lds
    v_mfma_f32_16x16x32_bf16 v[212:215], a[228:231], v[144:147], v[212:215]
    v_mul_f32 v205, v205, v197
    v_cvt_pk_bf16_f32 v242, v204, v205
    v_mfma_f32_16x16x32_bf16 v[228:231], a[228:231], v[148:151], v[228:231]
    ds_read_b128 a[228:231], v1 offset:27648
    v_mul_f32 v207, v199, v207
    v_mfma_f32_16x16x32_bf16 v[220:223], a[232:235], v[144:147], v[220:223]
    v_exp_f32 v198, v198
    v_mfma_f32_16x16x32_bf16 v[236:239], a[232:235], v[148:151], v[236:239]
    ds_read_b128 a[232:235], v1 offset:28672
    s_waitcnt lgkmcnt(5)
    v_mfma_f32_16x16x32_bf16 v[208:211], a[236:239], v[152:155], v[208:211]
    v_add_f32 v198, 1.0, v198
    v_mul_f32_e64 v199, -v199, v11
    v_mfma_f32_16x16x32_bf16 v[224:227], a[236:239], v[156:159], v[224:227]
    ds_read_b128 a[236:239], v1 offset:29696
    v_mfma_f32_16x16x32_bf16 v[216:219], a[240:243], v[152:155], v[216:219]
    buffer_load_dwordx4 a[108:111], v1, s[8:11], s77 offen offset:3072 sc1
    v_mfma_f32_16x16x32_bf16 v[232:235], a[240:243], v[156:159], v[232:235]
    ds_read_b128 a[240:243], v1 offset:30720
    v_mfma_f32_16x16x32_bf16 v[212:215], a[244:247], v[152:155], v[212:215]
    v_rcp_f32 v198, v198
    v_mfma_f32_16x16x32_bf16 v[228:231], a[244:247], v[156:159], v[228:231]
    ds_read_b128 a[244:247], v1 offset:31744
    v_mul_f32 v206, v206, v198
    v_mfma_f32_16x16x32_bf16 v[220:223], a[248:251], v[152:155], v[220:223]
    v_exp_f32 v199, v199
    v_mfma_f32_16x16x32_bf16 v[236:239], a[248:251], v[156:159], v[236:239]
    s_waitcnt vmcnt(16)
    s_barrier
    ds_read_b128 a[248:251], v1 offset:32768
    s_waitcnt lgkmcnt(5)
    v_mfma_f32_16x16x32_bf16 v[208:211], a[252:255], v[160:163], v[208:211]
    s_add_u32 s86, s85, 229376
    s_add_u32 m0, s87, 98304
    v_mfma_f32_16x16x32_bf16 v[224:227], a[252:255], v[164:167], v[224:227]
    ds_read_b128 a[252:255], v1 offset:33792
    v_add_f32 v199, 1.0, v199
    v_mfma_f32_16x16x32_bf16 v[216:219], a[220:223], v[160:163], v[216:219]
    buffer_load_dwordx4 v1, s[8:11], s86 offen offset:0 sc1 lds
    v_mfma_f32_16x16x32_bf16 v[232:235], a[220:223], v[164:167], v[232:235]
    ds_read_b128 a[220:223], v1 offset:34816
    v_mfma_f32_16x16x32_bf16 v[212:215], a[224:227], v[160:163], v[212:215]
    v_rcp_f32 v199, v199
    v_mfma_f32_16x16x32_bf16 v[228:231], a[224:227], v[164:167], v[228:231]
    ds_read_b128 a[224:227], v1 offset:35840
    s_add_u32 s77, s94, 28672
    v_mfma_f32_16x16x32_bf16 v[220:223], a[228:231], v[160:163], v[220:223]
    buffer_load_dwordx4 a[112:115], v1, s[8:11], s77 offen offset:0 sc1
    v_mul_f32 v207, v207, v199
    v_mfma_f32_16x16x32_bf16 v[236:239], a[228:231], v[164:167], v[236:239]
    ds_read_b128 a[228:231], v1 offset:36864
    s_waitcnt lgkmcnt(5)
    v_mfma_f32_16x16x32_bf16 v[208:211], a[232:235], v[168:171], v[208:211]
    v_cvt_pk_bf16_f32 v243, v206, v207
    v_mfma_f32_16x16x32_bf16 v[224:227], a[232:235], v[172:175], v[224:227]
    ds_read_b128 a[232:235], v1 offset:37888
    buffer_load_dwordx4 v1, s[8:11], s86 offen offset:1024 sc1 lds
    v_mfma_f32_16x16x32_bf16 v[216:219], a[236:239], v[168:171], v[216:219]
    buffer_store_dwordx4 v[240:243], v1, s[8:11], s80 offen sc1
    s_add_u32 s92, s92, 4096
    v_mfma_f32_16x16x32_bf16 v[232:235], a[236:239], v[172:175], v[232:235]
    ds_read_b128 a[236:239], v1 offset:38912
    s_add_u32 s80, s80, 4096
    v_mfma_f32_16x16x32_bf16 v[212:215], a[240:243], v[168:171], v[212:215]
    v_mfma_f32_16x16x32_bf16 v[228:231], a[240:243], v[172:175], v[228:231]
    ds_read_b128 a[240:243], v1 offset:39936
    v_mfma_f32_16x16x32_bf16 v[220:223], a[244:247], v[168:171], v[220:223]
    v_mfma_f32_16x16x32_bf16 v[236:239], a[244:247], v[172:175], v[236:239]
    ds_read_b128 a[244:247], v1 offset:40960
    s_waitcnt lgkmcnt(5)
    v_mfma_f32_16x16x32_bf16 v[176:179], a[248:251], v[16:19], 0
    buffer_load_dwordx4 a[116:119], v1, s[8:11], s77 offen offset:1024 sc1
    buffer_load_dwordx4 v1, s[8:11], s86 offen offset:2048 sc1 lds
    v_mfma_f32_16x16x32_bf16 v[192:195], a[248:251], v[20:23], 0
    ds_read_b128 a[248:251], v1 offset:41984
    v_mfma_f32_16x16x32_bf16 v[184:187], a[252:255], v[16:19], 0
    v_mfma_f32_16x16x32_bf16 v[200:203], a[252:255], v[20:23], 0
    ds_read_b128 a[252:255], v1 offset:43008
    v_fma_f32 v8, v208, v208, v4
    v_mfma_f32_16x16x32_bf16 v[180:183], a[220:223], v[16:19], 0
    v_mul_f32 v216, v208, v216
    v_mul_f32_e64 v208, -v208, v8
    v_mfma_f32_16x16x32_bf16 v[196:199], a[220:223], v[20:23], 0
    ds_read_b128 a[220:223], v1 offset:44032
    v_fma_f32 v9, v209, v209, v4
    v_mfma_f32_16x16x32_bf16 v[188:191], a[224:227], v[16:19], 0
    v_exp_f32 v208, v208
    v_mfma_f32_16x16x32_bf16 v[204:207], a[224:227], v[20:23], 0
    ds_read_b128 a[224:227], v1 offset:45056
    s_waitcnt lgkmcnt(5)
    v_mfma_f32_16x16x32_bf16 v[176:179], a[228:231], v[24:27], v[176:179]
    buffer_load_dwordx4 v1, s[8:11], s86 offen offset:3072 sc1 lds
    v_add_f32 v208, 1.0, v208
    v_mfma_f32_16x16x32_bf16 v[192:195], a[228:231], v[28:31], v[192:195]
    ds_read_b128 a[228:231], v1 offset:46080
    v_mul_f32 v217, v209, v217
    v_mfma_f32_16x16x32_bf16 v[184:187], a[232:235], v[24:27], v[184:187]
    buffer_load_dwordx4 a[120:123], v1, s[8:11], s77 offen offset:2048 sc1
    v_mul_f32_e64 v209, -v209, v9
    v_mfma_f32_16x16x32_bf16 v[200:203], a[232:235], v[28:31], v[200:203]
    ds_read_b128 a[232:235], v1 offset:47104
    v_fma_f32 v10, v210, v210, v4
    v_mfma_f32_16x16x32_bf16 v[180:183], a[236:239], v[24:27], v[180:183]
    s_add_u32 s86, s85, 245760
    s_add_u32 m0, s87, 114688
    v_mfma_f32_16x16x32_bf16 v[196:199], a[236:239], v[28:31], v[196:199]
    ds_read_b128 a[236:239], v1 offset:48128
    v_mul_f32 v218, v210, v218
    v_mfma_f32_16x16x32_bf16 v[188:191], a[240:243], v[24:27], v[188:191]
    buffer_load_dwordx4 v1, s[8:11], s86 offen offset:0 sc1 lds
    v_mul_f32_e64 v210, -v210, v10
    v_mfma_f32_16x16x32_bf16 v[204:207], a[240:243], v[28:31], v[204:207]
    ds_read_b128 a[240:243], v1 offset:49152
    s_waitcnt lgkmcnt(5)
    v_mfma_f32_16x16x32_bf16 v[176:179], a[244:247], v[32:35], v[176:179]
    v_rcp_f32 v208, v208
    v_mfma_f32_16x16x32_bf16 v[192:195], a[244:247], v[36:39], v[192:195]
    ds_read_b128 a[244:247], v1 offset:50176
    v_mul_f32 v216, v216, v208
    v_mfma_f32_16x16x32_bf16 v[184:187], a[248:251], v[32:35], v[184:187]
    v_exp_f32 v209, v209
    v_mfma_f32_16x16x32_bf16 v[200:203], a[248:251], v[36:39], v[200:203]
    ds_read_b128 a[248:251], v1 offset:51200
    v_add_f32 v209, 1.0, v209
    v_mfma_f32_16x16x32_bf16 v[180:183], a[252:255], v[32:35], v[180:183]
    v_rcp_f32 v209, v209
    v_mfma_f32_16x16x32_bf16 v[196:199], a[252:255], v[36:39], v[196:199]
    ds_read_b128 a[252:255], v1 offset:52224
    buffer_load_dwordx4 a[124:127], v1, s[8:11], s77 offen offset:3072 sc1
    v_mfma_f32_16x16x32_bf16 v[188:191], a[220:223], v[32:35], v[188:191]
    buffer_load_dwordx4 v1, s[8:11], s86 offen offset:1024 sc1 lds
    v_mul_f32 v217, v217, v209
    v_mfma_f32_16x16x32_bf16 v[204:207], a[220:223], v[36:39], v[204:207]
    ds_read_b128 a[220:223], v1 offset:53248
    s_waitcnt lgkmcnt(5)
    v_mfma_f32_16x16x32_bf16 v[176:179], a[224:227], v[40:43], v[176:179]
    v_cvt_pk_bf16_f32 v12, v216, v217
    v_fma_f32 v11, v211, v211, v4
    v_mfma_f32_16x16x32_bf16 v[192:195], a[224:227], v[44:47], v[192:195]
    ds_read_b128 a[224:227], v1 offset:54272
    v_mul_f32 v219, v211, v219
    v_mfma_f32_16x16x32_bf16 v[184:187], a[228:231], v[40:43], v[184:187]
    v_exp_f32 v210, v210
    v_mfma_f32_16x16x32_bf16 v[200:203], a[228:231], v[44:47], v[200:203]
    ds_read_b128 a[228:231], v1 offset:55296
    v_add_f32 v210, 1.0, v210
    v_mfma_f32_16x16x32_bf16 v[180:183], a[232:235], v[40:43], v[180:183]
    buffer_load_dwordx4 v1, s[8:11], s86 offen offset:2048 sc1 lds
    v_mul_f32_e64 v211, -v211, v11
    v_mfma_f32_16x16x32_bf16 v[196:199], a[232:235], v[44:47], v[196:199]
    ds_read_b128 a[232:235], v1 offset:56320
    v_fma_f32 v8, v212, v212, v4
    v_mfma_f32_16x16x32_bf16 v[188:191], a[236:239], v[40:43], v[188:191]
    v_rcp_f32 v210, v210
    v_mfma_f32_16x16x32_bf16 v[204:207], a[236:239], v[44:47], v[204:207]
    ds_read_b128 a[236:239], v1 offset:57344
    s_waitcnt lgkmcnt(5)
    v_mfma_f32_16x16x32_bf16 v[176:179], a[240:243], v[48:51], v[176:179]
    s_add_u32 s77, s94, 32768
    buffer_load_dwordx4 a[128:131], v1, s[8:11], s77 offen offset:0 sc1
    v_mfma_f32_16x16x32_bf16 v[192:195], a[240:243], v[52:55], v[192:195]
    ds_read_b128 a[240:243], v1 offset:58368
    v_mul_f32 v218, v218, v210
    v_mfma_f32_16x16x32_bf16 v[184:187], a[244:247], v[48:51], v[184:187]
    v_exp_f32 v211, v211
    v_mfma_f32_16x16x32_bf16 v[200:203], a[244:247], v[52:55], v[200:203]
    ds_read_b128 a[244:247], v1 offset:59392
    buffer_load_dwordx4 v1, s[8:11], s86 offen offset:3072 sc1 lds
    v_mfma_f32_16x16x32_bf16 v[180:183], a[248:251], v[48:51], v[180:183]
    v_add_f32 v211, 1.0, v211
    v_mul_f32 v220, v212, v220
    v_mfma_f32_16x16x32_bf16 v[196:199], a[248:251], v[52:55], v[196:199]
    ds_read_b128 a[248:251], v1 offset:60416
    v_mul_f32_e64 v212, -v212, v8
    v_mfma_f32_16x16x32_bf16 v[188:191], a[252:255], v[48:51], v[188:191]
    v_rcp_f32 v211, v211
    v_mfma_f32_16x16x32_bf16 v[204:207], a[252:255], v[52:55], v[204:207]
    ds_read_b128 a[252:255], v1 offset:61440
    s_waitcnt lgkmcnt(5)
    v_mfma_f32_16x16x32_bf16 v[176:179], a[220:223], v[56:59], v[176:179]
    v_mul_f32 v219, v219, v211
    v_cvt_pk_bf16_f32 v13, v218, v219
    v_mfma_f32_16x16x32_bf16 v[192:195], a[220:223], v[60:63], v[192:195]
    ds_read_b128 a[220:223], v1 offset:62464
    v_fma_f32 v9, v213, v213, v4
    v_mfma_f32_16x16x32_bf16 v[184:187], a[224:227], v[56:59], v[184:187]
    v_exp_f32 v212, v212
    v_mfma_f32_16x16x32_bf16 v[200:203], a[224:227], v[60:63], v[200:203]
    ds_read_b128 a[224:227], v1 offset:63488
    buffer_load_dwordx4 a[132:135], v1, s[8:11], s77 offen offset:1024 sc1
    v_mfma_f32_16x16x32_bf16 v[180:183], a[228:231], v[56:59], v[180:183]
    v_add_f32 v212, 1.0, v212
    v_mul_f32 v221, v213, v221
    v_mfma_f32_16x16x32_bf16 v[196:199], a[228:231], v[60:63], v[196:199]
    ds_read_b128 a[228:231], v1 offset:64512
    v_mul_f32_e64 v213, -v213, v9
    v_mfma_f32_16x16x32_bf16 v[188:191], a[232:235], v[56:59], v[188:191]
    v_rcp_f32 v212, v212
    v_mfma_f32_16x16x32_bf16 v[204:207], a[232:235], v[60:63], v[204:207]
    s_waitcnt vmcnt(11)
    s_barrier
    s_add_u32 s78, s76, 0
    s_cmp_lg_u32 s52, 0
    s_cbranch_scc1 w065
    s_mov_b64 exec, 1
    v_mov_b32 v6, s78
    v_mov_b32 v7, 1
    global_atomic_add v6, v7, s[40:41] sc1
    s_mov_b64 exec, -1
w065:
    ds_read_b128 a[232:235], v2 offset:0
    s_waitcnt lgkmcnt(5)
    v_mfma_f32_16x16x32_bf16 v[176:179], a[236:239], v[64:67], v[176:179]
    s_add_u32 s86, s85, 262144
    s_add_u32 m0, s87, 0
    v_mfma_f32_16x16x32_bf16 v[192:195], a[236:239], v[68:71], v[192:195]
    ds_read_b128 a[236:239], v2 offset:1024
    v_mul_f32 v220, v220, v212
    v_mfma_f32_16x16x32_bf16 v[184:187], a[240:243], v[64:67], v[184:187]
    buffer_load_dwordx4 v1, s[8:11], s86 offen offset:0 sc1 lds
    v_fma_f32 v10, v214, v214, v4
    v_mfma_f32_16x16x32_bf16 v[200:203], a[240:243], v[68:71], v[200:203]
    ds_read_b128 a[240:243], v2 offset:2048
    v_mul_f32 v222, v214, v222
    v_mfma_f32_16x16x32_bf16 v[180:183], a[244:247], v[64:67], v[180:183]
    v_exp_f32 v213, v213
    v_mfma_f32_16x16x32_bf16 v[196:199], a[244:247], v[68:71], v[196:199]
    ds_read_b128 a[244:247], v2 offset:3072
    buffer_load_dwordx4 a[136:139], v1, s[8:11], s77 offen offset:2048 sc1
    v_mfma_f32_16x16x32_bf16 v[188:191], a[248:251], v[64:67], v[188:191]
    v_add_f32 v213, 1.0, v213
    v_mul_f32_e64 v214, -v214, v10
    v_mfma_f32_16x16x32_bf16 v[204:207], a[248:251], v[68:71], v[204:207]
    ds_read_b128 a[248:251], v2 offset:4096
    s_waitcnt lgkmcnt(5)
    v_mfma_f32_16x16x32_bf16 v[176:179], a[252:255], v[72:75], v[176:179]
    v_rcp_f32 v213, v213
    v_mfma_f32_16x16x32_bf16 v[192:195], a[252:255], v[76:79], v[192:195]
    ds_read_b128 a[252:255], v2 offset:5120
    buffer_load_dwordx4 v1, s[8:11], s86 offen offset:1024 sc1 lds
    v_mfma_f32_16x16x32_bf16 v[184:187], a[220:223], v[72:75], v[184:187]
    v_mul_f32 v221, v221, v213
    v_cvt_pk_bf16_f32 v14, v220, v221
    v_mfma_f32_16x16x32_bf16 v[200:203], a[220:223], v[76:79], v[200:203]
    ds_read_b128 a[220:223], v2 offset:6144
    v_fma_f32 v11, v215, v215, v4
    v_mfma_f32_16x16x32_bf16 v[180:183], a[224:227], v[72:75], v[180:183]
    v_exp_f32 v214, v214
    v_mfma_f32_16x16x32_bf16 v[196:199], a[224:227], v[76:79], v[196:199]
    ds_read_b128 a[224:227], v2 offset:7168
    v_add_f32 v214, 1.0, v214
    v_mfma_f32_16x16x32_bf16 v[188:191], a[228:231], v[72:75], v[188:191]
    v_rcp_f32 v214, v214
    v_mfma_f32_16x16x32_bf16 v[204:207], a[228:231], v[76:79], v[204:207]
    ds_read_b128 a[228:231], v2 offset:8192
    s_waitcnt lgkmcnt(5)
    v_mfma_f32_16x16x32_bf16 v[176:179], a[232:235], v[80:83], v[176:179]
    s_add_u32 s77, s94, 40960
    buffer_load_dwordx4 a[140:143], v1, s[8:11], s77 offen offset:0 sc1
    v_mfma_f32_16x16x32_bf16 v[192:195], a[232:235], v[84:87], v[192:195]
    ds_read_b128 a[232:235], v2 offset:9216
    buffer_load_dwordx4 v1, s[8:11], s86 offen offset:2048 sc1 lds
    v_mfma_f32_16x16x32_bf16 v[184:187], a[236:239], v[80:83], v[184:187]
    v_mul_f32 v222, v222, v214
    v_mul_f32 v223, v215, v223
    v_mfma_f32_16x16x32_bf16 v[200:203], a[236:239], v[84:87], v[200:203]
    ds_read_b128 a[236:239], v2 offset:10240
    v_mul_f32_e64 v215, -v215, v11
    v_mfma_f32_16x16x32_bf16 v[180:183], a[240:243], v[80:83], v[180:183]
    v_exp_f32 v215, v215
    v_mfma_f32_16x16x32_bf16 v[196:199], a[240:243], v[84:87], v[196:199]
    ds_read_b128 a[240:243], v2 offset:11264
    v_add_f32 v215, 1.0, v215
    v_mfma_f32_16x16x32_bf16 v[188:191], a[244:247], v[80:83], v[188:191]
    v_rcp_f32 v215, v215
    v_mfma_f32_16x16x32_bf16 v[204:207], a[244:247], v[84:87], v[204:207]
    ds_read_b128 a[244:247], v2 offset:12288
    s_waitcnt lgkmcnt(5)
    v_mfma_f32_16x16x32_bf16 v[176:179], a[248:251], v[88:91], v[176:179]
    buffer_load_dwordx4 v1, s[8:11], s86 offen offset:3072 sc1 lds
    v_mul_f32 v223, v223, v215
    v_mfma_f32_16x16x32_bf16 v[192:195], a[248:251], v[92:95], v[192:195]
    ds_read_b128 a[248:251], v2 offset:13312
    v_cvt_pk_bf16_f32 v15, v222, v223
    v_mfma_f32_16x16x32_bf16 v[184:187], a[252:255], v[88:91], v[184:187]
    buffer_store_dwordx4 v[12:15], v1, s[8:11], s92 offen sc1
    v_fma_f32 v8, v224, v224, v4
    v_mfma_f32_16x16x32_bf16 v[200:203], a[252:255], v[92:95], v[200:203]
    ds_read_b128 a[252:255], v2 offset:14336
    buffer_load_dwordx4 a[144:147], v1, s[8:11], s77 offen offset:1024 sc1
    v_mfma_f32_16x16x32_bf16 v[180:183], a[220:223], v[88:91], v[180:183]
    s_add_u32 s86, s85, 278528
    s_add_u32 m0, s87, 16384
    v_mfma_f32_16x16x32_bf16 v[196:199], a[220:223], v[92:95], v[196:199]
    ds_read_b128 a[220:223], v2 offset:15360
    v_mul_f32 v232, v224, v232
    v_mfma_f32_16x16x32_bf16 v[188:191], a[224:227], v[88:91], v[188:191]
    buffer_load_dwordx4 v1, s[8:11], s86 offen offset:0 sc1 lds
    v_mul_f32_e64 v224, -v224, v8
    v_mfma_f32_16x16x32_bf16 v[204:207], a[224:227], v[92:95], v[204:207]
    s_branch L_past5
L_page5:
    s_setpc_b64 s[98:99]
L_past5:
    ds_read_b128 a[224:227], v2 offset:16384
    s_waitcnt lgkmcnt(5)
    v_mfma_f32_16x16x32_bf16 v[176:179], a[228:231], v[96:99], v[176:179]
    v_exp_f32 v224, v224
    v_mfma_f32_16x16x32_bf16 v[192:195], a[228:231], v[100:103], v[192:195]
    ds_read_b128 a[228:231], v2 offset:17408
    v_add_f32 v224, 1.0, v224
    v_mfma_f32_16x16x32_bf16 v[184:187], a[232:235], v[96:99], v[184:187]
    v_rcp_f32 v224, v224
    v_mfma_f32_16x16x32_bf16 v[200:203], a[232:235], v[100:103], v[200:203]
    ds_read_b128 a[232:235], v2 offset:18432
    v_mul_f32 v232, v232, v224
    v_mfma_f32_16x16x32_bf16 v[180:183], a[236:239], v[96:99], v[180:183]
    v_fma_f32 v9, v225, v225, v4
    v_mul_f32 v233, v225, v233
    v_mfma_f32_16x16x32_bf16 v[196:199], a[236:239], v[100:103], v[196:199]
    ds_read_b128 a[236:239], v2 offset:19456
    buffer_load_dwordx4 a[148:151], v1, s[8:11], s77 offen offset:2048 sc1
    v_mfma_f32_16x16x32_bf16 v[188:191], a[240:243], v[96:99], v[188:191]
    buffer_load_dwordx4 v1, s[8:11], s86 offen offset:1024 sc1 lds
    v_mul_f32_e64 v225, -v225, v9
    v_mfma_f32_16x16x32_bf16 v[204:207], a[240:243], v[100:103], v[204:207]
    ds_read_b128 a[240:243], v2 offset:20480
    s_waitcnt lgkmcnt(5)
    v_mfma_f32_16x16x32_bf16 v[176:179], a[244:247], v[104:107], v[176:179]
    v_exp_f32 v225, v225
    v_mfma_f32_16x16x32_bf16 v[192:195], a[244:247], v[108:111], v[192:195]
    ds_read_b128 a[244:247], v2 offset:21504
    v_add_f32 v225, 1.0, v225
    v_mfma_f32_16x16x32_bf16 v[184:187], a[248:251], v[104:107], v[184:187]
    v_rcp_f32 v225, v225
    v_mfma_f32_16x16x32_bf16 v[200:203], a[248:251], v[108:111], v[200:203]
    ds_read_b128 a[248:251], v2 offset:22528
    v_mul_f32 v233, v233, v225
    v_mfma_f32_16x16x32_bf16 v[180:183], a[252:255], v[104:107], v[180:183]
    buffer_load_dwordx4 v1, s[8:11], s86 offen offset:2048 sc1 lds
    v_cvt_pk_bf16_f32 v240, v232, v233
    v_mfma_f32_16x16x32_bf16 v[196:199], a[252:255], v[108:111], v[196:199]
    ds_read_b128 a[252:255], v2 offset:23552
    v_fma_f32 v10, v226, v226, v4
    v_mfma_f32_16x16x32_bf16 v[188:191], a[220:223], v[104:107], v[188:191]
    v_mul_f32 v234, v226, v234
    v_mul_f32_e64 v226, -v226, v10
    v_mfma_f32_16x16x32_bf16 v[204:207], a[220:223], v[108:111], v[204:207]
    ds_read_b128 a[220:223], v2 offset:24576
    s_waitcnt lgkmcnt(5)
    v_mfma_f32_16x16x32_bf16 v[176:179], a[224:227], v[112:115], v[176:179]
    buffer_load_dwordx4 a[152:155], v1, s[8:11], s77 offen offset:3072 sc1
    v_fma_f32 v11, v227, v227, v4
    v_mfma_f32_16x16x32_bf16 v[192:195], a[224:227], v[116:119], v[192:195]
    ds_read_b128 a[224:227], v2 offset:25600
    v_mul_f32 v235, v227, v235
    v_mfma_f32_16x16x32_bf16 v[184:187], a[228:231], v[112:115], v[184:187]
    v_exp_f32 v226, v226
    v_mfma_f32_16x16x32_bf16 v[200:203], a[228:231], v[116:119], v[200:203]
    ds_read_b128 a[228:231], v2 offset:26624
    buffer_load_dwordx4 v1, s[8:11], s86 offen offset:3072 sc1 lds
    v_mfma_f32_16x16x32_bf16 v[180:183], a[232:235], v[112:115], v[180:183]
    v_add_f32 v226, 1.0, v226
    v_mul_f32_e64 v227, -v227, v11
    v_mfma_f32_16x16x32_bf16 v[196:199], a[232:235], v[116:119], v[196:199]
    ds_read_b128 a[232:235], v2 offset:27648
    v_fma_f32 v8, v228, v228, v4
    v_mfma_f32_16x16x32_bf16 v[188:191], a[236:239], v[112:115], v[188:191]
    v_rcp_f32 v226, v226
    v_mfma_f32_16x16x32_bf16 v[204:207], a[236:239], v[116:119], v[204:207]
    ds_read_b128 a[236:239], v2 offset:28672
    s_waitcnt lgkmcnt(5)
    v_mfma_f32_16x16x32_bf16 v[176:179], a[240:243], v[120:123], v[176:179]
    v_mul_f32 v234, v234, v226
    v_mul_f32 v236, v228, v236
    v_mfma_f32_16x16x32_bf16 v[192:195], a[240:243], v[124:127], v[192:195]
    ds_read_b128 a[240:243], v2 offset:29696
    v_mul_f32_e64 v228, -v228, v8
    v_mfma_f32_16x16x32_bf16 v[184:187], a[244:247], v[120:123], v[184:187]
    v_exp_f32 v227, v227
    v_mfma_f32_16x16x32_bf16 v[200:203], a[244:247], v[124:127], v[200:203]
    ds_read_b128 a[244:247], v2 offset:30720
    s_add_u32 s77, s94, 45056
    v_mfma_f32_16x16x32_bf16 v[180:183], a[248:251], v[120:123], v[180:183]
    buffer_load_dwordx4 a[156:159], v1, s[8:11], s77 offen offset:0 sc1
    v_add_f32 v227, 1.0, v227
    v_mfma_f32_16x16x32_bf16 v[196:199], a[248:251], v[124:127], v[196:199]
    ds_read_b128 a[248:251], v2 offset:31744
    v_fma_f32 v9, v229, v229, v4
    v_mfma_f32_16x16x32_bf16 v[188:191], a[252:255], v[120:123], v[188:191]
    v_rcp_f32 v227, v227
    v_mfma_f32_16x16x32_bf16 v[204:207], a[252:255], v[124:127], v[204:207]
    s_waitcnt vmcnt(16)
    s_barrier
    ds_read_b128 a[252:255], v2 offset:32768
    s_waitcnt lgkmcnt(5)
    v_mfma_f32_16x16x32_bf16 v[176:179], a[220:223], v[128:131], v[176:179]
    v_mul_f32 v235, v235, v227
    v_cvt_pk_bf16_f32 v241, v234, v235
    v_mfma_f32_16x16x32_bf16 v[192:195], a[220:223], v[132:135], v[192:195]
    ds_read_b128 a[220:223], v2 offset:33792
    v_mul_f32 v237, v229, v237
    v_mfma_f32_16x16x32_bf16 v[184:187], a[224:227], v[128:131], v[184:187]
    global_load_dword v247, v244, s[40:41] sc1
    v_mul_f32_e64 v229, -v229, v9
    v_mfma_f32_16x16x32_bf16 v[200:203], a[224:227], v[132:135], v[200:203]
    ds_read_b128 a[224:227], v2 offset:34816
    v_fma_f32 v10, v230, v230, v4
    v_mfma_f32_16x16x32_bf16 v[180:183], a[228:231], v[128:131], v[180:183]
    v_exp_f32 v228, v228
    v_mfma_f32_16x16x32_bf16 v[196:199], a[228:231], v[132:135], v[196:199]
    ds_read_b128 a[228:231], v2 offset:35840
    v_add_f32 v228, 1.0, v228
    v_mfma_f32_16x16x32_bf16 v[188:191], a[232:235], v[128:131], v[188:191]
    buffer_load_dwordx4 a[160:163], v1, s[8:11], s77 offen offset:1024 sc1
    v_mul_f32 v238, v230, v238
    v_mfma_f32_16x16x32_bf16 v[204:207], a[232:235], v[132:135], v[204:207]
    ds_read_b128 a[232:235], v2 offset:36864
    s_waitcnt lgkmcnt(5)
    v_mfma_f32_16x16x32_bf16 v[176:179], a[236:239], v[136:139], v[176:179]
    v_rcp_f32 v228, v228
    v_mfma_f32_16x16x32_bf16 v[192:195], a[236:239], v[140:143], v[192:195]
    ds_read_b128 a[236:239], v2 offset:37888
    v_mul_f32 v236, v236, v228
    v_mfma_f32_16x16x32_bf16 v[184:187], a[240:243], v[136:139], v[184:187]
    v_exp_f32 v229, v229
    v_mfma_f32_16x16x32_bf16 v[200:203], a[240:243], v[140:143], v[200:203]
    ds_read_b128 a[240:243], v2 offset:38912
    v_add_f32 v229, 1.0, v229
    v_mfma_f32_16x16x32_bf16 v[180:183], a[244:247], v[136:139], v[180:183]
    v_rcp_f32 v229, v229
    v_mfma_f32_16x16x32_bf16 v[196:199], a[244:247], v[140:143], v[196:199]
    ds_read_b128 a[244:247], v2 offset:39936
    v_mul_f32 v237, v237, v229
    v_mfma_f32_16x16x32_bf16 v[188:191], a[248:251], v[136:139], v[188:191]
    v_cvt_pk_bf16_f32 v242, v236, v237
    v_mul_f32_e64 v230, -v230, v10
    v_mfma_f32_16x16x32_bf16 v[204:207], a[248:251], v[140:143], v[204:207]
    ds_read_b128 a[248:251], v2 offset:40960
    s_waitcnt lgkmcnt(5)
    v_mfma_f32_16x16x32_bf16 v[176:179], a[252:255], v[144:147], v[176:179]
    buffer_load_dwordx4 a[164:167], v1, s[8:11], s77 offen offset:2048 sc1
    v_fma_f32 v11, v231, v231, v4
    v_mfma_f32_16x16x32_bf16 v[192:195], a[252:255], v[148:151], v[192:195]
    ds_read_b128 a[252:255], v2 offset:41984
    v_mul_f32 v239, v231, v239
    v_mfma_f32_16x16x32_bf16 v[184:187], a[220:223], v[144:147], v[184:187]
    v_exp_f32 v230, v230
    v_mfma_f32_16x16x32_bf16 v[200:203], a[220:223], v[148:151], v[200:203]
    ds_read_b128 a[220:223], v2 offset:43008
    v_add_f32 v230, 1.0, v230
    v_mfma_f32_16x16x32_bf16 v[180:183], a[224:227], v[144:147], v[180:183]
    v_rcp_f32 v230, v230
    v_mfma_f32_16x16x32_bf16 v[196:199], a[224:227], v[148:151], v[196:199]
    ds_read_b128 a[224:227], v2 offset:44032
    v_mul_f32 v238, v238, v230
    v_mfma_f32_16x16x32_bf16 v[188:191], a[228:231], v[144:147], v[188:191]
    v_mul_f32_e64 v231, -v231, v11
    v_mfma_f32_16x16x32_bf16 v[204:207], a[228:231], v[148:151], v[204:207]
    ds_read_b128 a[228:231], v2 offset:45056
    s_waitcnt lgkmcnt(5)
    v_mfma_f32_16x16x32_bf16 v[176:179], a[232:235], v[152:155], v[176:179]
    v_exp_f32 v231, v231
    v_mfma_f32_16x16x32_bf16 v[192:195], a[232:235], v[156:159], v[192:195]
    ds_read_b128 a[232:235], v2 offset:46080
    v_add_f32 v231, 1.0, v231
    v_mfma_f32_16x16x32_bf16 v[184:187], a[236:239], v[152:155], v[184:187]
    v_rcp_f32 v231, v231
    v_mfma_f32_16x16x32_bf16 v[200:203], a[236:239], v[156:159], v[200:203]
    ds_read_b128 a[236:239], v2 offset:47104
    buffer_load_dwordx4 a[168:171], v1, s[8:11], s77 offen offset:3072 sc1
    v_mfma_f32_16x16x32_bf16 v[180:183], a[240:243], v[152:155], v[180:183]
    v_mul_f32 v239, v239, v231
    v_cvt_pk_bf16_f32 v243, v238, v239
    v_mfma_f32_16x16x32_bf16 v[196:199], a[240:243], v[156:159], v[196:199]
    ds_read_b128 a[240:243], v2 offset:48128
    buffer_store_dwordx4 v[240:243], v1, s[8:11], s80 offen sc1
    v_mfma_f32_16x16x32_bf16 v[188:191], a[244:247], v[152:155], v[188:191]
    s_add_u32 s92, s92, 4096
    s_add_u32 s80, s80, 4096
    v_mfma_f32_16x16x32_bf16 v[204:207], a[244:247], v[156:159], v[204:207]
    ds_read_b128 a[244:247], v2 offset:49152
    s_waitcnt lgkmcnt(5)
    v_mfma_f32_16x16x32_bf16 v[176:179], a[248:251], v[160:163], v[176:179]
    v_mfma_f32_16x16x32_bf16 v[192:195], a[248:251], v[164:167], v[192:195]
    ds_read_b128 a[248:251], v2 offset:50176
    v_mfma_f32_16x16x32_bf16 v[184:187], a[252:255], v[160:163], v[184:187]
    v_mfma_f32_16x16x32_bf16 v[200:203], a[252:255], v[164:167], v[200:203]
    ds_read_b128 a[252:255], v2 offset:51200
    v_mfma_f32_16x16x32_bf16 v[180:183], a[220:223], v[160:163], v[180:183]
    v_mfma_f32_16x16x32_bf16 v[196:199], a[220:223], v[164:167], v[196:199]
    ds_read_b128 a[220:223], v2 offset:52224
    v_mfma_f32_16x16x32_bf16 v[188:191], a[224:227], v[160:163], v[188:191]
    s_add_u32 s77, s94, 49152
    buffer_load_dwordx4 a[172:175], v1, s[8:11], s77 offen offset:0 sc1
    v_mfma_f32_16x16x32_bf16 v[204:207], a[224:227], v[164:167], v[204:207]
    ds_read_b128 a[224:227], v2 offset:53248
    s_waitcnt lgkmcnt(5)
    v_mfma_f32_16x16x32_bf16 v[176:179], a[228:231], v[168:171], v[176:179]
    v_mfma_f32_16x16x32_bf16 v[192:195], a[228:231], v[172:175], v[192:195]
    ds_read_b128 a[228:231], v2 offset:54272
    v_mfma_f32_16x16x32_bf16 v[184:187], a[232:235], v[168:171], v[184:187]
    v_mfma_f32_16x16x32_bf16 v[200:203], a[232:235], v[172:175], v[200:203]
    ds_read_b128 a[232:235], v2 offset:55296
    v_mfma_f32_16x16x32_bf16 v[180:183], a[236:239], v[168:171], v[180:183]
    v_mfma_f32_16x16x32_bf16 v[196:199], a[236:239], v[172:175], v[196:199]
    ds_read_b128 a[236:239], v2 offset:56320
    v_mfma_f32_16x16x32_bf16 v[188:191], a[240:243], v[168:171], v[188:191]
    v_mfma_f32_16x16x32_bf16 v[204:207], a[240:243], v[172:175], v[204:207]
    ds_read_b128 a[240:243], v2 offset:57344
    s_waitcnt vmcnt(5)
    v_cmp_gt_u32 vcc, 16, v247
    s_cbranch_vccz rdy66
    s_mov_b32 s84, 0
spin67:
    global_load_dword v247, v244, s[40:41] sc1
    s_add_u32 s84, s84, 1
    s_cmp_gt_u32 s84, 2000000
    s_cbranch_scc1 spun68
    s_waitcnt vmcnt(0)
    v_cmp_gt_u32 vcc, 16, v247
    s_cbranch_vccnz spin67
spun68:
    s_waitcnt vmcnt(0)
rdy66:
    s_waitcnt lgkmcnt(5)
    v_mfma_f32_16x16x32_bf16 v[208:211], a[244:247], v[16:19], 0
    v_mfma_f32_16x16x32_bf16 v[216:219], a[244:247], v[20:23], 0
    ds_read_b128 a[244:247], v2 offset:58368
    buffer_load_dwordx4 a[176:179], v1, s[8:11], s77 offen offset:1024 sc1
    v_mfma_f32_16x16x32_bf16 v[212:215], a[248:251], v[16:19], 0
    v_mfma_f32_16x16x32_bf16 v[220:223], a[248:251], v[20:23], 0
    ds_read_b128 a[248:251], v2 offset:59392
    v_fma_f32 v8, v176, v176, v4
    v_mfma_f32_16x16x32_bf16 v[208:211], a[252:255], v[24:27], v[208:211]
    buffer_load_dwordx4 v[16:19], v1, s[8:11], s88 offen offset:0 sc1
    v_mul_f32 v184, v176, v184
    v_mul_f32_e64 v176, -v176, v8
    v_exp_f32 v176, v176
    v_mfma_f32_16x16x32_bf16 v[216:219], a[252:255], v[28:31], v[216:219]
    ds_read_b128 a[252:255], v2 offset:60416
    v_add_f32 v176, 1.0, v176
    v_mfma_f32_16x16x32_bf16 v[212:215], a[220:223], v[24:27], v[212:215]
    v_rcp_f32 v176, v176
    v_mfma_f32_16x16x32_bf16 v[220:223], a[220:223], v[28:31], v[220:223]
    ds_read_b128 a[220:223], v2 offset:61440
    s_waitcnt lgkmcnt(5)
    v_mfma_f32_16x16x32_bf16 v[208:211], a[224:227], v[32:35], v[208:211]
    buffer_load_dwordx4 v[20:23], v1, s[8:11], s89 offen offset:0 sc1
    v_mul_f32 v184, v184, v176
    v_fma_f32 v9, v177, v177, v4
    v_mul_f32 v185, v177, v185
    v_mul_f32_e64 v177, -v177, v9
    v_fma_f32 v10, v178, v178, v4
    v_mfma_f32_16x16x32_bf16 v[216:219], a[224:227], v[36:39], v[216:219]
    ds_read_b128 a[224:227], v2 offset:62464
    v_mul_f32 v186, v178, v186
    v_mfma_f32_16x16x32_bf16 v[212:215], a[228:231], v[32:35], v[212:215]
    v_exp_f32 v177, v177
    v_mfma_f32_16x16x32_bf16 v[220:223], a[228:231], v[36:39], v[220:223]
    ds_read_b128 a[228:231], v2 offset:63488
    buffer_load_dwordx4 a[180:183], v1, s[8:11], s77 offen offset:2048 sc1
    v_mfma_f32_16x16x32_bf16 v[208:211], a[232:235], v[40:43], v[208:211]
    buffer_load_dwordx4 v[24:27], v1, s[8:11], s90 offen offset:0 sc1
    v_add_f32 v177, 1.0, v177
    v_rcp_f32 v177, v177
    v_mfma_f32_16x16x32_bf16 v[216:219], a[232:235], v[44:47], v[216:219]
    ds_read_b128 a[232:235], v2 offset:64512
    v_mul_f32 v185, v185, v177
    v_mfma_f32_16x16x32_bf16 v[212:215], a[236:239], v[40:43], v[212:215]
    v_cvt_pk_bf16_f32 v12, v184, v185
    v_mul_f32_e64 v178, -v178, v10
    v_exp_f32 v178, v178
    v_mfma_f32_16x16x32_bf16 v[220:223], a[236:239], v[44:47], v[220:223]
    s_barrier
    ds_read_b128 a[236:239], v1 offset:0
    s_waitcnt lgkmcnt(5)
    v_mfma_f32_16x16x32_bf16 v[208:211], a[240:243], v[48:51], v[208:211]
    buffer_load_dwordx4 v[28:31], v1, s[8:11], s91 offen offset:0 sc1
    v_add_f32 v178, 1.0, v178
    v_rcp_f32 v178, v178
    v_mfma_f32_16x16x32_bf16 v[216:219], a[240:243], v[52:55], v[216:219]
    ds_read_b128 a[240:243], v1 offset:1024
    v_mul_f32 v186, v186, v178
    v_mfma_f32_16x16x32_bf16 v[212:215], a[244:247], v[48:51], v[212:215]
    v_fma_f32 v11, v179, v179, v4
    v_mul_f32 v187, v179, v187
    v_mul_f32_e64 v179, -v179, v11
    v_exp_f32 v179, v179
    v_mfma_f32_16x16x32_bf16 v[220:223], a[244:247], v[52:55], v[220:223]
    ds_read_b128 a[244:247], v1 offset:2048
    v_add_f32 v179, 1.0, v179
    v_mfma_f32_16x16x32_bf16 v[208:211], a[248:251], v[56:59], v[208:211]
    s_add_u32 s81, s94, 32768
    buffer_load_dwordx4 v[224:227], v1, s[8:11], s81 offen offset:3072 sc1
    v_rcp_f32 v179, v179
    v_mfma_f32_16x16x32_bf16 v[216:219], a[248:251], v[60:63], v[216:219]
    ds_read_b128 a[248:251], v1 offset:3072
    v_mul_f32 v187, v187, v179
    v_mfma_f32_16x16x32_bf16 v[212:215], a[252:255], v[56:59], v[212:215]
    buffer_load_dwordx4 a[184:187], v1, s[8:11], s77 offen offset:3072 sc1
    v_cvt_pk_bf16_f32 v13, v186, v187
    v_fma_f32 v8, v180, v180, v4
    v_mul_f32 v188, v180, v188
    v_mul_f32_e64 v180, -v180, v8
    v_fma_f32 v9, v181, v181, v4
    v_mfma_f32_16x16x32_bf16 v[220:223], a[252:255], v[60:63], v[220:223]
    ds_read_b128 a[252:255], v1 offset:4096
    s_waitcnt lgkmcnt(5)
    v_mfma_f32_16x16x32_bf16 v[208:211], a[220:223], v[64:67], v[208:211]
    buffer_load_dwordx4 v[32:35], v1, s[8:11], s88 offen offset:1024 sc1
    v_exp_f32 v180, v180
    v_mfma_f32_16x16x32_bf16 v[216:219], a[220:223], v[68:71], v[216:219]
    ds_read_b128 a[220:223], v1 offset:5120
    v_add_f32 v180, 1.0, v180
    v_mfma_f32_16x16x32_bf16 v[212:215], a[224:227], v[64:67], v[212:215]
    v_rcp_f32 v180, v180
    v_mfma_f32_16x16x32_bf16 v[220:223], a[224:227], v[68:71], v[220:223]
    ds_read_b128 a[224:227], v1 offset:6144
    v_mul_f32 v188, v188, v180
    v_mfma_f32_16x16x32_bf16 v[208:211], a[228:231], v[72:75], v[208:211]
    buffer_load_dwordx4 v[36:39], v1, s[8:11], s89 offen offset:1024 sc1
    v_mul_f32 v189, v181, v189
    v_mul_f32_e64 v181, -v181, v9
    v_exp_f32 v181, v181
    v_mfma_f32_16x16x32_bf16 v[216:219], a[228:231], v[76:79], v[216:219]
    ds_read_b128 a[228:231], v1 offset:7168
    v_add_f32 v181, 1.0, v181
    v_mfma_f32_16x16x32_bf16 v[212:215], a[232:235], v[72:75], v[212:215]
    v_rcp_f32 v181, v181
    v_mfma_f32_16x16x32_bf16 v[220:223], a[232:235], v[76:79], v[220:223]
    ds_read_b128 a[232:235], v1 offset:8192
    s_waitcnt lgkmcnt(5)
    v_mfma_f32_16x16x32_bf16 v[208:211], a[236:239], v[80:83], v[208:211]
    s_waitcnt vmcnt(11)
    s_barrier
    s_add_u32 s78, s76, 64
    s_cmp_lg_u32 s52, 0
    s_cbranch_scc1 w069
    s_mov_b64 exec, 1
    v_mov_b32 v6, s78
    v_mov_b32 v7, 1
    global_atomic_add v6, v7, s[40:41] sc1
    s_mov_b64 exec, -1
w069:
    buffer_load_dwordx4 v[40:43], v1, s[8:11], s90 offen offset:1024 sc1
    v_mul_f32 v189, v189, v181
    v_cvt_pk_bf16_f32 v14, v188, v189
    v_fma_f32 v10, v182, v182, v4
    v_mfma_f32_16x16x32_bf16 v[216:219], a[236:239], v[84:87], v[216:219]
    ds_read_b128 a[236:239], v1 offset:9216
    s_add_u32 s77, s94, 53248
    v_mfma_f32_16x16x32_bf16 v[212:215], a[240:243], v[80:83], v[212:215]
    buffer_load_dwordx4 a[188:191], v1, s[8:11], s77 offen offset:0 sc1
    v_mul_f32 v190, v182, v190
    v_mul_f32_e64 v182, -v182, v10
    v_exp_f32 v182, v182
    v_mfma_f32_16x16x32_bf16 v[220:223], a[240:243], v[84:87], v[220:223]
    ds_read_b128 a[240:243], v1 offset:10240
    v_add_f32 v182, 1.0, v182
    v_mfma_f32_16x16x32_bf16 v[208:211], a[244:247], v[88:91], v[208:211]
    s_add_u32 s81, s94, 36864
    buffer_load_dwordx4 v[228:231], v1, s[8:11], s81 offen offset:0 sc1
    v_rcp_f32 v182, v182
    v_mfma_f32_16x16x32_bf16 v[216:219], a[244:247], v[92:95], v[216:219]
    ds_read_b128 a[244:247], v1 offset:11264
    v_mul_f32 v190, v190, v182
    v_mfma_f32_16x16x32_bf16 v[212:215], a[248:251], v[88:91], v[212:215]
    v_fma_f32 v11, v183, v183, v4
    v_mul_f32 v191, v183, v191
    v_mul_f32_e64 v183, -v183, v11
    v_exp_f32 v183, v183
    v_mfma_f32_16x16x32_bf16 v[220:223], a[248:251], v[92:95], v[220:223]
    ds_read_b128 a[248:251], v1 offset:12288
    s_waitcnt lgkmcnt(5)
    v_mfma_f32_16x16x32_bf16 v[208:211], a[252:255], v[96:99], v[208:211]
    buffer_load_dwordx4 v[44:47], v1, s[8:11], s91 offen offset:1024 sc1
    v_add_f32 v183, 1.0, v183
    v_rcp_f32 v183, v183
    v_mfma_f32_16x16x32_bf16 v[216:219], a[252:255], v[100:103], v[216:219]
    ds_read_b128 a[252:255], v1 offset:13312
    v_mul_f32 v191, v191, v183
    v_mfma_f32_16x16x32_bf16 v[212:215], a[220:223], v[96:99], v[212:215]
    v_cvt_pk_bf16_f32 v15, v190, v191
    v_fma_f32 v8, v192, v192, v4
    v_mul_f32 v200, v192, v200
    v_mul_f32_e64 v192, -v192, v8
    v_exp_f32 v192, v192
    v_mfma_f32_16x16x32_bf16 v[220:223], a[220:223], v[100:103], v[220:223]
    ds_read_b128 a[220:223], v1 offset:14336
    buffer_load_dwordx4 a[192:195], v1, s[8:11], s77 offen offset:1024 sc1
    v_mfma_f32_16x16x32_bf16 v[208:211], a[224:227], v[104:107], v[208:211]
    buffer_load_dwordx4 v[48:51], v1, s[8:11], s88 offen offset:2048 sc1
    buffer_store_dwordx4 v[12:15], v1, s[8:11], s92 offen sc1
    v_add_f32 v192, 1.0, v192
    v_rcp_f32 v192, v192
    v_mfma_f32_16x16x32_bf16 v[216:219], a[224:227], v[108:111], v[216:219]
    ds_read_b128 a[224:227], v1 offset:15360
    v_mul_f32 v200, v200, v192
    v_mfma_f32_16x16x32_bf16 v[212:215], a[228:231], v[104:107], v[212:215]
    v_fma_f32 v9, v193, v193, v4
    v_mul_f32 v201, v193, v201
    v_mul_f32_e64 v193, -v193, v9
    v_exp_f32 v193, v193
    v_mfma_f32_16x16x32_bf16 v[220:223], a[228:231], v[108:111], v[220:223]
    ds_read_b128 a[228:231], v1 offset:16384
    s_waitcnt lgkmcnt(5)
    v_mfma_f32_16x16x32_bf16 v[208:211], a[232:235], v[112:115], v[208:211]
    buffer_load_dwordx4 v[52:55], v1, s[8:11], s89 offen offset:2048 sc1
    v_add_f32 v193, 1.0, v193
    v_rcp_f32 v193, v193
    v_mfma_f32_16x16x32_bf16 v[216:219], a[232:235], v[116:119], v[216:219]
    ds_read_b128 a[232:235], v1 offset:17408
    v_mul_f32 v201, v201, v193
    v_mfma_f32_16x16x32_bf16 v[212:215], a[236:239], v[112:115], v[212:215]
    v_cvt_pk_bf16_f32 v240, v200, v201
    v_fma_f32 v10, v194, v194, v4
    v_mul_f32 v202, v194, v202
    v_mul_f32_e64 v194, -v194, v10
    v_exp_f32 v194, v194
    v_mfma_f32_16x16x32_bf16 v[220:223], a[236:239], v[116:119], v[220:223]
    ds_read_b128 a[236:239], v1 offset:18432
    v_add_f32 v194, 1.0, v194
    v_mfma_f32_16x16x32_bf16 v[208:211], a[240:243], v[120:123], v[208:211]
    global_load_dword v247, v245, s[40:41] sc1
    buffer_load_dwordx4 v[232:235], v1, s[8:11], s81 offen offset:1024 sc1
    v_rcp_f32 v194, v194
    v_mfma_f32_16x16x32_bf16 v[216:219], a[240:243], v[124:127], v[216:219]
    ds_read_b128 a[240:243], v1 offset:19456
    v_mul_f32 v202, v202, v194
    v_mfma_f32_16x16x32_bf16 v[212:215], a[244:247], v[120:123], v[212:215]
    buffer_load_dwordx4 a[196:199], v1, s[8:11], s77 offen offset:2048 sc1
    v_fma_f32 v11, v195, v195, v4
    v_mul_f32 v203, v195, v203
    v_mul_f32_e64 v195, -v195, v11
    v_exp_f32 v195, v195
    v_mfma_f32_16x16x32_bf16 v[220:223], a[244:247], v[124:127], v[220:223]
    ds_read_b128 a[244:247], v1 offset:20480
    s_waitcnt lgkmcnt(5)
    v_mfma_f32_16x16x32_bf16 v[208:211], a[248:251], v[128:131], v[208:211]
    buffer_load_dwordx4 v[56:59], v1, s[8:11], s90 offen offset:2048 sc1
    v_add_f32 v195, 1.0, v195
    v_rcp_f32 v195, v195
    v_mfma_f32_16x16x32_bf16 v[216:219], a[248:251], v[132:135], v[216:219]
    ds_read_b128 a[248:251], v1 offset:21504
    v_mul_f32 v203, v203, v195
    v_mfma_f32_16x16x32_bf16 v[212:215], a[252:255], v[128:131], v[212:215]
    v_cvt_pk_bf16_f32 v241, v202, v203
    v_fma_f32 v8, v196, v196, v4
    v_mul_f32 v204, v196, v204
    v_mul_f32_e64 v196, -v196, v8
    v_exp_f32 v196, v196
    v_mfma_f32_16x16x32_bf16 v[220:223], a[252:255], v[132:135], v[220:223]
    ds_read_b128 a[252:255], v1 offset:22528
    v_add_f32 v196, 1.0, v196
    v_mfma_f32_16x16x32_bf16 v[208:211], a[220:223], v[136:139], v[208:211]
    buffer_load_dwordx4 v[60:63], v1, s[8:11], s91 offen offset:2048 sc1
    v_rcp_f32 v196, v196
    v_mfma_f32_16x16x32_bf16 v[216:219], a[220:223], v[140:143], v[216:219]
    ds_read_b128 a[220:223], v1 offset:23552
    v_mul_f32 v204, v204, v196
    v_mfma_f32_16x16x32_bf16 v[212:215], a[224:227], v[136:139], v[212:215]
    v_fma_f32 v9, v197, v197, v4
    v_mul_f32 v205, v197, v205
    v_mul_f32_e64 v197, -v197, v9
    v_exp_f32 v197, v197
    v_mfma_f32_16x16x32_bf16 v[220:223], a[224:227], v[140:143], v[220:223]
    v_add_f32 v197, 1.0, v197
    s_waitcnt lgkmcnt(4)
    v_mfma_f32_16x16x32_bf16 v[208:211], a[228:231], v[144:147], v[208:211]
    buffer_load_dwordx4 v[64:67], v1, s[8:11], s88 offen offset:3072 sc1
    v_rcp_f32 v197, v197
    v_mfma_f32_16x16x32_bf16 v[216:219], a[228:231], v[148:151], v[216:219]
    buffer_load_dwordx4 a[200:203], v1, s[8:11], s77 offen offset:3072 sc1
    v_mul_f32 v205, v205, v197
    v_mfma_f32_16x16x32_bf16 v[212:215], a[232:235], v[144:147], v[212:215]
    v_cvt_pk_bf16_f32 v242, v204, v205
    v_fma_f32 v10, v198, v198, v4
    v_mul_f32 v206, v198, v206
    v_mul_f32_e64 v198, -v198, v10
    v_exp_f32 v198, v198
    v_mfma_f32_16x16x32_bf16 v[220:223], a[232:235], v[148:151], v[220:223]
    v_add_f32 v198, 1.0, v198
    v_fma_f32 v11, v199, v199, v4
    v_mfma_f32_16x16x32_bf16 v[208:211], a[236:239], v[152:155], v[208:211]
    buffer_load_dwordx4 v[236:239], v1, s[8:11], s81 offen offset:2048 sc1
    v_rcp_f32 v198, v198
    v_mfma_f32_16x16x32_bf16 v[216:219], a[236:239], v[156:159], v[216:219]
    v_mul_f32 v206, v206, v198
    v_mul_f32 v207, v199, v207
    v_mfma_f32_16x16x32_bf16 v[212:215], a[240:243], v[152:155], v[212:215]
    v_mul_f32_e64 v199, -v199, v11
    v_exp_f32 v199, v199
    v_mfma_f32_16x16x32_bf16 v[220:223], a[240:243], v[156:159], v[220:223]
    v_add_f32 v199, 1.0, v199
    s_waitcnt lgkmcnt(0)
    v_mfma_f32_16x16x32_bf16 v[208:211], a[244:247], v[160:163], v[208:211]
    buffer_load_dwordx4 v[68:71], v1, s[8:11], s89 offen offset:3072 sc1
    v_rcp_f32 v199, v199
    v_mfma_f32_16x16x32_bf16 v[216:219], a[244:247], v[164:167], v[216:219]
    v_mul_f32 v207, v207, v199
    v_cvt_pk_bf16_f32 v243, v206, v207
    v_mfma_f32_16x16x32_bf16 v[212:215], a[248:251], v[160:163], v[212:215]
    buffer_store_dwordx4 v[240:243], v1, s[8:11], s80 offen sc1
    v_mfma_f32_16x16x32_bf16 v[220:223], a[248:251], v[164:167], v[220:223]
    v_mfma_f32_16x16x32_bf16 v[208:211], a[252:255], v[168:171], v[208:211]
    s_add_u32 s77, s94, 57344
    buffer_load_dwordx4 a[204:207], v1, s[8:11], s77 offen offset:0 sc1
    buffer_load_dwordx4 v[72:75], v1, s[8:11], s90 offen offset:3072 sc1
    v_mfma_f32_16x16x32_bf16 v[216:219], a[252:255], v[172:175], v[216:219]
    v_mfma_f32_16x16x32_bf16 v[212:215], a[220:223], v[168:171], v[212:215]
    v_mfma_f32_16x16x32_bf16 v[220:223], a[220:223], v[172:175], v[220:223]
    s_waitcnt vmcnt(28)
    v_mfma_f32_16x16x32_bf16 v[80:83], a[0:3], v[16:19], 0
    buffer_load_dwordx4 v[76:79], v1, s[8:11], s91 offen offset:3072 sc1
    v_mfma_f32_16x16x32_bf16 v[84:87], a[4:7], v[16:19], 0
    v_mfma_f32_16x16x32_bf16 v[88:91], a[8:11], v[16:19], 0
    v_mfma_f32_16x16x32_bf16 v[92:95], a[12:15], v[16:19], 0
    v_fma_f32 v8, v208, v208, v4
    v_mul_f32 v212, v208, v212
    v_mfma_f32_16x16x32_bf16 v[96:99], a[16:19], v[16:19], 0
    v_mul_f32_e64 v208, -v208, v8
    v_exp_f32 v208, v208
    s_waitcnt vmcnt(28)
    v_mfma_f32_16x16x32_bf16 v[100:103], a[0:3], v[20:23], 0
    v_add_f32 v208, 1.0, v208
    v_fma_f32 v9, v209, v209, v4
    v_mfma_f32_16x16x32_bf16 v[104:107], a[4:7], v[20:23], 0
    buffer_load_dwordx4 a[208:211], v1, s[8:11], s77 offen offset:1024 sc1
    v_rcp_f32 v208, v208
    v_mfma_f32_16x16x32_bf16 v[108:111], a[8:11], v[20:23], 0
    buffer_load_dwordx4 v[160:163], v1, s[8:11], s81 offen offset:3072 sc1
    v_mul_f32 v212, v212, v208
    v_mfma_f32_16x16x32_bf16 v[112:115], a[12:15], v[20:23], 0
    v_mul_f32 v213, v209, v213
    v_mul_f32_e64 v209, -v209, v9
    v_exp_f32 v209, v209
    v_mfma_f32_16x16x32_bf16 v[116:119], a[16:19], v[20:23], 0
    v_add_f32 v209, 1.0, v209
    s_waitcnt vmcnt(28)
    v_mfma_f32_16x16x32_bf16 v[120:123], a[0:3], v[24:27], 0
    v_rcp_f32 v209, v209
    v_mfma_f32_16x16x32_bf16 v[124:127], a[4:7], v[24:27], 0
    v_mul_f32 v213, v213, v209
    v_cvt_pk_bf16_f32 v12, v212, v213
    v_mfma_f32_16x16x32_bf16 v[128:131], a[8:11], v[24:27], 0
    v_fma_f32 v10, v210, v210, v4
    v_mul_f32 v214, v210, v214
    v_mul_f32_e64 v210, -v210, v10
    v_fma_f32 v11, v211, v211, v4
    v_mfma_f32_16x16x32_bf16 v[132:135], a[12:15], v[24:27], 0
    v_exp_f32 v210, v210
    v_mfma_f32_16x16x32_bf16 v[136:139], a[16:19], v[24:27], 0
    v_add_f32 v210, 1.0, v210
    v_rcp_f32 v210, v210
    s_waitcnt vmcnt(27)
    v_mfma_f32_16x16x32_bf16 v[140:143], a[0:3], v[28:31], 0
    v_mul_f32 v214, v214, v210
    v_mul_f32 v215, v211, v215
    v_mfma_f32_16x16x32_bf16 v[144:147], a[4:7], v[28:31], 0
    v_mul_f32_e64 v211, -v211, v11
    v_exp_f32 v211, v211
    v_mfma_f32_16x16x32_bf16 v[148:151], a[8:11], v[28:31], 0
    buffer_load_dwordx4 a[212:215], v1, s[8:11], s77 offen offset:2048 sc1
    s_waitcnt vmcnt(15)
    v_cmp_gt_u32 vcc, 16, v247
    s_cbranch_vccz rdy70
    s_mov_b32 s84, 0
spin71:
    global_load_dword v247, v245, s[40:41] sc1
    s_add_u32 s84, s84, 1
    s_cmp_gt_u32 s84, 2000000
    s_cbranch_scc1 spun72
    s_waitcnt vmcnt(0)
    v_cmp_gt_u32 vcc, 16, v247
    s_cbranch_vccnz spin71
spun72:
    s_waitcnt vmcnt(0)
rdy70:
    v_mfma_f32_16x16x32_bf16 v[152:155], a[12:15], v[28:31], 0
    s_add_u32 s88, s88, 4096
    buffer_load_dwordx4 v[16:19], v1, s[8:11], s88 offen offset:0 sc1
    v_add_f32 v211, 1.0, v211
    v_fma_f32 v8, v216, v216, v4
    v_mfma_f32_16x16x32_bf16 v[156:159], a[16:19], v[28:31], 0
    v_rcp_f32 v211, v211
    v_mfma_f32_16x16x32_bf16 v[80:83], a[20:23], v[32:35], v[80:83]
    v_mul_f32 v215, v215, v211
    v_cvt_pk_bf16_f32 v13, v214, v215
    v_mul_f32 v220, v216, v220
    v_mul_f32_e64 v216, -v216, v8
    v_mfma_f32_16x16x32_bf16 v[84:87], a[24:27], v[32:35], v[84:87]
    v_exp_f32 v216, v216
    v_mfma_f32_16x16x32_bf16 v[88:91], a[28:31], v[32:35], v[88:91]
    s_add_u32 s89, s89, 4096
    buffer_load_dwordx4 v[20:23], v1, s[8:11], s89 offen offset:0 sc1
    v_add_f32 v216, 1.0, v216
    v_fma_f32 v9, v217, v217, v4
    v_mfma_f32_16x16x32_bf16 v[92:95], a[32:35], v[32:35], v[92:95]
    v_rcp_f32 v216, v216
    v_mfma_f32_16x16x32_bf16 v[96:99], a[36:39], v[32:35], v[96:99]
    v_mul_f32 v220, v220, v216
    v_mul_f32 v221, v217, v221
    v_mul_f32_e64 v217, -v217, v9
    v_fma_f32 v10, v218, v218, v4
    v_mfma_f32_16x16x32_bf16 v[100:103], a[20:23], v[36:39], v[100:103]
    v_exp_f32 v217, v217
    v_mfma_f32_16x16x32_bf16 v[104:107], a[24:27], v[36:39], v[104:107]
    s_add_u32 s81, s94, 61440
    buffer_load_dwordx4 v[164:167], v1, s[8:11], s81 offen offset:0 sc1
    v_add_f32 v217, 1.0, v217
    v_mul_f32 v222, v218, v222
    v_mfma_f32_16x16x32_bf16 v[108:111], a[28:31], v[36:39], v[108:111]
    v_rcp_f32 v217, v217
    v_mfma_f32_16x16x32_bf16 v[112:115], a[32:35], v[36:39], v[112:115]
    buffer_load_dwordx4 a[216:219], v1, s[8:11], s77 offen offset:3072 sc1
    v_mul_f32 v221, v221, v217
    v_cvt_pk_bf16_f32 v14, v220, v221
    v_mul_f32_e64 v218, -v218, v10
    v_mfma_f32_16x16x32_bf16 v[116:119], a[36:39], v[36:39], v[116:119]
    v_exp_f32 v218, v218
    v_mfma_f32_16x16x32_bf16 v[120:123], a[20:23], v[40:43], v[120:123]
    s_add_u32 s90, s90, 4096
    buffer_load_dwordx4 v[24:27], v1, s[8:11], s90 offen offset:0 sc1
    v_add_f32 v218, 1.0, v218
    v_fma_f32 v11, v219, v219, v4
    s_branch L_past6
L_page6:
    s_setpc_b64 s[98:99]
L_past6:
    v_mfma_f32_16x16x32_bf16 v[124:127], a[24:27], v[40:43], v[124:127]
    v_rcp_f32 v218, v218
    v_mfma_f32_16x16x32_bf16 v[128:131], a[28:31], v[40:43], v[128:131]
    v_mul_f32 v222, v222, v218
    v_mul_f32 v223, v219, v223
    v_mul_f32_e64 v219, -v219, v11
    v_mfma_f32_16x16x32_bf16 v[132:135], a[32:35], v[40:43], v[132:135]
    v_exp_f32 v219, v219
    v_mfma_f32_16x16x32_bf16 v[136:139], a[36:39], v[40:43], v[136:139]
    s_add_u32 s91, s91, 4096
    buffer_load_dwordx4 v[28:31], v1, s[8:11], s91 offen offset:0 sc1
    v_add_f32 v219, 1.0, v219
    v_mfma_f32_16x16x32_bf16 v[140:143], a[20:23], v[44:47], v[140:143]
    v_rcp_f32 v219, v219
    v_mfma_f32_16x16x32_bf16 v[144:147], a[24:27], v[44:47], v[144:147]
    v_mul_f32 v223, v223, v219
    v_cvt_pk_bf16_f32 v15, v222, v223
    v_mfma_f32_16x16x32_bf16 v[148:151], a[28:31], v[44:47], v[148:151]
    v_permlane16_swap_b32 v12, v14
    v_mfma_f32_16x16x32_bf16 v[152:155], a[32:35], v[44:47], v[152:155]
    buffer_load_dwordx4 v[32:35], v1, s[8:11], s88 offen offset:1024 sc1
    v_permlane16_swap_b32 v13, v15
    v_mfma_f32_16x16x32_bf16 v[156:159], a[36:39], v[44:47], v[156:159]
    buffer_store_dwordx4 v[12:15], v3, s[8:11], s93 offen sc1
    v_mfma_f32_16x16x32_bf16 v[80:83], a[40:43], v[48:51], v[80:83]
    v_mfma_f32_16x16x32_bf16 v[84:87], a[44:47], v[48:51], v[84:87]
    v_mfma_f32_16x16x32_bf16 v[88:91], a[48:51], v[48:51], v[88:91]
    buffer_load_dwordx4 v[168:171], v1, s[8:11], s81 offen offset:1024 sc1
    v_mfma_f32_16x16x32_bf16 v[92:95], a[52:55], v[48:51], v[92:95]
    v_mfma_f32_16x16x32_bf16 v[96:99], a[56:59], v[48:51], v[96:99]
    s_waitcnt vmcnt(15)
    s_barrier
    s_add_u32 s78, s76, 256
    s_cmp_lg_u32 s52, 0
    s_cbranch_scc1 w073
    s_mov_b64 exec, 1
    v_mov_b32 v6, s78
    v_mov_b32 v7, 1
    global_atomic_add v6, v7, s[40:41] sc1
    s_mov_b64 exec, -1
w073:
    v_mfma_f32_16x16x32_bf16 v[100:103], a[40:43], v[52:55], v[100:103]
    v_mfma_f32_16x16x32_bf16 v[104:107], a[44:47], v[52:55], v[104:107]
    buffer_load_dwordx4 v[36:39], v1, s[8:11], s89 offen offset:1024 sc1
    v_mfma_f32_16x16x32_bf16 v[108:111], a[48:51], v[52:55], v[108:111]
    v_mfma_f32_16x16x32_bf16 v[112:115], a[52:55], v[52:55], v[112:115]
    v_mfma_f32_16x16x32_bf16 v[116:119], a[56:59], v[52:55], v[116:119]
    v_mfma_f32_16x16x32_bf16 v[120:123], a[40:43], v[56:59], v[120:123]
    buffer_load_dwordx4 v[40:43], v1, s[8:11], s90 offen offset:1024 sc1
    v_mfma_f32_16x16x32_bf16 v[124:127], a[44:47], v[56:59], v[124:127]
    v_mfma_f32_16x16x32_bf16 v[128:131], a[48:51], v[56:59], v[128:131]
    v_mfma_f32_16x16x32_bf16 v[132:135], a[52:55], v[56:59], v[132:135]
    v_mfma_f32_16x16x32_bf16 v[136:139], a[56:59], v[56:59], v[136:139]
    buffer_load_dwordx4 v[44:47], v1, s[8:11], s91 offen offset:1024 sc1
    v_mfma_f32_16x16x32_bf16 v[140:143], a[40:43], v[60:63], v[140:143]
    v_mfma_f32_16x16x32_bf16 v[144:147], a[44:47], v[60:63], v[144:147]
    v_mfma_f32_16x16x32_bf16 v[148:151], a[48:51], v[60:63], v[148:151]
    v_mfma_f32_16x16x32_bf16 v[152:155], a[52:55], v[60:63], v[152:155]
    buffer_load_dwordx4 v[172:175], v1, s[8:11], s81 offen offset:2048 sc1
    v_mfma_f32_16x16x32_bf16 v[156:159], a[56:59], v[60:63], v[156:159]
    v_mfma_f32_16x16x32_bf16 v[80:83], a[60:63], v[64:67], v[80:83]
    v_mfma_f32_16x16x32_bf16 v[84:87], a[64:67], v[64:67], v[84:87]
    v_mfma_f32_16x16x32_bf16 v[88:91], a[68:71], v[64:67], v[88:91]
    buffer_load_dwordx4 v[48:51], v1, s[8:11], s88 offen offset:2048 sc1
    v_mfma_f32_16x16x32_bf16 v[92:95], a[72:75], v[64:67], v[92:95]
    v_mfma_f32_16x16x32_bf16 v[96:99], a[76:79], v[64:67], v[96:99]
    v_mfma_f32_16x16x32_bf16 v[100:103], a[60:63], v[68:71], v[100:103]
    v_mfma_f32_16x16x32_bf16 v[104:107], a[64:67], v[68:71], v[104:107]
    buffer_load_dwordx4 v[52:55], v1, s[8:11], s89 offen offset:2048 sc1
    v_mfma_f32_16x16x32_bf16 v[108:111], a[68:71], v[68:71], v[108:111]
    v_mfma_f32_16x16x32_bf16 v[112:115], a[72:75], v[68:71], v[112:115]
    v_mfma_f32_16x16x32_bf16 v[116:119], a[76:79], v[68:71], v[116:119]
    s_waitcnt vmcnt(19)
    v_mfma_f32_16x16x32_bf16 v[120:123], a[60:63], v[72:75], v[120:123]
    buffer_load_dwordx4 v[56:59], v1, s[8:11], s90 offen offset:2048 sc1
    v_mfma_f32_16x16x32_bf16 v[124:127], a[64:67], v[72:75], v[124:127]
    v_mfma_f32_16x16x32_bf16 v[128:131], a[68:71], v[72:75], v[128:131]
    global_load_dword v247, v246, s[40:41] sc1
    v_mfma_f32_16x16x32_bf16 v[132:135], a[72:75], v[72:75], v[132:135]
    v_mfma_f32_16x16x32_bf16 v[136:139], a[76:79], v[72:75], v[136:139]
    buffer_load_dwordx4 v[176:179], v1, s[8:11], s81 offen offset:3072 sc1
    s_waitcnt vmcnt(21)
    v_mfma_f32_16x16x32_bf16 v[140:143], a[60:63], v[76:79], v[140:143]
    v_mfma_f32_16x16x32_bf16 v[144:147], a[64:67], v[76:79], v[144:147]
    v_mfma_f32_16x16x32_bf16 v[148:151], a[68:71], v[76:79], v[148:151]
    v_mfma_f32_16x16x32_bf16 v[152:155], a[72:75], v[76:79], v[152:155]
    buffer_load_dwordx4 v[60:63], v1, s[8:11], s91 offen offset:2048 sc1
    v_mfma_f32_16x16x32_bf16 v[156:159], a[76:79], v[76:79], v[156:159]
    s_waitcnt vmcnt(18)
    v_mfma_f32_16x16x32_bf16 v[80:83], a[80:83], v[16:19], v[80:83]
    v_mfma_f32_16x16x32_bf16 v[84:87], a[84:87], v[16:19], v[84:87]
    v_mfma_f32_16x16x32_bf16 v[88:91], a[88:91], v[16:19], v[88:91]
    buffer_load_dwordx4 v[64:67], v1, s[8:11], s88 offen offset:3072 sc1
    v_mfma_f32_16x16x32_bf16 v[92:95], a[92:95], v[16:19], v[92:95]
    v_mfma_f32_16x16x32_bf16 v[96:99], a[96:99], v[16:19], v[96:99]
    s_waitcnt vmcnt(18)
    v_mfma_f32_16x16x32_bf16 v[100:103], a[80:83], v[20:23], v[100:103]
    v_mfma_f32_16x16x32_bf16 v[104:107], a[84:87], v[20:23], v[104:107]
    buffer_load_dwordx4 v[68:71], v1, s[8:11], s89 offen offset:3072 sc1
    v_mfma_f32_16x16x32_bf16 v[108:111], a[88:91], v[20:23], v[108:111]
    v_mfma_f32_16x16x32_bf16 v[112:115], a[92:95], v[20:23], v[112:115]
    v_mfma_f32_16x16x32_bf16 v[116:119], a[96:99], v[20:23], v[116:119]
    s_waitcnt vmcnt(13)
    s_barrier
    s_add_u32 s78, s76, 512
    s_cmp_lg_u32 s52, 0
    s_cbranch_scc1 w074
    s_mov_b64 exec, 1
    v_mov_b32 v6, s78
    v_mov_b32 v7, 1
    global_atomic_add v6, v7, s[40:41] sc1
    s_mov_b64 exec, -1
w074:
    v_mfma_f32_16x16x32_bf16 v[120:123], a[80:83], v[24:27], v[120:123]
    s_add_u32 s81, s94, 65536
    buffer_load_dwordx4 v[180:183], v1, s[8:11], s81 offen offset:0 sc1
    v_mfma_f32_16x16x32_bf16 v[124:127], a[84:87], v[24:27], v[124:127]
    v_mfma_f32_16x16x32_bf16 v[128:131], a[88:91], v[24:27], v[128:131]
    v_mfma_f32_16x16x32_bf16 v[132:135], a[92:95], v[24:27], v[132:135]
    v_mfma_f32_16x16x32_bf16 v[136:139], a[96:99], v[24:27], v[136:139]
    buffer_load_dwordx4 v[72:75], v1, s[8:11], s90 offen offset:3072 sc1
    v_mfma_f32_16x16x32_bf16 v[140:143], a[80:83], v[28:31], v[140:143]
    v_mfma_f32_16x16x32_bf16 v[144:147], a[84:87], v[28:31], v[144:147]
    v_mfma_f32_16x16x32_bf16 v[148:151], a[88:91], v[28:31], v[148:151]
    v_mfma_f32_16x16x32_bf16 v[152:155], a[92:95], v[28:31], v[152:155]
    buffer_load_dwordx4 v[76:79], v1, s[8:11], s91 offen offset:3072 sc1
    v_mfma_f32_16x16x32_bf16 v[156:159], a[96:99], v[28:31], v[156:159]
    v_mfma_f32_16x16x32_bf16 v[80:83], a[100:103], v[32:35], v[80:83]
    v_mfma_f32_16x16x32_bf16 v[84:87], a[104:107], v[32:35], v[84:87]
    v_mfma_f32_16x16x32_bf16 v[88:91], a[108:111], v[32:35], v[88:91]
    buffer_load_dwordx4 v[184:187], v1, s[8:11], s81 offen offset:1024 sc1
    v_mfma_f32_16x16x32_bf16 v[92:95], a[112:115], v[32:35], v[92:95]
    v_mfma_f32_16x16x32_bf16 v[96:99], a[116:119], v[32:35], v[96:99]
    s_waitcnt vmcnt(15)
    v_mfma_f32_16x16x32_bf16 v[100:103], a[100:103], v[36:39], v[100:103]
    v_mfma_f32_16x16x32_bf16 v[104:107], a[104:107], v[36:39], v[104:107]
    v_mfma_f32_16x16x32_bf16 v[108:111], a[108:111], v[36:39], v[108:111]
    v_mfma_f32_16x16x32_bf16 v[112:115], a[112:115], v[36:39], v[112:115]
    v_mfma_f32_16x16x32_bf16 v[116:119], a[116:119], v[36:39], v[116:119]
    s_waitcnt vmcnt(14)
    v_mfma_f32_16x16x32_bf16 v[120:123], a[100:103], v[40:43], v[120:123]
    v_mfma_f32_16x16x32_bf16 v[124:127], a[104:107], v[40:43], v[124:127]
    v_mfma_f32_16x16x32_bf16 v[128:131], a[108:111], v[40:43], v[128:131]
    v_mfma_f32_16x16x32_bf16 v[132:135], a[112:115], v[40:43], v[132:135]
    v_mfma_f32_16x16x32_bf16 v[136:139], a[116:119], v[40:43], v[136:139]
    s_waitcnt vmcnt(13)
    v_mfma_f32_16x16x32_bf16 v[140:143], a[100:103], v[44:47], v[140:143]
    v_mfma_f32_16x16x32_bf16 v[144:147], a[104:107], v[44:47], v[144:147]
    v_mfma_f32_16x16x32_bf16 v[148:151], a[108:111], v[44:47], v[148:151]
    s_waitcnt vmcnt(8)
    v_cmp_gt_u32 vcc, 16, v247
    s_cbranch_vccz rdy75
    s_mov_b32 s84, 0
spin76:
    global_load_dword v247, v246, s[40:41] sc1
    s_add_u32 s84, s84, 1
    s_cmp_gt_u32 s84, 2000000
    s_cbranch_scc1 spun77
    s_waitcnt vmcnt(0)
    v_cmp_gt_u32 vcc, 16, v247
    s_cbranch_vccnz spin76
spun77:
    s_waitcnt vmcnt(0)
rdy75:
    v_mfma_f32_16x16x32_bf16 v[152:155], a[112:115], v[44:47], v[152:155]
    s_add_u32 s88, s88, 4096
    buffer_load_dwordx4 v[16:19], v1, s[8:11], s88 offen offset:0 sc1
    v_mfma_f32_16x16x32_bf16 v[156:159], a[116:119], v[44:47], v[156:159]
    v_lshrrev_b32 v8, 4, v0
    v_and_b32 v9, 15, v0
    v_mfma_f32_16x16x32_bf16 v[80:83], a[120:123], v[48:51], v[80:83]
    v_lshrrev_b32 v11, 1, v8
    v_lshlrev_b32 v11, 8, v11
    v_mfma_f32_16x16x32_bf16 v[84:87], a[124:127], v[48:51], v[84:87]
    v_lshl_add_u32 v11, v9, 4, v11
    v_add_u32 v11, 2048, v11
    v_mfma_f32_16x16x32_bf16 v[88:91], a[128:131], v[48:51], v[88:91]
    s_add_u32 s89, s89, 4096
    buffer_load_dwordx4 v[20:23], v1, s[8:11], s89 offen offset:0 sc1
    v_mfma_f32_16x16x32_bf16 v[92:95], a[132:135], v[48:51], v[92:95]
    v_mov_b32 v15, 0x80000000
    v_and_b32 v12, 16, v0
    v_mfma_f32_16x16x32_bf16 v[96:99], a[136:139], v[48:51], v[96:99]
    v_cmp_eq_u32 s[98:99], 0, v12
    s_lshl_b32 s72, s55, 3
    v_mfma_f32_16x16x32_bf16 v[100:103], a[120:123], v[52:55], v[100:103]
    s_lshl_b32 s73, s56, 2
    s_add_u32 s72, s72, s73
    v_mfma_f32_16x16x32_bf16 v[104:107], a[124:127], v[52:55], v[104:107]
    s_add_u32 s90, s90, 4096
    buffer_load_dwordx4 v[24:27], v1, s[8:11], s90 offen offset:0 sc1
    v_mfma_f32_16x16x32_bf16 v[108:111], a[128:131], v[52:55], v[108:111]
    s_add_u32 s72, s72, s52
    v_cndmask_b32 v11, v15, v11, s[98:99]
    v_mfma_f32_16x16x32_bf16 v[112:115], a[132:135], v[52:55], v[112:115]
    s_mul_i32 s71, s72, 20480
    s_mul_i32 s72, s72, 20480
    v_mfma_f32_16x16x32_bf16 v[116:119], a[136:139], v[52:55], v[116:119]
    s_mul_i32 s73, s57, 2560
    s_add_u32 s72, s72, s73
    v_mfma_f32_16x16x32_bf16 v[120:123], a[120:123], v[56:59], v[120:123]
    buffer_load_dwordx4 v[188:191], v1, s[8:11], s81 offen offset:2048 sc1
    s_add_u32 s72, s72, 14155776
    v_mfma_f32_16x16x32_bf16 v[124:127], a[124:127], v[56:59], v[124:127]
    s_mul_i32 s64, s52, 15360
    v_add_u32 v204, s64, v2
    v_mfma_f32_16x16x32_bf16 v[128:131], a[128:131], v[56:59], v[128:131]
    s_add_u32 s64, s52, 1
    s_and_b32 s64, s64, 3
    v_mfma_f32_16x16x32_bf16 v[132:135], a[132:135], v[56:59], v[132:135]
    s_mul_i32 s64, s64, 15360
    v_add_u32 v205, s64, v2
    v_mfma_f32_16x16x32_bf16 v[136:139], a[136:139], v[56:59], v[136:139]
    s_add_u32 s91, s91, 4096
    s_waitcnt vmcnt(10)
    v_mfma_f32_16x16x32_bf16 v[140:143], a[120:123], v[60:63], v[140:143]
    buffer_load_dwordx4 v[28:31], v1, s[8:11], s91 offen offset:0 sc1
    s_add_u32 s64, s52, 2
    v_mfma_f32_16x16x32_bf16 v[144:147], a[124:127], v[60:63], v[144:147]
    s_and_b32 s64, s64, 3
    s_mul_i32 s64, s64, 15360
    v_mfma_f32_16x16x32_bf16 v[148:151], a[128:131], v[60:63], v[148:151]
    v_add_u32 v206, s64, v2
    s_add_u32 s64, s52, 3
    v_mfma_f32_16x16x32_bf16 v[152:155], a[132:135], v[60:63], v[152:155]
    buffer_load_dwordx4 v[32:35], v1, s[8:11], s88 offen offset:1024 sc1
    s_and_b32 s64, s64, 3
    v_mfma_f32_16x16x32_bf16 v[156:159], a[136:139], v[60:63], v[156:159]
    s_mul_i32 s64, s64, 15360
    s_waitcnt vmcnt(11)
    v_mfma_f32_16x16x32_bf16 v[80:83], v[224:227], v[64:67], v[80:83]
    v_add_u32 v207, s64, v2
    s_lshl_b32 s71, s55, 1
    v_mfma_f32_16x16x32_bf16 v[84:87], v[228:231], v[64:67], v[84:87]
    s_add_u32 s71, s71, s56
    s_lshl_b32 s71, s71, 8
    v_mfma_f32_16x16x32_bf16 v[88:91], v[232:235], v[64:67], v[88:91]
    buffer_load_dwordx4 v[36:39], v1, s[8:11], s89 offen offset:1024 sc1
    s_add_u32 s71, s71, 8320
    v_mfma_f32_16x16x32_bf16 v[92:95], v[236:239], v[64:67], v[92:95]
    v_mfma_f32_16x16x32_bf16 v[96:99], v[160:163], v[64:67], v[96:99]
    s_waitcnt vmcnt(11)
    v_mfma_f32_16x16x32_bf16 v[100:103], v[224:227], v[68:71], v[100:103]
    v_mfma_f32_16x16x32_bf16 v[104:107], v[228:231], v[68:71], v[104:107]
    buffer_load_dwordx4 v[192:195], v1, s[8:11], s81 offen offset:3072 sc1
    v_mfma_f32_16x16x32_bf16 v[108:111], v[232:235], v[68:71], v[108:111]
    v_mfma_f32_16x16x32_bf16 v[112:115], v[236:239], v[68:71], v[112:115]
    v_mfma_f32_16x16x32_bf16 v[116:119], v[160:163], v[68:71], v[116:119]
    s_waitcnt vmcnt(10)
    v_mfma_f32_16x16x32_bf16 v[120:123], v[224:227], v[72:75], v[120:123]
    buffer_load_dwordx4 v[40:43], v1, s[8:11], s90 offen offset:1024 sc1
    v_mfma_f32_16x16x32_bf16 v[124:127], v[228:231], v[72:75], v[124:127]
    v_mfma_f32_16x16x32_bf16 v[128:131], v[232:235], v[72:75], v[128:131]
    global_load_dword v247, v248, s[40:41] sc1
    v_mfma_f32_16x16x32_bf16 v[132:135], v[236:239], v[72:75], v[132:135]
    v_mfma_f32_16x16x32_bf16 v[136:139], v[160:163], v[72:75], v[136:139]
    buffer_load_dwordx4 v[44:47], v1, s[8:11], s91 offen offset:1024 sc1
    s_waitcnt vmcnt(12)
    v_mfma_f32_16x16x32_bf16 v[140:143], v[224:227], v[76:79], v[140:143]
    v_mfma_f32_16x16x32_bf16 v[144:147], v[228:231], v[76:79], v[144:147]
    v_mfma_f32_16x16x32_bf16 v[148:151], v[232:235], v[76:79], v[148:151]
    v_mfma_f32_16x16x32_bf16 v[152:155], v[236:239], v[76:79], v[152:155]
    buffer_load_dwordx4 v[48:51], v1, s[8:11], s88 offen offset:2048 sc1
    v_mfma_f32_16x16x32_bf16 v[156:159], v[160:163], v[76:79], v[156:159]
    s_waitcnt vmcnt(11)
    v_mfma_f32_16x16x32_bf16 v[80:83], a[140:143], v[16:19], v[80:83]
    v_mfma_f32_16x16x32_bf16 v[84:87], a[144:147], v[16:19], v[84:87]
    v_mfma_f32_16x16x32_bf16 v[88:91], a[148:151], v[16:19], v[88:91]
    s_add_u32 s81, s94, 69632
    buffer_load_dwordx4 v[196:199], v1, s[8:11], s81 offen offset:0 sc1
    v_mfma_f32_16x16x32_bf16 v[92:95], a[152:155], v[16:19], v[92:95]
    v_mfma_f32_16x16x32_bf16 v[96:99], a[156:159], v[16:19], v[96:99]
    s_waitcnt vmcnt(11)
    v_mfma_f32_16x16x32_bf16 v[100:103], a[140:143], v[20:23], v[100:103]
    v_mfma_f32_16x16x32_bf16 v[104:107], a[144:147], v[20:23], v[104:107]
    buffer_load_dwordx4 v[52:55], v1, s[8:11], s89 offen offset:2048 sc1
    v_mfma_f32_16x16x32_bf16 v[108:111], a[148:151], v[20:23], v[108:111]
    v_mfma_f32_16x16x32_bf16 v[112:115], a[152:155], v[20:23], v[112:115]
    v_mfma_f32_16x16x32_bf16 v[116:119], a[156:159], v[20:23], v[116:119]
    s_waitcnt vmcnt(11)
    v_mfma_f32_16x16x32_bf16 v[120:123], a[140:143], v[24:27], v[120:123]
    buffer_load_dwordx4 v[56:59], v1, s[8:11], s90 offen offset:2048 sc1
    v_mfma_f32_16x16x32_bf16 v[124:127], a[144:147], v[24:27], v[124:127]
    v_mfma_f32_16x16x32_bf16 v[128:131], a[148:151], v[24:27], v[128:131]
    v_mfma_f32_16x16x32_bf16 v[132:135], a[152:155], v[24:27], v[132:135]
    v_mfma_f32_16x16x32_bf16 v[136:139], a[156:159], v[24:27], v[136:139]
    buffer_load_dwordx4 v[60:63], v1, s[8:11], s91 offen offset:2048 sc1
    s_waitcnt vmcnt(11)
    v_mfma_f32_16x16x32_bf16 v[140:143], a[140:143], v[28:31], v[140:143]
    v_mfma_f32_16x16x32_bf16 v[144:147], a[144:147], v[28:31], v[144:147]
    v_mfma_f32_16x16x32_bf16 v[148:151], a[148:151], v[28:31], v[148:151]
    v_mfma_f32_16x16x32_bf16 v[152:155], a[152:155], v[28:31], v[152:155]
    buffer_load_dwordx4 v[200:203], v1, s[8:11], s81 offen offset:1024 sc1
    v_mfma_f32_16x16x32_bf16 v[156:159], a[156:159], v[28:31], v[156:159]
    s_waitcnt vmcnt(11)
    v_mfma_f32_16x16x32_bf16 v[80:83], a[160:163], v[32:35], v[80:83]
    v_mfma_f32_16x16x32_bf16 v[84:87], a[164:167], v[32:35], v[84:87]
    v_mfma_f32_16x16x32_bf16 v[88:91], a[168:171], v[32:35], v[88:91]
    buffer_load_dwordx4 v[64:67], v1, s[8:11], s88 offen offset:3072 sc1
    v_mfma_f32_16x16x32_bf16 v[92:95], a[172:175], v[32:35], v[92:95]
    v_mfma_f32_16x16x32_bf16 v[96:99], a[176:179], v[32:35], v[96:99]
    s_waitcnt vmcnt(11)
    v_mfma_f32_16x16x32_bf16 v[100:103], a[160:163], v[36:39], v[100:103]
    v_mfma_f32_16x16x32_bf16 v[104:107], a[164:167], v[36:39], v[104:107]
    buffer_load_dwordx4 v[68:71], v1, s[8:11], s89 offen offset:3072 sc1
    v_mfma_f32_16x16x32_bf16 v[108:111], a[168:171], v[36:39], v[108:111]
    v_mfma_f32_16x16x32_bf16 v[112:115], a[172:175], v[36:39], v[112:115]
    v_mfma_f32_16x16x32_bf16 v[116:119], a[176:179], v[36:39], v[116:119]
    s_waitcnt vmcnt(10)
    v_mfma_f32_16x16x32_bf16 v[120:123], a[160:163], v[40:43], v[120:123]
    buffer_load_dwordx4 v[72:75], v1, s[8:11], s90 offen offset:3072 sc1
    v_mfma_f32_16x16x32_bf16 v[124:127], a[164:167], v[40:43], v[124:127]
    v_mfma_f32_16x16x32_bf16 v[128:131], a[168:171], v[40:43], v[128:131]
    v_mfma_f32_16x16x32_bf16 v[132:135], a[172:175], v[40:43], v[132:135]
    v_mfma_f32_16x16x32_bf16 v[136:139], a[176:179], v[40:43], v[136:139]
    buffer_load_dwordx4 v[76:79], v1, s[8:11], s91 offen offset:3072 sc1
    s_waitcnt vmcnt(10)
    v_mfma_f32_16x16x32_bf16 v[140:143], a[160:163], v[44:47], v[140:143]
    v_mfma_f32_16x16x32_bf16 v[144:147], a[164:167], v[44:47], v[144:147]
    v_mfma_f32_16x16x32_bf16 v[148:151], a[168:171], v[44:47], v[148:151]
    v_cmp_gt_u32 vcc, 16, v247
    s_cbranch_vccz rdy78
    s_mov_b32 s84, 0
spin79:
    global_load_dword v247, v248, s[40:41] sc1
    s_add_u32 s84, s84, 1
    s_cmp_gt_u32 s84, 2000000
    s_cbranch_scc1 spun80
    s_waitcnt vmcnt(0)
    v_cmp_gt_u32 vcc, 16, v247
    s_cbranch_vccnz spin79
spun80:
    s_waitcnt vmcnt(0)
rdy78:
    v_mfma_f32_16x16x32_bf16 v[152:155], a[172:175], v[44:47], v[152:155]
    s_add_u32 s89, s89, 4096
    buffer_load_dwordx4 v[20:23], v1, s[8:11], s89 offen offset:0 sc1
    v_mfma_f32_16x16x32_bf16 v[156:159], a[176:179], v[44:47], v[156:159]
    s_waitcnt vmcnt(10)
    v_mfma_f32_16x16x32_bf16 v[80:83], a[180:183], v[48:51], v[80:83]
    v_mfma_f32_16x16x32_bf16 v[84:87], a[184:187], v[48:51], v[84:87]
    v_mfma_f32_16x16x32_bf16 v[88:91], a[188:191], v[48:51], v[88:91]
    buffer_load_dwordx4 v[36:39], v1, s[8:11], s89 offen offset:1024 sc1
    v_mfma_f32_16x16x32_bf16 v[92:95], a[192:195], v[48:51], v[92:95]
    v_mfma_f32_16x16x32_bf16 v[96:99], a[196:199], v[48:51], v[96:99]
    s_waitcnt vmcnt(9)
    v_mfma_f32_16x16x32_bf16 v[100:103], a[180:183], v[52:55], v[100:103]
    v_mfma_f32_16x16x32_bf16 v[104:107], a[184:187], v[52:55], v[104:107]
    s_add_u32 s90, s90, 4096
    buffer_load_dwordx4 v[24:27], v1, s[8:11], s90 offen offset:0 sc1
    v_mfma_f32_16x16x32_bf16 v[108:111], a[188:191], v[52:55], v[108:111]
    v_mfma_f32_16x16x32_bf16 v[112:115], a[192:195], v[52:55], v[112:115]
    v_mfma_f32_16x16x32_bf16 v[116:119], a[196:199], v[52:55], v[116:119]
    s_waitcnt vmcnt(9)
    v_mfma_f32_16x16x32_bf16 v[120:123], a[180:183], v[56:59], v[120:123]
    buffer_load_dwordx4 v[40:43], v1, s[8:11], s90 offen offset:1024 sc1
    v_mfma_f32_16x16x32_bf16 v[124:127], a[184:187], v[56:59], v[124:127]
    v_mfma_f32_16x16x32_bf16 v[128:131], a[188:191], v[56:59], v[128:131]
    v_mfma_f32_16x16x32_bf16 v[132:135], a[192:195], v[56:59], v[132:135]
    v_mfma_f32_16x16x32_bf16 v[136:139], a[196:199], v[56:59], v[136:139]
    s_add_u32 s91, s91, 4096
    s_waitcnt vmcnt(9)
    v_mfma_f32_16x16x32_bf16 v[140:143], a[180:183], v[60:63], v[140:143]
    buffer_load_dwordx4 v[28:31], v1, s[8:11], s91 offen offset:0 sc1
    v_mfma_f32_16x16x32_bf16 v[144:147], a[184:187], v[60:63], v[144:147]
    v_mfma_f32_16x16x32_bf16 v[148:151], a[188:191], v[60:63], v[148:151]
    v_mfma_f32_16x16x32_bf16 v[152:155], a[192:195], v[60:63], v[152:155]
    buffer_load_dwordx4 v[44:47], v1, s[8:11], s91 offen offset:1024 sc1
    v_mfma_f32_16x16x32_bf16 v[156:159], a[196:199], v[60:63], v[156:159]
    s_waitcnt vmcnt(9)
    v_mfma_f32_16x16x32_bf16 v[80:83], a[200:203], v[64:67], v[80:83]
    v_mfma_f32_16x16x32_bf16 v[84:87], a[204:207], v[64:67], v[84:87]
    v_mfma_f32_16x16x32_bf16 v[88:91], a[208:211], v[64:67], v[88:91]
    s_add_u32 s88, s88, 4096
    buffer_load_dwordx4 v[16:19], v1, s[8:11], s88 offen offset:0 sc1
    v_mfma_f32_16x16x32_bf16 v[92:95], a[212:215], v[64:67], v[92:95]
    v_mfma_f32_16x16x32_bf16 v[96:99], a[216:219], v[64:67], v[96:99]
    s_waitcnt vmcnt(9)
    v_mfma_f32_16x16x32_bf16 v[100:103], a[200:203], v[68:71], v[100:103]
    v_mfma_f32_16x16x32_bf16 v[104:107], a[204:207], v[68:71], v[104:107]
    buffer_load_dwordx4 v[32:35], v1, s[8:11], s88 offen offset:1024 sc1
    v_mfma_f32_16x16x32_bf16 v[108:111], a[208:211], v[68:71], v[108:111]
    v_mfma_f32_16x16x32_bf16 v[112:115], a[212:215], v[68:71], v[112:115]
    v_mfma_f32_16x16x32_bf16 v[116:119], a[216:219], v[68:71], v[116:119]
    s_waitcnt vmcnt(9)
    v_mfma_f32_16x16x32_bf16 v[120:123], a[200:203], v[72:75], v[120:123]
    v_mfma_f32_16x16x32_bf16 v[124:127], a[204:207], v[72:75], v[124:127]
    v_mfma_f32_16x16x32_bf16 v[128:131], a[208:211], v[72:75], v[128:131]
    v_mfma_f32_16x16x32_bf16 v[132:135], a[212:215], v[72:75], v[132:135]
    v_mfma_f32_16x16x32_bf16 v[136:139], a[216:219], v[72:75], v[136:139]
    s_waitcnt vmcnt(8)
    v_mfma_f32_16x16x32_bf16 v[140:143], a[200:203], v[76:79], v[140:143]
    v_mfma_f32_16x16x32_bf16 v[144:147], a[204:207], v[76:79], v[144:147]
    v_mfma_f32_16x16x32_bf16 v[148:151], a[208:211], v[76:79], v[148:151]
    v_mfma_f32_16x16x32_bf16 v[152:155], a[212:215], v[76:79], v[152:155]
    v_mfma_f32_16x16x32_bf16 v[156:159], a[216:219], v[76:79], v[156:159]
    s_waitcnt vmcnt(7)
    v_mfma_f32_16x16x32_bf16 v[100:103], v[164:167], v[20:23], v[100:103]
    v_mfma_f32_16x16x32_bf16 v[104:107], v[168:171], v[20:23], v[104:107]
    v_mfma_f32_16x16x32_bf16 v[108:111], v[172:175], v[20:23], v[108:111]
    v_mfma_f32_16x16x32_bf16 v[112:115], v[176:179], v[20:23], v[112:115]
    v_mfma_f32_16x16x32_bf16 v[116:119], v[180:183], v[20:23], v[116:119]
    s_waitcnt vmcnt(6)
    v_mfma_f32_16x16x32_bf16 v[100:103], v[184:187], v[36:39], v[100:103]
    v_mfma_f32_16x16x32_bf16 v[104:107], v[188:191], v[36:39], v[104:107]
    v_mfma_f32_16x16x32_bf16 v[108:111], v[192:195], v[36:39], v[108:111]
    v_mfma_f32_16x16x32_bf16 v[112:115], v[196:199], v[36:39], v[112:115]
    v_mfma_f32_16x16x32_bf16 v[116:119], v[200:203], v[36:39], v[116:119]
    s_waitcnt vmcnt(5)
    v_mfma_f32_16x16x32_bf16 v[120:123], v[164:167], v[24:27], v[120:123]
    s_nop 1
    ds_write_b128 v205, v[100:103] offset:0
    v_mfma_f32_16x16x32_bf16 v[124:127], v[168:171], v[24:27], v[124:127]
    ds_write_b128 v205, v[104:107] offset:1024
    v_mfma_f32_16x16x32_bf16 v[128:131], v[172:175], v[24:27], v[128:131]
    ds_write_b128 v205, v[108:111] offset:2048
    v_mfma_f32_16x16x32_bf16 v[132:135], v[176:179], v[24:27], v[132:135]
    ds_write_b128 v205, v[112:115] offset:3072
    v_mfma_f32_16x16x32_bf16 v[136:139], v[180:183], v[24:27], v[136:139]
    ds_write_b128 v205, v[116:119] offset:4096
    s_waitcnt vmcnt(4)
    v_mfma_f32_16x16x32_bf16 v[120:123], v[184:187], v[40:43], v[120:123]
    v_mfma_f32_16x16x32_bf16 v[124:127], v[188:191], v[40:43], v[124:127]
    v_mfma_f32_16x16x32_bf16 v[128:131], v[192:195], v[40:43], v[128:131]
    v_mfma_f32_16x16x32_bf16 v[132:135], v[196:199], v[40:43], v[132:135]
    v_mfma_f32_16x16x32_bf16 v[136:139], v[200:203], v[40:43], v[136:139]
    s_waitcnt vmcnt(3)
    v_mfma_f32_16x16x32_bf16 v[140:143], v[164:167], v[28:31], v[140:143]
    s_nop 1
    ds_write_b128 v206, v[120:123] offset:5120
    v_mfma_f32_16x16x32_bf16 v[144:147], v[168:171], v[28:31], v[144:147]
    ds_write_b128 v206, v[124:127] offset:6144
    v_mfma_f32_16x16x32_bf16 v[148:151], v[172:175], v[28:31], v[148:151]
    ds_write_b128 v206, v[128:131] offset:7168
    v_mfma_f32_16x16x32_bf16 v[152:155], v[176:179], v[28:31], v[152:155]
    ds_write_b128 v206, v[132:135] offset:8192
    v_mfma_f32_16x16x32_bf16 v[156:159], v[180:183], v[28:31], v[156:159]
    ds_write_b128 v206, v[136:139] offset:9216
    s_waitcnt vmcnt(2)
    v_mfma_f32_16x16x32_bf16 v[140:143], v[184:187], v[44:47], v[140:143]
    v_mfma_f32_16x16x32_bf16 v[144:147], v[188:191], v[44:47], v[144:147]
    v_mfma_f32_16x16x32_bf16 v[148:151], v[192:195], v[44:47], v[148:151]
    v_mfma_f32_16x16x32_bf16 v[152:155], v[196:199], v[44:47], v[152:155]
    v_mfma_f32_16x16x32_bf16 v[156:159], v[200:203], v[44:47], v[156:159]
    s_waitcnt vmcnt(1)
    v_mfma_f32_16x16x32_bf16 v[80:83], v[164:167], v[16:19], v[80:83]
    s_nop 1
    ds_write_b128 v207, v[140:143] offset:10240
    v_mfma_f32_16x16x32_bf16 v[84:87], v[168:171], v[16:19], v[84:87]
    ds_write_b128 v207, v[144:147] offset:11264
    v_mfma_f32_16x16x32_bf16 v[88:91], v[172:175], v[16:19], v[88:91]
    ds_write_b128 v207, v[148:151] offset:12288
    v_mfma_f32_16x16x32_bf16 v[92:95], v[176:179], v[16:19], v[92:95]
    ds_write_b128 v207, v[152:155] offset:13312
    v_mfma_f32_16x16x32_bf16 v[96:99], v[180:183], v[16:19], v[96:99]
    s_waitcnt lgkmcnt(4)
    s_barrier
    s_waitcnt vmcnt(0)
    v_mfma_f32_16x16x32_bf16 v[80:83], v[184:187], v[32:35], v[80:83]
    ds_read_b128 v[64:67], v204 offset:0
    ds_read_b128 v[68:71], v204 offset:1024
    v_mfma_f32_16x16x32_bf16 v[84:87], v[188:191], v[32:35], v[84:87]
    ds_read_b128 v[72:75], v204 offset:2048
    ds_read_b128 v[76:79], v204 offset:3072
    v_mfma_f32_16x16x32_bf16 v[88:91], v[192:195], v[32:35], v[88:91]
    ds_read_b128 v[208:211], v204 offset:4096
    ds_read_b128 v[212:215], v204 offset:5120
    v_mfma_f32_16x16x32_bf16 v[92:95], v[196:199], v[32:35], v[92:95]
    ds_read_b128 v[216:219], v204 offset:6144
    ds_read_b128 v[220:223], v204 offset:7168
    v_mfma_f32_16x16x32_bf16 v[96:99], v[200:203], v[32:35], v[96:99]
    ds_write_b128 v207, v[156:159] offset:14336
    s_waitcnt lgkmcnt(0)
    s_barrier
    ds_read_b128 v[224:227], v204 offset:8192
    ds_read_b128 v[228:231], v204 offset:9216
    ds_read_b128 v[232:235], v204 offset:10240
    ds_read_b128 v[236:239], v204 offset:11264
    ds_read_b128 v[160:163], v204 offset:12288
    ds_read_b128 v[164:167], v204 offset:13312
    ds_read_b128 v[168:171], v204 offset:14336
    v_pk_add_f32 v[80:81], v[80:81], v[64:65]
    v_pk_add_f32 v[82:83], v[82:83], v[66:67]
    v_pk_add_f32 v[84:85], v[84:85], v[68:69]
    v_pk_add_f32 v[86:87], v[86:87], v[70:71]
    v_pk_add_f32 v[88:89], v[88:89], v[72:73]
    v_pk_add_f32 v[90:91], v[90:91], v[74:75]
    v_pk_add_f32 v[92:93], v[92:93], v[76:77]
    v_pk_add_f32 v[94:95], v[94:95], v[78:79]
    v_pk_add_f32 v[96:97], v[96:97], v[208:209]
    v_pk_add_f32 v[98:99], v[98:99], v[210:211]
    v_pk_add_f32 v[80:81], v[80:81], v[212:213]
    v_pk_add_f32 v[82:83], v[82:83], v[214:215]
    v_pk_add_f32 v[84:85], v[84:85], v[216:217]
    v_pk_add_f32 v[86:87], v[86:87], v[218:219]
    v_pk_add_f32 v[88:89], v[88:89], v[220:221]
    v_pk_add_f32 v[90:91], v[90:91], v[222:223]
    s_waitcnt lgkmcnt(6)
    v_pk_add_f32 v[92:93], v[92:93], v[224:225]
    v_pk_add_f32 v[94:95], v[94:95], v[226:227]
    s_waitcnt lgkmcnt(5)
    v_pk_add_f32 v[96:97], v[96:97], v[228:229]
    v_pk_add_f32 v[98:99], v[98:99], v[230:231]
    s_waitcnt lgkmcnt(4)
    v_pk_add_f32 v[80:81], v[80:81], v[232:233]
    v_pk_add_f32 v[82:83], v[82:83], v[234:235]
    s_waitcnt lgkmcnt(3)
    v_pk_add_f32 v[84:85], v[84:85], v[236:237]
    v_pk_add_f32 v[86:87], v[86:87], v[238:239]
    s_waitcnt lgkmcnt(2)
    v_pk_add_f32 v[88:89], v[88:89], v[160:161]
    v_pk_add_f32 v[90:91], v[90:91], v[162:163]
    s_waitcnt lgkmcnt(1)
    v_pk_add_f32 v[92:93], v[92:93], v[164:165]
    v_pk_add_f32 v[94:95], v[94:95], v[166:167]
    s_waitcnt lgkmcnt(0)
    v_pk_add_f32 v[96:97], v[96:97], v[168:169]
    v_pk_add_f32 v[98:99], v[98:99], v[170:171]
    v_cvt_pk_bf16_f32 v16, v80, v81
    v_cvt_pk_bf16_f32 v17, v82, v83
    v_cvt_pk_bf16_f32 v18, v84, v85
    v_cvt_pk_bf16_f32 v19, v86, v87
    buffer_store_dwordx4 v[16:19], v1, s[8:11], s72 offen offset:0 sc1
    v_cvt_pk_bf16_f32 v20, v88, v89
    v_cvt_pk_bf16_f32 v21, v90, v91
    v_cvt_pk_bf16_f32 v22, v92, v93
    v_cvt_pk_bf16_f32 v23, v94, v95
    buffer_store_dwordx4 v[20:23], v1, s[8:11], s72 offen offset:1024 sc1
    v_cvt_pk_bf16_f32 v24, v96, v97
    v_cvt_pk_bf16_f32 v25, v98, v99
    v_mov_b32 v26, v24
    v_mov_b32 v27, v25
    s_nop 0
    v_permlane16_swap_b32 v24, v26
    v_permlane16_swap_b32 v25, v27
    buffer_store_dwordx4 v[24:27], v11, s[8:11], s72 offen sc1
    v_and_b32 v8, 7, v0
    v_lshrrev_b32 v9, 3, v0
    s_mul_i32 s64, s52, 20
    v_add_u32 v9, s64, v9
    v_lshlrev_b32 v10, 8, v9
    v_lshl_add_u32 v10, v8, 4, v10
    v_add_u32 v11, 2048, v10
    v_add_u32 v12, 4096, v10
    v_mov_b32 v15, 0x80000000
    v_cmp_gt_u32 vcc, 32, v0
    s_nop 1
    v_cndmask_b32 v12, v15, v12, vcc
    v_lshlrev_b32 v14, 5, v8
    v_add_u32 v14, 155648, v14
    s_lshl_b32 s64, s52, 3
    v_add_u32 v13, s64, v14
    s_lshr_b32 s65, s61, 1
    s_mul_i32 s65, s65, 20480
    s_and_b32 s66, s61, 1
    s_lshl_b32 s66, s66, 7
    s_add_u32 s65, s65, s66
    s_lshl_b32 s66, s52, 10
    v_add_u32 v4, s66, v1
    v_add_u32 v4, 131072, v4
    ds_read_b128 v[64:67], v4 offset:0
    ds_read_b128 v[68:71], v4 offset:4096
    ds_read_b128 v[72:75], v4 offset:8192
    ds_read_b128 v[76:79], v4 offset:12288
    ds_read_b128 v[80:83], v4 offset:16384
    ds_read_b128 v[84:87], v4 offset:20480
    s_waitcnt lgkmcnt(0)
    v_lshlrev_b32 v16, 16, v64
    v_and_b32 v17, s60, v64
    v_lshlrev_b32 v18, 16, v65
    v_and_b32 v19, s60, v65
    v_lshlrev_b32 v20, 16, v66
    v_and_b32 v21, s60, v66
    v_lshlrev_b32 v22, 16, v67
    v_and_b32 v23, s60, v67
    v_lshlrev_b32 v24, 16, v68
    v_and_b32 v25, s60, v68
    v_lshlrev_b32 v26, 16, v69
    v_and_b32 v27, s60, v69
    v_lshlrev_b32 v28, 16, v70
    v_and_b32 v29, s60, v70
    v_lshlrev_b32 v30, 16, v71
    v_and_b32 v31, s60, v71
    v_lshlrev_b32 v32, 16, v72
    v_and_b32 v33, s60, v72
    v_lshlrev_b32 v34, 16, v73
    v_and_b32 v35, s60, v73
    v_lshlrev_b32 v36, 16, v74
    v_and_b32 v37, s60, v74
    v_lshlrev_b32 v38, 16, v75
    v_and_b32 v39, s60, v75
    v_lshlrev_b32 v40, 16, v76
    v_and_b32 v41, s60, v76
    v_lshlrev_b32 v42, 16, v77
    v_and_b32 v43, s60, v77
    v_lshlrev_b32 v44, 16, v78
    v_and_b32 v45, s60, v78
    v_lshlrev_b32 v46, 16, v79
    v_and_b32 v47, s60, v79
    v_lshlrev_b32 v48, 16, v80
    v_and_b32 v49, s60, v80
    v_lshlrev_b32 v50, 16, v81
    v_and_b32 v51, s60, v81
    v_lshlrev_b32 v52, 16, v82
    v_and_b32 v53, s60, v82
    v_lshlrev_b32 v54, 16, v83
    v_and_b32 v55, s60, v83
    v_lshlrev_b32 v56, 16, v84
    v_and_b32 v57, s60, v84
    v_lshlrev_b32 v58, 16, v85
    s_branch L_past7
L_page7:
    s_setpc_b64 s[98:99]
L_past7:
    v_and_b32 v59, s60, v85
    v_lshlrev_b32 v60, 16, v86
    v_and_b32 v61, s60, v86
    v_lshlrev_b32 v62, 16, v87
    v_and_b32 v63, s60, v87
    s_add_u32 s66, s65, 14155776
    s_waitcnt vmcnt(0)
    s_barrier
    s_cmp_lg_u32 s52, 0
    s_cbranch_scc1 w081
    s_mov_b64 exec, 1
    v_mov_b32 v6, s71
    v_mov_b32 v7, 1
    global_atomic_add v6, v7, s[40:41] sc1
    s_mov_b64 exec, -1
w081:
    v_mov_b32 v7, s71
    s_add_u32 s86, s85, 163840
    s_add_u32 m0, s87, 0
    s_nop 0
    buffer_load_dwordx4 v1, s[8:11], s86 offen offset:0 sc1 lds
    buffer_load_dwordx4 v1, s[8:11], s86 offen offset:1024 sc1 lds
    buffer_load_dwordx4 v1, s[8:11], s86 offen offset:2048 sc1 lds
    buffer_load_dwordx4 v1, s[8:11], s86 offen offset:3072 sc1 lds
    s_add_u32 s86, s85, 180224
    s_add_u32 m0, s87, 16384
    s_nop 0
    buffer_load_dwordx4 v1, s[8:11], s86 offen offset:0 sc1 lds
    buffer_load_dwordx4 v1, s[8:11], s86 offen offset:1024 sc1 lds
    buffer_load_dwordx4 v1, s[8:11], s86 offen offset:2048 sc1 lds
    buffer_load_dwordx4 v1, s[8:11], s86 offen offset:3072 sc1 lds
    s_add_u32 s86, s85, 196608
    s_add_u32 m0, s87, 32768
    s_nop 0
    buffer_load_dwordx4 v1, s[8:11], s86 offen offset:0 sc1 lds
    buffer_load_dwordx4 v1, s[8:11], s86 offen offset:1024 sc1 lds
    buffer_load_dwordx4 v1, s[8:11], s86 offen offset:2048 sc1 lds
    buffer_load_dwordx4 v1, s[8:11], s86 offen offset:3072 sc1 lds
    s_cmp_lg_u32 s52, 0
    s_cbranch_scc1 w082
    s_mov_b32 s84, 0
spin83:
    global_load_dword v6, v7, s[40:41] sc1
    s_add_u32 s84, s84, 1
    s_cmp_gt_u32 s84, 2000000
    s_cbranch_scc1 spun84
    s_waitcnt vmcnt(0)
    v_cmp_gt_u32 vcc, 8, v6
    s_cbranch_vccnz spin83
spun84:
    s_waitcnt vmcnt(0)
w082:
    s_barrier
    s_mov_b32 s96, 0x4091afa4
    buffer_load_dwordx4 v[64:67], v10, s[8:11], s66 offen sc1
    buffer_load_dwordx4 v[68:71], v11, s[8:11], s66 offen sc1
    buffer_load_dwordx4 v[72:75], v12, s[8:11], s66 offen sc1
    s_add_u32 s86, s85, 212992
    s_add_u32 m0, s87, 49152
    s_nop 0
    buffer_load_dwordx4 v1, s[8:11], s86 offen offset:0 sc1 lds
    buffer_load_dwordx4 v1, s[8:11], s86 offen offset:1024 sc1 lds
    buffer_load_dwordx4 v1, s[8:11], s86 offen offset:2048 sc1 lds
    buffer_load_dwordx4 v1, s[8:11], s86 offen offset:3072 sc1 lds
    s_waitcnt vmcnt(4)
    v_lshlrev_b32 v88, 16, v64
    v_and_b32 v89, s60, v64
    v_lshlrev_b32 v90, 16, v65
    v_and_b32 v91, s60, v65
    v_lshlrev_b32 v92, 16, v66
    v_and_b32 v93, s60, v66
    v_lshlrev_b32 v94, 16, v67
    v_and_b32 v95, s60, v67
    v_lshlrev_b32 v96, 16, v68
    v_and_b32 v97, s60, v68
    v_lshlrev_b32 v98, 16, v69
    v_and_b32 v99, s60, v69
    v_lshlrev_b32 v100, 16, v70
    v_and_b32 v101, s60, v70
    v_lshlrev_b32 v102, 16, v71
    v_and_b32 v103, s60, v71
    v_lshlrev_b32 v104, 16, v72
    v_and_b32 v105, s60, v72
    v_lshlrev_b32 v106, 16, v73
    v_and_b32 v107, s60, v73
    v_lshlrev_b32 v108, 16, v74
    v_and_b32 v109, s60, v74
    v_lshlrev_b32 v110, 16, v75
    v_and_b32 v111, s60, v75
    v_pk_fma_f32 v[16:17], v[88:89], s[96:97], v[16:17] op_sel_hi:[1,0,1]
    v_pk_fma_f32 v[18:19], v[90:91], s[96:97], v[18:19] op_sel_hi:[1,0,1]
    v_pk_fma_f32 v[20:21], v[92:93], s[96:97], v[20:21] op_sel_hi:[1,0,1]
    v_pk_fma_f32 v[22:23], v[94:95], s[96:97], v[22:23] op_sel_hi:[1,0,1]
    v_pk_fma_f32 v[24:25], v[96:97], s[96:97], v[24:25] op_sel_hi:[1,0,1]
    v_pk_fma_f32 v[26:27], v[98:99], s[96:97], v[26:27] op_sel_hi:[1,0,1]
    v_pk_fma_f32 v[28:29], v[100:101], s[96:97], v[28:29] op_sel_hi:[1,0,1]
    v_pk_fma_f32 v[30:31], v[102:103], s[96:97], v[30:31] op_sel_hi:[1,0,1]
    v_pk_fma_f32 v[32:33], v[104:105], s[96:97], v[32:33] op_sel_hi:[1,0,1]
    v_pk_fma_f32 v[34:35], v[106:107], s[96:97], v[34:35] op_sel_hi:[1,0,1]
    v_pk_fma_f32 v[36:37], v[108:109], s[96:97], v[36:37] op_sel_hi:[1,0,1]
    v_pk_fma_f32 v[38:39], v[110:111], s[96:97], v[38:39] op_sel_hi:[1,0,1]
    v_pk_add_f32 v[112:113], v[16:17], v[18:19]
    v_pk_mul_f32 v[114:115], v[16:17], v[16:17]
    v_pk_fma_f32 v[114:115], v[18:19], v[18:19], v[114:115]
    v_pk_add_f32 v[112:113], v[112:113], v[20:21]
    v_pk_fma_f32 v[114:115], v[20:21], v[20:21], v[114:115]
    v_pk_add_f32 v[112:113], v[112:113], v[22:23]
    v_pk_fma_f32 v[114:115], v[22:23], v[22:23], v[114:115]
    v_pk_add_f32 v[112:113], v[112:113], v[24:25]
    v_pk_fma_f32 v[114:115], v[24:25], v[24:25], v[114:115]
    v_pk_add_f32 v[112:113], v[112:113], v[26:27]
    v_pk_fma_f32 v[114:115], v[26:27], v[26:27], v[114:115]
    v_pk_add_f32 v[112:113], v[112:113], v[28:29]
    v_pk_fma_f32 v[114:115], v[28:29], v[28:29], v[114:115]
    v_pk_add_f32 v[112:113], v[112:113], v[30:31]
    v_pk_fma_f32 v[114:115], v[30:31], v[30:31], v[114:115]
    v_pk_add_f32 v[112:113], v[112:113], v[32:33]
    v_pk_fma_f32 v[114:115], v[32:33], v[32:33], v[114:115]
    v_pk_add_f32 v[112:113], v[112:113], v[34:35]
    v_pk_fma_f32 v[114:115], v[34:35], v[34:35], v[114:115]
    v_pk_add_f32 v[112:113], v[112:113], v[36:37]
    v_pk_fma_f32 v[114:115], v[36:37], v[36:37], v[114:115]
    v_pk_add_f32 v[112:113], v[112:113], v[38:39]
    v_pk_fma_f32 v[114:115], v[38:39], v[38:39], v[114:115]
    v_add_f32 v112, v112, v113
    v_add_f32 v113, v114, v115
    s_nop 0
    v_add_f32_dpp v112, v112, v112 row_ror:8 row_mask:0xf bank_mask:0xf
    v_add_f32_dpp v113, v113, v113 row_ror:8 row_mask:0xf bank_mask:0xf
    v_mov_b32 v114, v112
    v_mov_b32 v115, v113
    s_nop 0
    v_permlane16_swap_b32 v112, v114
    v_permlane16_swap_b32 v113, v115
    v_add_f32 v112, v112, v114
    v_add_f32 v113, v113, v115
    v_mov_b32 v114, v112
    v_mov_b32 v115, v113
    s_nop 0
    v_permlane32_swap_b32 v112, v114
    v_permlane32_swap_b32 v113, v115
    v_add_f32 v112, v112, v114
    v_add_f32 v113, v113, v115
    s_mov_b64 exec, 0xff
    ds_write_b64 v13, v[112:113] offset:0
    s_mov_b64 exec, -1
    s_waitcnt lgkmcnt(0)
    s_barrier
    ds_read_b128 v[112:115], v14 offset:0
    ds_read_b128 v[116:119], v14 offset:16
    s_waitcnt lgkmcnt(0)
    v_pk_add_f32 v[112:113], v[112:113], v[114:115]
    v_pk_add_f32 v[116:117], v[116:117], v[118:119]
    v_pk_add_f32 v[112:113], v[112:113], v[116:117]
    v_mul_f32 v112, 0x3acccccd, v112
    v_mul_f32 v113, 0x3acccccd, v113
    v_fma_f32 v113, -v112, v112, v113
    v_max_f32 v113, 0, v113
    v_add_f32 v113, 0x3727c5ac, v113
    v_rsq_f32 v120, v113
    s_nop 0
    v_mul_f32_e64 v121, -v112, v120
    v_pk_fma_f32 v[88:89], v[16:17], v[120:121], v[120:121] op_sel:[0,0,1] op_sel_hi:[1,0,1]
    v_pk_fma_f32 v[90:91], v[18:19], v[120:121], v[120:121] op_sel:[0,0,1] op_sel_hi:[1,0,1]
    v_pk_fma_f32 v[92:93], v[20:21], v[120:121], v[120:121] op_sel:[0,0,1] op_sel_hi:[1,0,1]
    v_pk_fma_f32 v[94:95], v[22:23], v[120:121], v[120:121] op_sel:[0,0,1] op_sel_hi:[1,0,1]
    v_pk_fma_f32 v[96:97], v[24:25], v[120:121], v[120:121] op_sel:[0,0,1] op_sel_hi:[1,0,1]
    v_pk_fma_f32 v[98:99], v[26:27], v[120:121], v[120:121] op_sel:[0,0,1] op_sel_hi:[1,0,1]
    v_pk_fma_f32 v[100:101], v[28:29], v[120:121], v[120:121] op_sel:[0,0,1] op_sel_hi:[1,0,1]
    v_pk_fma_f32 v[102:103], v[30:31], v[120:121], v[120:121] op_sel:[0,0,1] op_sel_hi:[1,0,1]
    v_pk_fma_f32 v[104:105], v[32:33], v[120:121], v[120:121] op_sel:[0,0,1] op_sel_hi:[1,0,1]
    v_pk_fma_f32 v[106:107], v[34:35], v[120:121], v[120:121] op_sel:[0,0,1] op_sel_hi:[1,0,1]
    v_pk_fma_f32 v[108:109], v[36:37], v[120:121], v[120:121] op_sel:[0,0,1] op_sel_hi:[1,0,1]
    v_pk_fma_f32 v[110:111], v[38:39], v[120:121], v[120:121] op_sel:[0,0,1] op_sel_hi:[1,0,1]
    v_pk_fma_f32 v[16:17], v[88:89], v[40:41], v[16:17]
    v_pk_fma_f32 v[18:19], v[90:91], v[42:43], v[18:19]
    v_pk_fma_f32 v[20:21], v[92:93], v[44:45], v[20:21]
    v_pk_fma_f32 v[22:23], v[94:95], v[46:47], v[22:23]
    v_pk_fma_f32 v[24:25], v[96:97], v[48:49], v[24:25]
    v_pk_fma_f32 v[26:27], v[98:99], v[50:51], v[26:27]
    v_pk_fma_f32 v[28:29], v[100:101], v[52:53], v[28:29]
    v_pk_fma_f32 v[30:31], v[102:103], v[54:55], v[30:31]
    v_pk_fma_f32 v[32:33], v[104:105], v[56:57], v[32:33]
    v_pk_fma_f32 v[34:35], v[106:107], v[58:59], v[34:35]
    v_pk_fma_f32 v[36:37], v[108:109], v[60:61], v[36:37]
    v_pk_fma_f32 v[38:39], v[110:111], v[62:63], v[38:39]
    v_pk_add_f32 v[112:113], v[16:17], v[18:19]
    v_pk_mul_f32 v[114:115], v[16:17], v[16:17]
    v_pk_fma_f32 v[114:115], v[18:19], v[18:19], v[114:115]
    v_pk_add_f32 v[112:113], v[112:113], v[20:21]
    v_pk_fma_f32 v[114:115], v[20:21], v[20:21], v[114:115]
    v_pk_add_f32 v[112:113], v[112:113], v[22:23]
    v_pk_fma_f32 v[114:115], v[22:23], v[22:23], v[114:115]
    v_pk_add_f32 v[112:113], v[112:113], v[24:25]
    v_pk_fma_f32 v[114:115], v[24:25], v[24:25], v[114:115]
    v_pk_add_f32 v[112:113], v[112:113], v[26:27]
    v_pk_fma_f32 v[114:115], v[26:27], v[26:27], v[114:115]
    v_pk_add_f32 v[112:113], v[112:113], v[28:29]
    v_pk_fma_f32 v[114:115], v[28:29], v[28:29], v[114:115]
    v_pk_add_f32 v[112:113], v[112:113], v[30:31]
    v_pk_fma_f32 v[114:115], v[30:31], v[30:31], v[114:115]
    v_pk_add_f32 v[112:113], v[112:113], v[32:33]
    v_pk_fma_f32 v[114:115], v[32:33], v[32:33], v[114:115]
    v_pk_add_f32 v[112:113], v[112:113], v[34:35]
    v_pk_fma_f32 v[114:115], v[34:35], v[34:35], v[114:115]
    v_pk_add_f32 v[112:113], v[112:113], v[36:37]
    v_pk_fma_f32 v[114:115], v[36:37], v[36:37], v[114:115]
    v_pk_add_f32 v[112:113], v[112:113], v[38:39]
    v_pk_fma_f32 v[114:115], v[38:39], v[38:39], v[114:115]
    v_add_f32 v112, v112, v113
    v_add_f32 v113, v114, v115
    s_nop 0
    v_add_f32_dpp v112, v112, v112 row_ror:8 row_mask:0xf bank_mask:0xf
    v_add_f32_dpp v113, v113, v113 row_ror:8 row_mask:0xf bank_mask:0xf
    v_mov_b32 v114, v112
    v_mov_b32 v115, v113
    s_nop 0
    v_permlane16_swap_b32 v112, v114
    v_permlane16_swap_b32 v113, v115
    v_add_f32 v112, v112, v114
    v_add_f32 v113, v113, v115
    v_mov_b32 v114, v112
    v_mov_b32 v115, v113
    s_nop 0
    v_permlane32_swap_b32 v112, v114
    v_permlane32_swap_b32 v113, v115
    v_add_f32 v112, v112, v114
    v_add_f32 v113, v113, v115
    s_mov_b64 exec, 0xff
    ds_write_b64 v13, v[112:113] offset:256
    s_mov_b64 exec, -1
    s_waitcnt lgkmcnt(0)
    s_barrier
    ds_read_b128 v[112:115], v14 offset:256
    ds_read_b128 v[116:119], v14 offset:272
    s_waitcnt lgkmcnt(0)
    v_pk_add_f32 v[112:113], v[112:113], v[114:115]
    v_pk_add_f32 v[116:117], v[116:117], v[118:119]
    v_pk_add_f32 v[112:113], v[112:113], v[116:117]
    v_mul_f32 v112, 0x3acccccd, v112
    v_mul_f32 v113, 0x3acccccd, v113
    v_fma_f32 v113, -v112, v112, v113
    v_max_f32 v113, 0, v113
    v_add_f32 v113, 0x3727c5ac, v113
    v_rsq_f32 v120, v113
    s_nop 0
    v_mul_f32 v120, 0x3eeff558, v120
    v_mul_f32_e64 v121, -v112, v120
    v_pk_fma_f32 v[88:89], v[16:17], v[120:121], v[120:121] op_sel:[0,0,1] op_sel_hi:[1,0,1]
    v_pk_fma_f32 v[90:91], v[18:19], v[120:121], v[120:121] op_sel:[0,0,1] op_sel_hi:[1,0,1]
    v_pk_fma_f32 v[92:93], v[20:21], v[120:121], v[120:121] op_sel:[0,0,1] op_sel_hi:[1,0,1]
    v_pk_fma_f32 v[94:95], v[22:23], v[120:121], v[120:121] op_sel:[0,0,1] op_sel_hi:[1,0,1]
    v_pk_fma_f32 v[96:97], v[24:25], v[120:121], v[120:121] op_sel:[0,0,1] op_sel_hi:[1,0,1]
    v_pk_fma_f32 v[98:99], v[26:27], v[120:121], v[120:121] op_sel:[0,0,1] op_sel_hi:[1,0,1]
    v_pk_fma_f32 v[100:101], v[28:29], v[120:121], v[120:121] op_sel:[0,0,1] op_sel_hi:[1,0,1]
    v_pk_fma_f32 v[102:103], v[30:31], v[120:121], v[120:121] op_sel:[0,0,1] op_sel_hi:[1,0,1]
    v_pk_fma_f32 v[104:105], v[32:33], v[120:121], v[120:121] op_sel:[0,0,1] op_sel_hi:[1,0,1]
    v_pk_fma_f32 v[106:107], v[34:35], v[120:121], v[120:121] op_sel:[0,0,1] op_sel_hi:[1,0,1]
    v_pk_fma_f32 v[108:109], v[36:37], v[120:121], v[120:121] op_sel:[0,0,1] op_sel_hi:[1,0,1]
    v_pk_fma_f32 v[110:111], v[38:39], v[120:121], v[120:121] op_sel:[0,0,1] op_sel_hi:[1,0,1]
    s_add_u32 s66, s65, 8912896
    v_cvt_pk_bf16_f32 v64, v88, v89
    v_cvt_pk_bf16_f32 v65, v90, v91
    v_cvt_pk_bf16_f32 v66, v92, v93
    v_cvt_pk_bf16_f32 v67, v94, v95
    buffer_store_dwordx4 v[64:67], v10, s[8:11], s66 offen sc1
    v_cvt_pk_bf16_f32 v68, v96, v97
    v_cvt_pk_bf16_f32 v69, v98, v99
    v_cvt_pk_bf16_f32 v70, v100, v101
    v_cvt_pk_bf16_f32 v71, v102, v103
    buffer_store_dwordx4 v[68:71], v11, s[8:11], s66 offen sc1
    v_cvt_pk_bf16_f32 v72, v104, v105
    v_cvt_pk_bf16_f32 v73, v106, v107
    v_cvt_pk_bf16_f32 v74, v108, v109
    v_cvt_pk_bf16_f32 v75, v110, v111
    buffer_store_dwordx4 v[72:75], v12, s[8:11], s66 offen sc1
    v_cvt_pk_bf16_f32 v76, v16, v17
    v_cvt_pk_bf16_f32 v77, v18, v19
    v_cvt_pk_bf16_f32 v78, v20, v21
    v_cvt_pk_bf16_f32 v79, v22, v23
    v_cvt_pk_bf16_f32 v80, v24, v25
    v_cvt_pk_bf16_f32 v81, v26, v27
    v_cvt_pk_bf16_f32 v82, v28, v29
    v_cvt_pk_bf16_f32 v83, v30, v31
    v_cvt_pk_bf16_f32 v84, v32, v33
    v_cvt_pk_bf16_f32 v85, v34, v35
    v_cvt_pk_bf16_f32 v86, v36, v37
    v_cvt_pk_bf16_f32 v87, v38, v39
    s_add_u32 s66, s65, 11534336
    buffer_store_dwordx4 v[76:79], v10, s[8:11], s66 offen sc1
    buffer_store_dwordx4 v[80:83], v11, s[8:11], s66 offen sc1
    buffer_store_dwordx4 v[84:87], v12, s[8:11], s66 offen sc1
    s_lshl_b32 s64, s55, 8
    s_add_u32 s64, s64, 4224
    s_waitcnt vmcnt(3)
    s_barrier
    s_cmp_lg_u32 s52, 0
    s_cbranch_scc1 w085
    s_mov_b64 exec, 1
    v_mov_b32 v6, s64
    v_mov_b32 v7, 1
    global_atomic_add v6, v7, s[40:41] sc1
    s_mov_b64 exec, -1
w085:
    v_mov_b32 v7, s64
    s_add_u32 s86, s85, 229376
    s_add_u32 m0, s87, 65536
    s_nop 0
    buffer_load_dwordx4 v1, s[8:11], s86 offen offset:0 sc1 lds
    buffer_load_dwordx4 v1, s[8:11], s86 offen offset:1024 sc1 lds
    buffer_load_dwordx4 v1, s[8:11], s86 offen offset:2048 sc1 lds
    buffer_load_dwordx4 v1, s[8:11], s86 offen offset:3072 sc1 lds
    s_add_u32 s86, s85, 81920
    s_add_u32 m0, s87, 81920
    s_nop 0
    buffer_load_dwordx4 v1, s[8:11], s86 offen offset:0 sc1 lds
    buffer_load_dwordx4 v1, s[8:11], s86 offen offset:1024 sc1 lds
    buffer_load_dwordx4 v1, s[8:11], s86 offen offset:2048 sc1 lds
    buffer_load_dwordx4 v1, s[8:11], s86 offen offset:3072 sc1 lds
    s_add_u32 s86, s85, 98304
    s_add_u32 m0, s87, 98304
    s_nop 0
    buffer_load_dwordx4 v1, s[8:11], s86 offen offset:0 sc1 lds
    buffer_load_dwordx4 v1, s[8:11], s86 offen offset:1024 sc1 lds
    buffer_load_dwordx4 v1, s[8:11], s86 offen offset:2048 sc1 lds
    buffer_load_dwordx4 v1, s[8:11], s86 offen offset:3072 sc1 lds
    s_add_u32 s86, s85, 114688
    s_add_u32 m0, s87, 114688
    s_nop 0
    buffer_load_dwordx4 v1, s[8:11], s86 offen offset:0 sc1 lds
    buffer_load_dwordx4 v1, s[8:11], s86 offen offset:1024 sc1 lds
    buffer_load_dwordx4 v1, s[8:11], s86 offen offset:2048 sc1 lds
    buffer_load_dwordx4 v1, s[8:11], s86 offen offset:3072 sc1 lds
    v_add_u32 v2, 0x10000, v1
    v_mov_b32 v4, 0x409d30fc
    v_bfe_u32 v8, v0, 4, 1
    v_mul_u32_u24 v3, 57344, v8
    v_lshrrev_b32 v8, 5, v0
    v_lshl_add_u32 v3, v8, 8, v3
    v_and_b32 v8, 15, v0
    v_lshl_add_u32 v3, v8, 4, v3
    s_lshl_b32 s64, s55, 3
    s_lshl_b32 s65, s52, 1
    s_add_u32 s65, s65, s64
    s_mul_i32 s74, s65, 20480
    s_add_u32 s74, s74, 8912896
    s_add_u32 s75, s74, 20480
    s_mul_i32 s65, s65, 57344
    s_lshr_b32 s66, s62, 2
    s_mul_i32 s66, s66, 14336
    s_add_u32 s65, s65, s66
    s_add_u32 s65, s65, 24117248
    s_and_b32 s66, s62, 3
    s_lshl_b32 s67, s66, 10
    s_add_u32 s92, s65, s67
    s_add_u32 s80, s92, 57344
    s_lshl_b32 s67, s66, 9
    s_add_u32 s93, s65, s67
    s_add_u32 s93, s93, 12288
    s_lshl_b32 s65, s56, 2
    s_add_u32 s64, s64, s65
    s_mul_i32 s66, s52, 14336
    s_add_u32 s66, s66, 24117248
    s_add_u32 s65, s52, 0
    s_and_b32 s65, s65, 3
    s_add_u32 s65, s65, s64
    s_mul_i32 s65, s65, 57344
    s_add_u32 s88, s65, s66
    s_add_u32 s65, s52, 1
    s_and_b32 s65, s65, 3
    s_add_u32 s65, s65, s64
    s_mul_i32 s65, s65, 57344
    s_add_u32 s89, s65, s66
    s_add_u32 s65, s52, 2
    s_and_b32 s65, s65, 3
    s_add_u32 s65, s65, s64
    s_mul_i32 s65, s65, 57344
    s_add_u32 s90, s65, s66
    s_add_u32 s65, s52, 3
    s_and_b32 s65, s65, 3
    s_add_u32 s65, s65, s64
    s_mul_i32 s65, s65, 57344
    s_add_u32 s91, s65, s66
    s_and_b32 s65, s57, 1
    s_lshl_b32 s65, s65, 1
    s_add_u32 s65, s65, s64
    s_lshr_b32 s66, s52, 1
    s_add_u32 s65, s65, s66
    s_mul_i32 s79, s65, 57344
    s_lshr_b32 s65, s57, 1
    s_mul_i32 s65, s65, 14336
    s_add_u32 s79, s79, s65
    s_add_u32 s79, s79, 24117248
    s_and_b32 s65, s52, 1
    s_lshl_b32 s66, s65, 11
    v_lshlrev_b32 v250, 7, v8
    v_and_b32 v251, 0x380, v250
    v_add_u32 v250, s66, v250
    s_lshl_b32 s66, s65, 10
    v_add_u32 v251, s66, v251
    s_mul_i32 s76, s55, 3
    s_lshl_b32 s76, s76, 8
    s_add_u32 s76, s76, 28800
    v_mov_b32 v244, s76
    v_add_u32 v245, 64, v244
    v_add_u32 v246, 256, v244
    v_add_u32 v248, 512, v244
    s_cmp_lg_u32 s52, 0
    s_cbranch_scc1 w086
    s_mov_b32 s84, 0
spin87:
    global_load_dword v6, v7, s[40:41] sc1
    s_add_u32 s84, s84, 1
    s_cmp_gt_u32 s84, 2000000
    s_cbranch_scc1 spun88
    s_waitcnt vmcnt(0)
    v_cmp_gt_u32 vcc, 16, v6
    s_cbranch_vccnz spin87
spun88:
    s_waitcnt vmcnt(0)
w086:
    s_barrier
    s_add_u32 s92, s92, 8192
    s_add_u32 s80, s80, 8192
    s_add_u32 s88, s88, 8192
    s_add_u32 s89, s89, 8192
    s_add_u32 s90, s90, 8192
    s_add_u32 s91, s91, 8192
    buffer_load_dwordx4 v[16:19], v1, s[8:11], s74 offen offset:0 sc1
    buffer_load_dwordx4 v[20:23], v1, s[8:11], s75 offen offset:0 sc1
    buffer_load_dwordx4 v[24:27], v1, s[8:11], s74 offen offset:1024 sc1
    buffer_load_dwordx4 v[28:31], v1, s[8:11], s75 offen offset:1024 sc1
    buffer_load_dwordx4 v[32:35], v1, s[8:11], s74 offen offset:2048 sc1
    buffer_load_dwordx4 v[36:39], v1, s[8:11], s75 offen offset:2048 sc1
    buffer_load_dwordx4 v[40:43], v1, s[8:11], s74 offen offset:3072 sc1
    s_add_u32 s74, s74, 4096
    buffer_load_dwordx4 v[44:47], v1, s[8:11], s75 offen offset:3072 sc1
    s_add_u32 s75, s75, 4096
    buffer_load_dwordx4 v[48:51], v1, s[8:11], s74 offen offset:0 sc1
    buffer_load_dwordx4 v[52:55], v1, s[8:11], s75 offen offset:0 sc1
    s_barrier
    ds_read_b128 a[220:223], v1 offset:0
    ds_read_b128 a[224:227], v1 offset:1024
    ds_read_b128 a[228:231], v1 offset:2048
    ds_read_b128 a[232:235], v1 offset:3072
    ds_read_b128 a[236:239], v1 offset:4096
    ds_read_b128 a[240:243], v1 offset:5120
    ds_read_b128 a[244:247], v1 offset:6144
    ds_read_b128 a[248:251], v1 offset:7168
    ds_read_b128 a[252:255], v1 offset:8192
    s_waitcnt vmcnt(8) lgkmcnt(5)
    v_mfma_f32_16x16x32_bf16 v[176:179], a[220:223], v[16:19], 0
    buffer_load_dwordx4 v[56:59], v1, s[8:11], s74 offen offset:1024 sc1
    v_mfma_f32_16x16x32_bf16 v[192:195], a[220:223], v[20:23], 0
    ds_read_b128 a[220:223], v1 offset:9216
    v_mfma_f32_16x16x32_bf16 v[184:187], a[224:227], v[16:19], 0
    v_mfma_f32_16x16x32_bf16 v[200:203], a[224:227], v[20:23], 0
    ds_read_b128 a[224:227], v1 offset:10240
    v_mfma_f32_16x16x32_bf16 v[180:183], a[228:231], v[16:19], 0
    buffer_load_dwordx4 v[60:63], v1, s[8:11], s75 offen offset:1024 sc1
    v_mfma_f32_16x16x32_bf16 v[196:199], a[228:231], v[20:23], 0
    ds_read_b128 a[228:231], v1 offset:11264
    v_mfma_f32_16x16x32_bf16 v[188:191], a[232:235], v[16:19], 0
    v_mfma_f32_16x16x32_bf16 v[204:207], a[232:235], v[20:23], 0
    ds_read_b128 a[232:235], v1 offset:12288
    s_waitcnt vmcnt(8) lgkmcnt(5)
    v_mfma_f32_16x16x32_bf16 v[176:179], a[236:239], v[24:27], v[176:179]
    buffer_load_dwordx4 v[64:67], v1, s[8:11], s74 offen offset:2048 sc1
    v_mfma_f32_16x16x32_bf16 v[192:195], a[236:239], v[28:31], v[192:195]
    ds_read_b128 a[236:239], v1 offset:13312
    v_mfma_f32_16x16x32_bf16 v[184:187], a[240:243], v[24:27], v[184:187]
    v_mfma_f32_16x16x32_bf16 v[200:203], a[240:243], v[28:31], v[200:203]
    ds_read_b128 a[240:243], v1 offset:14336
    v_mfma_f32_16x16x32_bf16 v[180:183], a[244:247], v[24:27], v[180:183]
    buffer_load_dwordx4 v[68:71], v1, s[8:11], s75 offen offset:2048 sc1
    v_mfma_f32_16x16x32_bf16 v[196:199], a[244:247], v[28:31], v[196:199]
    ds_read_b128 a[244:247], v1 offset:15360
    v_mfma_f32_16x16x32_bf16 v[188:191], a[248:251], v[24:27], v[188:191]
    v_mfma_f32_16x16x32_bf16 v[204:207], a[248:251], v[28:31], v[204:207]
    ds_read_b128 a[248:251], v1 offset:16384
    s_waitcnt vmcnt(8) lgkmcnt(5)
    v_mfma_f32_16x16x32_bf16 v[176:179], a[252:255], v[32:35], v[176:179]
    buffer_load_dwordx4 v[72:75], v1, s[8:11], s74 offen offset:3072 sc1
    s_add_u32 s74, s74, 4096
    v_mfma_f32_16x16x32_bf16 v[192:195], a[252:255], v[36:39], v[192:195]
    ds_read_b128 a[252:255], v1 offset:17408
    v_mfma_f32_16x16x32_bf16 v[184:187], a[220:223], v[32:35], v[184:187]
    v_mfma_f32_16x16x32_bf16 v[200:203], a[220:223], v[36:39], v[200:203]
    ds_read_b128 a[220:223], v1 offset:18432
    v_mfma_f32_16x16x32_bf16 v[180:183], a[224:227], v[32:35], v[180:183]
    buffer_load_dwordx4 v[76:79], v1, s[8:11], s75 offen offset:3072 sc1
    s_add_u32 s75, s75, 4096
    v_mfma_f32_16x16x32_bf16 v[196:199], a[224:227], v[36:39], v[196:199]
    ds_read_b128 a[224:227], v1 offset:19456
    v_mfma_f32_16x16x32_bf16 v[188:191], a[228:231], v[32:35], v[188:191]
    v_mfma_f32_16x16x32_bf16 v[204:207], a[228:231], v[36:39], v[204:207]
    ds_read_b128 a[228:231], v1 offset:20480
    s_waitcnt vmcnt(8) lgkmcnt(5)
    v_mfma_f32_16x16x32_bf16 v[176:179], a[232:235], v[40:43], v[176:179]
    buffer_load_dwordx4 v[80:83], v1, s[8:11], s74 offen offset:0 sc1
    v_mfma_f32_16x16x32_bf16 v[192:195], a[232:235], v[44:47], v[192:195]
    ds_read_b128 a[232:235], v1 offset:21504
    v_mfma_f32_16x16x32_bf16 v[184:187], a[236:239], v[40:43], v[184:187]
    v_mfma_f32_16x16x32_bf16 v[200:203], a[236:239], v[44:47], v[200:203]
    ds_read_b128 a[236:239], v1 offset:22528
    v_mfma_f32_16x16x32_bf16 v[180:183], a[240:243], v[40:43], v[180:183]
    buffer_load_dwordx4 v[84:87], v1, s[8:11], s75 offen offset:0 sc1
    v_mfma_f32_16x16x32_bf16 v[196:199], a[240:243], v[44:47], v[196:199]
    ds_read_b128 a[240:243], v1 offset:23552
    v_mfma_f32_16x16x32_bf16 v[188:191], a[244:247], v[40:43], v[188:191]
    v_mfma_f32_16x16x32_bf16 v[204:207], a[244:247], v[44:47], v[204:207]
    ds_read_b128 a[244:247], v1 offset:24576
    s_waitcnt vmcnt(8) lgkmcnt(5)
    v_mfma_f32_16x16x32_bf16 v[176:179], a[248:251], v[48:51], v[176:179]
    buffer_load_dwordx4 v[88:91], v1, s[8:11], s74 offen offset:1024 sc1
    v_mfma_f32_16x16x32_bf16 v[192:195], a[248:251], v[52:55], v[192:195]
    ds_read_b128 a[248:251], v1 offset:25600
    v_mfma_f32_16x16x32_bf16 v[184:187], a[252:255], v[48:51], v[184:187]
    v_mfma_f32_16x16x32_bf16 v[200:203], a[252:255], v[52:55], v[200:203]
    ds_read_b128 a[252:255], v1 offset:26624
    v_mfma_f32_16x16x32_bf16 v[180:183], a[220:223], v[48:51], v[180:183]
    buffer_load_dwordx4 v[92:95], v1, s[8:11], s75 offen offset:1024 sc1
    v_mfma_f32_16x16x32_bf16 v[196:199], a[220:223], v[52:55], v[196:199]
    ds_read_b128 a[220:223], v1 offset:27648
    v_mfma_f32_16x16x32_bf16 v[188:191], a[224:227], v[48:51], v[188:191]
    v_mfma_f32_16x16x32_bf16 v[204:207], a[224:227], v[52:55], v[204:207]
    ds_read_b128 a[224:227], v1 offset:28672
    s_waitcnt vmcnt(8) lgkmcnt(5)
    v_mfma_f32_16x16x32_bf16 v[176:179], a[228:231], v[56:59], v[176:179]
    buffer_load_dwordx4 v[96:99], v1, s[8:11], s74 offen offset:2048 sc1
    v_mfma_f32_16x16x32_bf16 v[192:195], a[228:231], v[60:63], v[192:195]
    ds_read_b128 a[228:231], v1 offset:29696
    v_mfma_f32_16x16x32_bf16 v[184:187], a[232:235], v[56:59], v[184:187]
    v_mfma_f32_16x16x32_bf16 v[200:203], a[232:235], v[60:63], v[200:203]
    ds_read_b128 a[232:235], v1 offset:30720
    v_mfma_f32_16x16x32_bf16 v[180:183], a[236:239], v[56:59], v[180:183]
    buffer_load_dwordx4 v[100:103], v1, s[8:11], s75 offen offset:2048 sc1
    v_mfma_f32_16x16x32_bf16 v[196:199], a[236:239], v[60:63], v[196:199]
    ds_read_b128 a[236:239], v1 offset:31744
    v_mfma_f32_16x16x32_bf16 v[188:191], a[240:243], v[56:59], v[188:191]
    v_mfma_f32_16x16x32_bf16 v[204:207], a[240:243], v[60:63], v[204:207]
    s_barrier
    ds_read_b128 a[240:243], v1 offset:32768
    s_waitcnt vmcnt(8) lgkmcnt(5)
    v_mfma_f32_16x16x32_bf16 v[176:179], a[244:247], v[64:67], v[176:179]
    buffer_load_dwordx4 v[104:107], v1, s[8:11], s74 offen offset:3072 sc1
    s_add_u32 s74, s74, 4096
    v_mfma_f32_16x16x32_bf16 v[192:195], a[244:247], v[68:71], v[192:195]
    ds_read_b128 a[244:247], v1 offset:33792
    v_mfma_f32_16x16x32_bf16 v[184:187], a[248:251], v[64:67], v[184:187]
    v_mfma_f32_16x16x32_bf16 v[200:203], a[248:251], v[68:71], v[200:203]
    ds_read_b128 a[248:251], v1 offset:34816
    v_mfma_f32_16x16x32_bf16 v[180:183], a[252:255], v[64:67], v[180:183]
    buffer_load_dwordx4 v[108:111], v1, s[8:11], s75 offen offset:3072 sc1
    s_add_u32 s75, s75, 4096
    v_mfma_f32_16x16x32_bf16 v[196:199], a[252:255], v[68:71], v[196:199]
    ds_read_b128 a[252:255], v1 offset:35840
    v_mfma_f32_16x16x32_bf16 v[188:191], a[220:223], v[64:67], v[188:191]
    v_mfma_f32_16x16x32_bf16 v[204:207], a[220:223], v[68:71], v[204:207]
    ds_read_b128 a[220:223], v1 offset:36864
    s_waitcnt vmcnt(8) lgkmcnt(5)
    v_mfma_f32_16x16x32_bf16 v[176:179], a[224:227], v[72:75], v[176:179]
    buffer_load_dwordx4 v[112:115], v1, s[8:11], s74 offen offset:0 sc1
    v_mfma_f32_16x16x32_bf16 v[192:195], a[224:227], v[76:79], v[192:195]
    ds_read_b128 a[224:227], v1 offset:37888
    v_mfma_f32_16x16x32_bf16 v[184:187], a[228:231], v[72:75], v[184:187]
    v_mfma_f32_16x16x32_bf16 v[200:203], a[228:231], v[76:79], v[200:203]
    ds_read_b128 a[228:231], v1 offset:38912
    v_mfma_f32_16x16x32_bf16 v[180:183], a[232:235], v[72:75], v[180:183]
    buffer_load_dwordx4 v[116:119], v1, s[8:11], s75 offen offset:0 sc1
    v_mfma_f32_16x16x32_bf16 v[196:199], a[232:235], v[76:79], v[196:199]
    ds_read_b128 a[232:235], v1 offset:39936
    v_mfma_f32_16x16x32_bf16 v[188:191], a[236:239], v[72:75], v[188:191]
    v_mfma_f32_16x16x32_bf16 v[204:207], a[236:239], v[76:79], v[204:207]
    ds_read_b128 a[236:239], v1 offset:40960
    s_waitcnt vmcnt(8) lgkmcnt(5)
    v_mfma_f32_16x16x32_bf16 v[176:179], a[240:243], v[80:83], v[176:179]
    buffer_load_dwordx4 v[120:123], v1, s[8:11], s74 offen offset:1024 sc1
    v_mfma_f32_16x16x32_bf16 v[192:195], a[240:243], v[84:87], v[192:195]
    ds_read_b128 a[240:243], v1 offset:41984
    v_mfma_f32_16x16x32_bf16 v[184:187], a[244:247], v[80:83], v[184:187]
    v_mfma_f32_16x16x32_bf16 v[200:203], a[244:247], v[84:87], v[200:203]
    ds_read_b128 a[244:247], v1 offset:43008
    v_mfma_f32_16x16x32_bf16 v[180:183], a[248:251], v[80:83], v[180:183]
    buffer_load_dwordx4 v[124:127], v1, s[8:11], s75 offen offset:1024 sc1
    v_mfma_f32_16x16x32_bf16 v[196:199], a[248:251], v[84:87], v[196:199]
    ds_read_b128 a[248:251], v1 offset:44032
    v_mfma_f32_16x16x32_bf16 v[188:191], a[252:255], v[80:83], v[188:191]
    v_mfma_f32_16x16x32_bf16 v[204:207], a[252:255], v[84:87], v[204:207]
    ds_read_b128 a[252:255], v1 offset:45056
    s_waitcnt vmcnt(8) lgkmcnt(5)
    v_mfma_f32_16x16x32_bf16 v[176:179], a[220:223], v[88:91], v[176:179]
    buffer_load_dwordx4 v[128:131], v1, s[8:11], s74 offen offset:2048 sc1
    v_mfma_f32_16x16x32_bf16 v[192:195], a[220:223], v[92:95], v[192:195]
    ds_read_b128 a[220:223], v1 offset:46080
    v_mfma_f32_16x16x32_bf16 v[184:187], a[224:227], v[88:91], v[184:187]
    v_mfma_f32_16x16x32_bf16 v[200:203], a[224:227], v[92:95], v[200:203]
    ds_read_b128 a[224:227], v1 offset:47104
    v_mfma_f32_16x16x32_bf16 v[180:183], a[228:231], v[88:91], v[180:183]
    buffer_load_dwordx4 v[132:135], v1, s[8:11], s75 offen offset:2048 sc1
    v_mfma_f32_16x16x32_bf16 v[196:199], a[228:231], v[92:95], v[196:199]
    ds_read_b128 a[228:231], v1 offset:48128
    v_mfma_f32_16x16x32_bf16 v[188:191], a[232:235], v[88:91], v[188:191]
    v_mfma_f32_16x16x32_bf16 v[204:207], a[232:235], v[92:95], v[204:207]
    ds_read_b128 a[232:235], v1 offset:49152
    s_waitcnt vmcnt(8) lgkmcnt(5)
    v_mfma_f32_16x16x32_bf16 v[176:179], a[236:239], v[96:99], v[176:179]
    buffer_load_dwordx4 v[136:139], v1, s[8:11], s74 offen offset:3072 sc1
    s_add_u32 s74, s74, 4096
    v_mfma_f32_16x16x32_bf16 v[192:195], a[236:239], v[100:103], v[192:195]
    ds_read_b128 a[236:239], v1 offset:50176
    v_mfma_f32_16x16x32_bf16 v[184:187], a[240:243], v[96:99], v[184:187]
    s_branch L_past8
L_page8:
    s_setpc_b64 s[98:99]
L_past8:
    v_mfma_f32_16x16x32_bf16 v[200:203], a[240:243], v[100:103], v[200:203]
    ds_read_b128 a[240:243], v1 offset:51200
    v_mfma_f32_16x16x32_bf16 v[180:183], a[244:247], v[96:99], v[180:183]
    buffer_load_dwordx4 v[140:143], v1, s[8:11], s75 offen offset:3072 sc1
    s_add_u32 s75, s75, 4096
    v_mfma_f32_16x16x32_bf16 v[196:199], a[244:247], v[100:103], v[196:199]
    ds_read_b128 a[244:247], v1 offset:52224
    v_mfma_f32_16x16x32_bf16 v[188:191], a[248:251], v[96:99], v[188:191]
    v_mfma_f32_16x16x32_bf16 v[204:207], a[248:251], v[100:103], v[204:207]
    ds_read_b128 a[248:251], v1 offset:53248
    s_waitcnt vmcnt(8) lgkmcnt(5)
    v_mfma_f32_16x16x32_bf16 v[176:179], a[252:255], v[104:107], v[176:179]
    buffer_load_dwordx4 v[144:147], v1, s[8:11], s74 offen offset:0 sc1
    v_mfma_f32_16x16x32_bf16 v[192:195], a[252:255], v[108:111], v[192:195]
    ds_read_b128 a[252:255], v1 offset:54272
    v_mfma_f32_16x16x32_bf16 v[184:187], a[220:223], v[104:107], v[184:187]
    v_mfma_f32_16x16x32_bf16 v[200:203], a[220:223], v[108:111], v[200:203]
    ds_read_b128 a[220:223], v1 offset:55296
    v_mfma_f32_16x16x32_bf16 v[180:183], a[224:227], v[104:107], v[180:183]
    buffer_load_dwordx4 v[148:151], v1, s[8:11], s75 offen offset:0 sc1
    v_mfma_f32_16x16x32_bf16 v[196:199], a[224:227], v[108:111], v[196:199]
    ds_read_b128 a[224:227], v1 offset:56320
    v_mfma_f32_16x16x32_bf16 v[188:191], a[228:231], v[104:107], v[188:191]
    v_mfma_f32_16x16x32_bf16 v[204:207], a[228:231], v[108:111], v[204:207]
    ds_read_b128 a[228:231], v1 offset:57344
    s_waitcnt vmcnt(8) lgkmcnt(5)
    v_mfma_f32_16x16x32_bf16 v[176:179], a[232:235], v[112:115], v[176:179]
    buffer_load_dwordx4 v[152:155], v1, s[8:11], s74 offen offset:1024 sc1
    v_mfma_f32_16x16x32_bf16 v[192:195], a[232:235], v[116:119], v[192:195]
    ds_read_b128 a[232:235], v1 offset:58368
    v_mfma_f32_16x16x32_bf16 v[184:187], a[236:239], v[112:115], v[184:187]
    v_mfma_f32_16x16x32_bf16 v[200:203], a[236:239], v[116:119], v[200:203]
    ds_read_b128 a[236:239], v1 offset:59392
    v_mfma_f32_16x16x32_bf16 v[180:183], a[240:243], v[112:115], v[180:183]
    buffer_load_dwordx4 v[156:159], v1, s[8:11], s75 offen offset:1024 sc1
    v_mfma_f32_16x16x32_bf16 v[196:199], a[240:243], v[116:119], v[196:199]
    ds_read_b128 a[240:243], v1 offset:60416
    v_mfma_f32_16x16x32_bf16 v[188:191], a[244:247], v[112:115], v[188:191]
    v_mfma_f32_16x16x32_bf16 v[204:207], a[244:247], v[116:119], v[204:207]
    ds_read_b128 a[244:247], v1 offset:61440
    s_waitcnt vmcnt(8) lgkmcnt(5)
    v_mfma_f32_16x16x32_bf16 v[176:179], a[248:251], v[120:123], v[176:179]
    buffer_load_dwordx4 v[160:163], v1, s[8:11], s74 offen offset:2048 sc1
    v_mfma_f32_16x16x32_bf16 v[192:195], a[248:251], v[124:127], v[192:195]
    ds_read_b128 a[248:251], v1 offset:62464
    v_mfma_f32_16x16x32_bf16 v[184:187], a[252:255], v[120:123], v[184:187]
    v_mfma_f32_16x16x32_bf16 v[200:203], a[252:255], v[124:127], v[200:203]
    ds_read_b128 a[252:255], v1 offset:63488
    v_mfma_f32_16x16x32_bf16 v[180:183], a[220:223], v[120:123], v[180:183]
    buffer_load_dwordx4 v[164:167], v1, s[8:11], s75 offen offset:2048 sc1
    v_mfma_f32_16x16x32_bf16 v[196:199], a[220:223], v[124:127], v[196:199]
    ds_read_b128 a[220:223], v1 offset:64512
    v_mfma_f32_16x16x32_bf16 v[188:191], a[224:227], v[120:123], v[188:191]
    v_mfma_f32_16x16x32_bf16 v[204:207], a[224:227], v[124:127], v[204:207]
    s_barrier
    ds_read_b128 a[224:227], v2 offset:0
    s_waitcnt vmcnt(8) lgkmcnt(5)
    v_mfma_f32_16x16x32_bf16 v[176:179], a[228:231], v[128:131], v[176:179]
    buffer_load_dwordx4 v[168:171], v1, s[8:11], s74 offen offset:3072 sc1
    v_mfma_f32_16x16x32_bf16 v[192:195], a[228:231], v[132:135], v[192:195]
    ds_read_b128 a[228:231], v2 offset:1024
    v_mfma_f32_16x16x32_bf16 v[184:187], a[232:235], v[128:131], v[184:187]
    v_mfma_f32_16x16x32_bf16 v[200:203], a[232:235], v[132:135], v[200:203]
    ds_read_b128 a[232:235], v2 offset:2048
    v_mfma_f32_16x16x32_bf16 v[180:183], a[236:239], v[128:131], v[180:183]
    buffer_load_dwordx4 v[172:175], v1, s[8:11], s75 offen offset:3072 sc1
    v_mfma_f32_16x16x32_bf16 v[196:199], a[236:239], v[132:135], v[196:199]
    ds_read_b128 a[236:239], v2 offset:3072
    v_mfma_f32_16x16x32_bf16 v[188:191], a[240:243], v[128:131], v[188:191]
    v_mfma_f32_16x16x32_bf16 v[204:207], a[240:243], v[132:135], v[204:207]
    ds_read_b128 a[240:243], v2 offset:4096
    s_waitcnt vmcnt(8) lgkmcnt(5)
    v_mfma_f32_16x16x32_bf16 v[176:179], a[244:247], v[136:139], v[176:179]
    v_mfma_f32_16x16x32_bf16 v[192:195], a[244:247], v[140:143], v[192:195]
    ds_read_b128 a[244:247], v2 offset:5120
    v_mfma_f32_16x16x32_bf16 v[184:187], a[248:251], v[136:139], v[184:187]
    s_add_u32 s86, s85, 131072
    s_add_u32 m0, s87, 0
    v_mfma_f32_16x16x32_bf16 v[200:203], a[248:251], v[140:143], v[200:203]
    ds_read_b128 a[248:251], v2 offset:6144
    v_mfma_f32_16x16x32_bf16 v[180:183], a[252:255], v[136:139], v[180:183]
    buffer_load_dwordx4 v1, s[8:11], s86 offen offset:0 sc1 lds
    v_mfma_f32_16x16x32_bf16 v[196:199], a[252:255], v[140:143], v[196:199]
    ds_read_b128 a[252:255], v2 offset:7168
    v_mfma_f32_16x16x32_bf16 v[188:191], a[220:223], v[136:139], v[188:191]
    v_mfma_f32_16x16x32_bf16 v[204:207], a[220:223], v[140:143], v[204:207]
    ds_read_b128 a[220:223], v2 offset:8192
    s_waitcnt vmcnt(7) lgkmcnt(5)
    v_mfma_f32_16x16x32_bf16 v[176:179], a[224:227], v[144:147], v[176:179]
    v_mfma_f32_16x16x32_bf16 v[192:195], a[224:227], v[148:151], v[192:195]
    ds_read_b128 a[224:227], v2 offset:9216
    v_mfma_f32_16x16x32_bf16 v[184:187], a[228:231], v[144:147], v[184:187]
    v_mfma_f32_16x16x32_bf16 v[200:203], a[228:231], v[148:151], v[200:203]
    ds_read_b128 a[228:231], v2 offset:10240
    buffer_load_dwordx4 v1, s[8:11], s86 offen offset:1024 sc1 lds
    v_mfma_f32_16x16x32_bf16 v[180:183], a[232:235], v[144:147], v[180:183]
    v_mfma_f32_16x16x32_bf16 v[196:199], a[232:235], v[148:151], v[196:199]
    ds_read_b128 a[232:235], v2 offset:11264
    v_mfma_f32_16x16x32_bf16 v[188:191], a[236:239], v[144:147], v[188:191]
    v_mfma_f32_16x16x32_bf16 v[204:207], a[236:239], v[148:151], v[204:207]
    ds_read_b128 a[236:239], v2 offset:12288
    s_waitcnt vmcnt(6) lgkmcnt(5)
    v_mfma_f32_16x16x32_bf16 v[176:179], a[240:243], v[152:155], v[176:179]
    v_mfma_f32_16x16x32_bf16 v[192:195], a[240:243], v[156:159], v[192:195]
    ds_read_b128 a[240:243], v2 offset:13312
    v_mfma_f32_16x16x32_bf16 v[184:187], a[244:247], v[152:155], v[184:187]
    buffer_load_dwordx4 v1, s[8:11], s86 offen offset:2048 sc1 lds
    v_mfma_f32_16x16x32_bf16 v[200:203], a[244:247], v[156:159], v[200:203]
    ds_read_b128 a[244:247], v2 offset:14336
    v_mfma_f32_16x16x32_bf16 v[180:183], a[248:251], v[152:155], v[180:183]
    v_mfma_f32_16x16x32_bf16 v[196:199], a[248:251], v[156:159], v[196:199]
    ds_read_b128 a[248:251], v2 offset:15360
    v_mfma_f32_16x16x32_bf16 v[188:191], a[252:255], v[152:155], v[188:191]
    v_mfma_f32_16x16x32_bf16 v[204:207], a[252:255], v[156:159], v[204:207]
    ds_read_b128 a[252:255], v2 offset:16384
    s_waitcnt vmcnt(5) lgkmcnt(5)
    v_mfma_f32_16x16x32_bf16 v[176:179], a[220:223], v[160:163], v[176:179]
    v_mfma_f32_16x16x32_bf16 v[192:195], a[220:223], v[164:167], v[192:195]
    ds_read_b128 a[220:223], v2 offset:17408
    buffer_load_dwordx4 v1, s[8:11], s86 offen offset:3072 sc1 lds
    v_mfma_f32_16x16x32_bf16 v[184:187], a[224:227], v[160:163], v[184:187]
    v_mfma_f32_16x16x32_bf16 v[200:203], a[224:227], v[164:167], v[200:203]
    ds_read_b128 a[224:227], v2 offset:18432
    v_mfma_f32_16x16x32_bf16 v[180:183], a[228:231], v[160:163], v[180:183]
    v_mfma_f32_16x16x32_bf16 v[196:199], a[228:231], v[164:167], v[196:199]
    ds_read_b128 a[228:231], v2 offset:19456
    v_mfma_f32_16x16x32_bf16 v[188:191], a[232:235], v[160:163], v[188:191]
    s_add_u32 s86, s85, 147456
    s_add_u32 m0, s87, 16384
    v_mfma_f32_16x16x32_bf16 v[204:207], a[232:235], v[164:167], v[204:207]
    ds_read_b128 a[232:235], v2 offset:20480
    s_waitcnt vmcnt(4) lgkmcnt(5)
    v_mfma_f32_16x16x32_bf16 v[176:179], a[236:239], v[168:171], v[176:179]
    buffer_load_dwordx4 v1, s[8:11], s86 offen offset:0 sc1 lds
    v_mfma_f32_16x16x32_bf16 v[192:195], a[236:239], v[172:175], v[192:195]
    ds_read_b128 a[236:239], v2 offset:21504
    v_mfma_f32_16x16x32_bf16 v[184:187], a[240:243], v[168:171], v[184:187]
    v_mfma_f32_16x16x32_bf16 v[200:203], a[240:243], v[172:175], v[200:203]
    ds_read_b128 a[240:243], v2 offset:22528
    v_mfma_f32_16x16x32_bf16 v[180:183], a[244:247], v[168:171], v[180:183]
    v_mfma_f32_16x16x32_bf16 v[196:199], a[244:247], v[172:175], v[196:199]
    ds_read_b128 a[244:247], v2 offset:23552
    v_mfma_f32_16x16x32_bf16 v[188:191], a[248:251], v[168:171], v[188:191]
    v_mfma_f32_16x16x32_bf16 v[204:207], a[248:251], v[172:175], v[204:207]
    ds_read_b128 a[248:251], v2 offset:24576
    s_waitcnt lgkmcnt(5)
    v_mfma_f32_16x16x32_bf16 v[208:211], a[252:255], v[16:19], 0
    buffer_load_dwordx4 v1, s[8:11], s86 offen offset:1024 sc1 lds
    v_mfma_f32_16x16x32_bf16 v[224:227], a[252:255], v[20:23], 0
    ds_read_b128 a[252:255], v2 offset:25600
    v_mfma_f32_16x16x32_bf16 v[216:219], a[220:223], v[16:19], 0
    v_mfma_f32_16x16x32_bf16 v[232:235], a[220:223], v[20:23], 0
    ds_read_b128 a[220:223], v2 offset:26624
    v_fma_f32 v8, v176, v176, v4
    v_mfma_f32_16x16x32_bf16 v[212:215], a[224:227], v[16:19], 0
    v_mul_f32 v184, v176, v184
    v_mul_f32_e64 v176, -v176, v8
    v_mfma_f32_16x16x32_bf16 v[228:231], a[224:227], v[20:23], 0
    ds_read_b128 a[224:227], v2 offset:27648
    v_fma_f32 v9, v177, v177, v4
    v_mfma_f32_16x16x32_bf16 v[220:223], a[228:231], v[16:19], 0
    buffer_load_dwordx4 v1, s[8:11], s86 offen offset:2048 sc1 lds
    v_mul_f32 v185, v177, v185
    v_mfma_f32_16x16x32_bf16 v[236:239], a[228:231], v[20:23], 0
    ds_read_b128 a[228:231], v2 offset:28672
    s_waitcnt lgkmcnt(5)
    v_mfma_f32_16x16x32_bf16 v[208:211], a[232:235], v[24:27], v[208:211]
    v_exp_f32 v176, v176
    v_mfma_f32_16x16x32_bf16 v[224:227], a[232:235], v[28:31], v[224:227]
    ds_read_b128 a[232:235], v2 offset:29696
    v_add_f32 v176, 1.0, v176
    v_mfma_f32_16x16x32_bf16 v[216:219], a[236:239], v[24:27], v[216:219]
    v_rcp_f32 v176, v176
    v_mfma_f32_16x16x32_bf16 v[232:235], a[236:239], v[28:31], v[232:235]
    ds_read_b128 a[236:239], v2 offset:30720
    v_mul_f32 v184, v184, v176
    v_mfma_f32_16x16x32_bf16 v[212:215], a[240:243], v[24:27], v[212:215]
    v_mul_f32_e64 v177, -v177, v9
    v_fma_f32 v10, v178, v178, v4
    v_mfma_f32_16x16x32_bf16 v[228:231], a[240:243], v[28:31], v[228:231]
    ds_read_b128 a[240:243], v2 offset:31744
    buffer_load_dwordx4 v1, s[8:11], s86 offen offset:3072 sc1 lds
    v_mfma_f32_16x16x32_bf16 v[220:223], a[244:247], v[24:27], v[220:223]
    v_exp_f32 v177, v177
    v_mfma_f32_16x16x32_bf16 v[236:239], a[244:247], v[28:31], v[236:239]
    s_barrier
    ds_read_b128 a[244:247], v2 offset:32768
    s_waitcnt lgkmcnt(5)
    v_mfma_f32_16x16x32_bf16 v[208:211], a[248:251], v[32:35], v[208:211]
    v_add_f32 v177, 1.0, v177
    v_mul_f32 v186, v178, v186
    v_mfma_f32_16x16x32_bf16 v[224:227], a[248:251], v[36:39], v[224:227]
    ds_read_b128 a[248:251], v2 offset:33792
    v_mul_f32_e64 v178, -v178, v10
    v_mfma_f32_16x16x32_bf16 v[216:219], a[252:255], v[32:35], v[216:219]
    s_add_u32 s86, s85, 0
    s_add_u32 m0, s87, 32768
    v_mfma_f32_16x16x32_bf16 v[232:235], a[252:255], v[36:39], v[232:235]
    ds_read_b128 a[252:255], v2 offset:34816
    v_fma_f32 v11, v179, v179, v4
    v_mfma_f32_16x16x32_bf16 v[212:215], a[220:223], v[32:35], v[212:215]
    buffer_load_dwordx4 v1, s[8:11], s86 offen offset:0 sc1 lds
    v_mul_f32 v187, v179, v187
    v_mfma_f32_16x16x32_bf16 v[228:231], a[220:223], v[36:39], v[228:231]
    ds_read_b128 a[220:223], v2 offset:35840
    v_mul_f32_e64 v179, -v179, v11
    v_mfma_f32_16x16x32_bf16 v[220:223], a[224:227], v[32:35], v[220:223]
    v_rcp_f32 v177, v177
    v_mfma_f32_16x16x32_bf16 v[236:239], a[224:227], v[36:39], v[236:239]
    ds_read_b128 a[224:227], v2 offset:36864
    s_waitcnt lgkmcnt(5)
    v_mfma_f32_16x16x32_bf16 v[208:211], a[228:231], v[40:43], v[208:211]
    v_mul_f32 v185, v185, v177
    v_cvt_pk_bf16_f32 v12, v184, v185
    v_mfma_f32_16x16x32_bf16 v[224:227], a[228:231], v[44:47], v[224:227]
    ds_read_b128 a[228:231], v2 offset:37888
    v_fma_f32 v8, v180, v180, v4
    v_mfma_f32_16x16x32_bf16 v[216:219], a[232:235], v[40:43], v[216:219]
    v_exp_f32 v178, v178
    v_mfma_f32_16x16x32_bf16 v[232:235], a[232:235], v[44:47], v[232:235]
    ds_read_b128 a[232:235], v2 offset:38912
    buffer_load_dwordx4 v1, s[8:11], s86 offen offset:1024 sc1 lds
    v_mfma_f32_16x16x32_bf16 v[212:215], a[236:239], v[40:43], v[212:215]
    v_add_f32 v178, 1.0, v178
    v_mul_f32 v188, v180, v188
    v_mfma_f32_16x16x32_bf16 v[228:231], a[236:239], v[44:47], v[228:231]
    ds_read_b128 a[236:239], v2 offset:39936
    v_mul_f32_e64 v180, -v180, v8
    v_mfma_f32_16x16x32_bf16 v[220:223], a[240:243], v[40:43], v[220:223]
    v_rcp_f32 v178, v178
    v_mfma_f32_16x16x32_bf16 v[236:239], a[240:243], v[44:47], v[236:239]
    ds_read_b128 a[240:243], v2 offset:40960
    s_waitcnt lgkmcnt(5)
    v_mfma_f32_16x16x32_bf16 v[208:211], a[244:247], v[48:51], v[208:211]
    v_mul_f32 v186, v186, v178
    v_fma_f32 v9, v181, v181, v4
    v_mfma_f32_16x16x32_bf16 v[224:227], a[244:247], v[52:55], v[224:227]
    ds_read_b128 a[244:247], v2 offset:41984
    v_mul_f32 v189, v181, v189
    v_mfma_f32_16x16x32_bf16 v[216:219], a[248:251], v[48:51], v[216:219]
    buffer_load_dwordx4 v1, s[8:11], s86 offen offset:2048 sc1 lds
    v_mul_f32_e64 v181, -v181, v9
    v_mfma_f32_16x16x32_bf16 v[232:235], a[248:251], v[52:55], v[232:235]
    ds_read_b128 a[248:251], v2 offset:43008
    v_fma_f32 v10, v182, v182, v4
    v_mfma_f32_16x16x32_bf16 v[212:215], a[252:255], v[48:51], v[212:215]
    v_exp_f32 v179, v179
    v_mfma_f32_16x16x32_bf16 v[228:231], a[252:255], v[52:55], v[228:231]
    ds_read_b128 a[252:255], v2 offset:44032
    v_add_f32 v179, 1.0, v179
    v_mfma_f32_16x16x32_bf16 v[220:223], a[220:223], v[48:51], v[220:223]
    v_rcp_f32 v179, v179
    v_mfma_f32_16x16x32_bf16 v[236:239], a[220:223], v[52:55], v[236:239]
    ds_read_b128 a[220:223], v2 offset:45056
    s_waitcnt lgkmcnt(5)
    v_mfma_f32_16x16x32_bf16 v[208:211], a[224:227], v[56:59], v[208:211]
    v_mul_f32 v187, v187, v179
    v_cvt_pk_bf16_f32 v13, v186, v187
    v_mfma_f32_16x16x32_bf16 v[224:227], a[224:227], v[60:63], v[224:227]
    ds_read_b128 a[224:227], v2 offset:46080
    buffer_load_dwordx4 v1, s[8:11], s86 offen offset:3072 sc1 lds
    v_mfma_f32_16x16x32_bf16 v[216:219], a[228:231], v[56:59], v[216:219]
    v_exp_f32 v180, v180
    v_mfma_f32_16x16x32_bf16 v[232:235], a[228:231], v[60:63], v[232:235]
    ds_read_b128 a[228:231], v2 offset:47104
    v_add_f32 v180, 1.0, v180
    v_mfma_f32_16x16x32_bf16 v[212:215], a[232:235], v[56:59], v[212:215]
    v_rcp_f32 v180, v180
    v_mfma_f32_16x16x32_bf16 v[228:231], a[232:235], v[60:63], v[228:231]
    ds_read_b128 a[232:235], v2 offset:48128
    v_mul_f32 v188, v188, v180
    v_mfma_f32_16x16x32_bf16 v[220:223], a[236:239], v[56:59], v[220:223]
    s_add_u32 s86, s85, 16384
    s_add_u32 m0, s87, 49152
    v_mfma_f32_16x16x32_bf16 v[236:239], a[236:239], v[60:63], v[236:239]
    ds_read_b128 a[236:239], v2 offset:49152
    s_waitcnt lgkmcnt(5)
    v_mfma_f32_16x16x32_bf16 v[208:211], a[240:243], v[64:67], v[208:211]
    buffer_load_dwordx4 v1, s[8:11], s86 offen offset:0 sc1 lds
    v_mul_f32 v190, v182, v190
    v_mfma_f32_16x16x32_bf16 v[224:227], a[240:243], v[68:71], v[224:227]
    ds_read_b128 a[240:243], v2 offset:50176
    v_mul_f32_e64 v182, -v182, v10
    v_mfma_f32_16x16x32_bf16 v[216:219], a[244:247], v[64:67], v[216:219]
    v_exp_f32 v181, v181
    v_mfma_f32_16x16x32_bf16 v[232:235], a[244:247], v[68:71], v[232:235]
    ds_read_b128 a[244:247], v2 offset:51200
    v_add_f32 v181, 1.0, v181
    v_mfma_f32_16x16x32_bf16 v[212:215], a[248:251], v[64:67], v[212:215]
    v_rcp_f32 v181, v181
    v_mfma_f32_16x16x32_bf16 v[228:231], a[248:251], v[68:71], v[228:231]
    ds_read_b128 a[248:251], v2 offset:52224
    v_mul_f32 v189, v189, v181
    v_mfma_f32_16x16x32_bf16 v[220:223], a[252:255], v[64:67], v[220:223]
    v_cvt_pk_bf16_f32 v14, v188, v189
    v_fma_f32 v11, v183, v183, v4
    v_mfma_f32_16x16x32_bf16 v[236:239], a[252:255], v[68:71], v[236:239]
    ds_read_b128 a[252:255], v2 offset:53248
    s_waitcnt lgkmcnt(5)
    v_mfma_f32_16x16x32_bf16 v[208:211], a[220:223], v[72:75], v[208:211]
    buffer_load_dwordx4 v1, s[8:11], s86 offen offset:1024 sc1 lds
    v_mul_f32 v191, v183, v191
    v_mfma_f32_16x16x32_bf16 v[224:227], a[220:223], v[76:79], v[224:227]
    ds_read_b128 a[220:223], v2 offset:54272
    v_mul_f32_e64 v183, -v183, v11
    v_mfma_f32_16x16x32_bf16 v[216:219], a[224:227], v[72:75], v[216:219]
    v_exp_f32 v182, v182
    v_mfma_f32_16x16x32_bf16 v[232:235], a[224:227], v[76:79], v[232:235]
    ds_read_b128 a[224:227], v2 offset:55296
    v_add_f32 v182, 1.0, v182
    v_mfma_f32_16x16x32_bf16 v[212:215], a[228:231], v[72:75], v[212:215]
    v_rcp_f32 v182, v182
    v_mfma_f32_16x16x32_bf16 v[228:231], a[228:231], v[76:79], v[228:231]
    ds_read_b128 a[228:231], v2 offset:56320
    v_mul_f32 v190, v190, v182
    v_mfma_f32_16x16x32_bf16 v[220:223], a[232:235], v[72:75], v[220:223]
    buffer_load_dwordx4 v1, s[8:11], s86 offen offset:2048 sc1 lds
    v_fma_f32 v8, v192, v192, v4
    v_mfma_f32_16x16x32_bf16 v[236:239], a[232:235], v[76:79], v[236:239]
    ds_read_b128 a[232:235], v2 offset:57344
    s_waitcnt lgkmcnt(5)
    v_mfma_f32_16x16x32_bf16 v[208:211], a[236:239], v[80:83], v[208:211]
    v_exp_f32 v183, v183
    v_mfma_f32_16x16x32_bf16 v[224:227], a[236:239], v[84:87], v[224:227]
    ds_read_b128 a[236:239], v2 offset:58368
    v_add_f32 v183, 1.0, v183
    v_mfma_f32_16x16x32_bf16 v[216:219], a[240:243], v[80:83], v[216:219]
    v_rcp_f32 v183, v183
    v_mfma_f32_16x16x32_bf16 v[232:235], a[240:243], v[84:87], v[232:235]
    ds_read_b128 a[240:243], v2 offset:59392
    v_mul_f32 v191, v191, v183
    v_mfma_f32_16x16x32_bf16 v[212:215], a[244:247], v[80:83], v[212:215]
    v_cvt_pk_bf16_f32 v15, v190, v191
    v_mul_f32 v200, v192, v200
    v_mfma_f32_16x16x32_bf16 v[228:231], a[244:247], v[84:87], v[228:231]
    ds_read_b128 a[244:247], v2 offset:60416
    buffer_load_dwordx4 v1, s[8:11], s86 offen offset:3072 sc1 lds
    v_mfma_f32_16x16x32_bf16 v[220:223], a[248:251], v[80:83], v[220:223]
    buffer_store_dwordx4 v[12:15], v1, s[8:11], s92 offen sc1
    v_mul_f32_e64 v192, -v192, v8
    v_mfma_f32_16x16x32_bf16 v[236:239], a[248:251], v[84:87], v[236:239]
    ds_read_b128 a[248:251], v2 offset:61440
    s_waitcnt lgkmcnt(5)
    v_mfma_f32_16x16x32_bf16 v[208:211], a[252:255], v[88:91], v[208:211]
    v_exp_f32 v192, v192
    v_mfma_f32_16x16x32_bf16 v[224:227], a[252:255], v[92:95], v[224:227]
    ds_read_b128 a[252:255], v2 offset:62464
    v_add_f32 v192, 1.0, v192
    v_mfma_f32_16x16x32_bf16 v[216:219], a[220:223], v[88:91], v[216:219]
    v_rcp_f32 v192, v192
    v_mfma_f32_16x16x32_bf16 v[232:235], a[220:223], v[92:95], v[232:235]
    ds_read_b128 a[220:223], v2 offset:63488
    v_mul_f32 v200, v200, v192
    v_mfma_f32_16x16x32_bf16 v[212:215], a[224:227], v[88:91], v[212:215]
    v_fma_f32 v9, v193, v193, v4
    v_mul_f32 v201, v193, v201
    v_mfma_f32_16x16x32_bf16 v[228:231], a[224:227], v[92:95], v[228:231]
    ds_read_b128 a[224:227], v2 offset:64512
    v_mul_f32_e64 v193, -v193, v9
    v_mfma_f32_16x16x32_bf16 v[220:223], a[228:231], v[88:91], v[220:223]
    v_exp_f32 v193, v193
    v_mfma_f32_16x16x32_bf16 v[236:239], a[228:231], v[92:95], v[236:239]
    s_waitcnt vmcnt(9)
    s_barrier
    ds_read_b128 a[228:231], v1 offset:0
    s_waitcnt lgkmcnt(5)
    v_mfma_f32_16x16x32_bf16 v[208:211], a[232:235], v[96:99], v[208:211]
    s_add_u32 s86, s85, 32768
    s_add_u32 m0, s87, 65536
    v_mfma_f32_16x16x32_bf16 v[224:227], a[232:235], v[100:103], v[224:227]
    ds_read_b128 a[232:235], v1 offset:1024
    v_add_f32 v193, 1.0, v193
    v_mfma_f32_16x16x32_bf16 v[216:219], a[236:239], v[96:99], v[216:219]
    buffer_load_dwordx4 v1, s[8:11], s86 offen offset:0 sc1 lds
    v_fma_f32 v10, v194, v194, v4
    v_mfma_f32_16x16x32_bf16 v[232:235], a[236:239], v[100:103], v[232:235]
    ds_read_b128 a[236:239], v1 offset:2048
    v_mul_f32 v202, v194, v202
    v_mfma_f32_16x16x32_bf16 v[212:215], a[240:243], v[96:99], v[212:215]
    v_rcp_f32 v193, v193
    v_mfma_f32_16x16x32_bf16 v[228:231], a[240:243], v[100:103], v[228:231]
    ds_read_b128 a[240:243], v1 offset:3072
    v_mul_f32 v201, v201, v193
    v_mfma_f32_16x16x32_bf16 v[220:223], a[244:247], v[96:99], v[220:223]
    v_cvt_pk_bf16_f32 v240, v200, v201
    v_mul_f32_e64 v194, -v194, v10
    v_mfma_f32_16x16x32_bf16 v[236:239], a[244:247], v[100:103], v[236:239]
    ds_read_b128 a[244:247], v1 offset:4096
    s_waitcnt lgkmcnt(5)
    v_mfma_f32_16x16x32_bf16 v[208:211], a[248:251], v[104:107], v[208:211]
    v_exp_f32 v194, v194
    v_mfma_f32_16x16x32_bf16 v[224:227], a[248:251], v[108:111], v[224:227]
    ds_read_b128 a[248:251], v1 offset:5120
    buffer_load_dwordx4 v1, s[8:11], s86 offen offset:1024 sc1 lds
    v_mfma_f32_16x16x32_bf16 v[216:219], a[252:255], v[104:107], v[216:219]
    v_add_f32 v194, 1.0, v194
    v_fma_f32 v11, v195, v195, v4
    v_mfma_f32_16x16x32_bf16 v[232:235], a[252:255], v[108:111], v[232:235]
    ds_read_b128 a[252:255], v1 offset:6144
    v_mul_f32 v203, v195, v203
    v_mfma_f32_16x16x32_bf16 v[212:215], a[220:223], v[104:107], v[212:215]
    v_rcp_f32 v194, v194
    v_mfma_f32_16x16x32_bf16 v[228:231], a[220:223], v[108:111], v[228:231]
    ds_read_b128 a[220:223], v1 offset:7168
    v_mul_f32 v202, v202, v194
    v_mfma_f32_16x16x32_bf16 v[220:223], a[224:227], v[104:107], v[220:223]
    v_mul_f32_e64 v195, -v195, v11
    v_fma_f32 v8, v196, v196, v4
    v_mfma_f32_16x16x32_bf16 v[236:239], a[224:227], v[108:111], v[236:239]
    ds_read_b128 a[224:227], v1 offset:8192
    s_waitcnt lgkmcnt(5)
    v_mfma_f32_16x16x32_bf16 v[208:211], a[228:231], v[112:115], v[208:211]
    buffer_load_dwordx4 v1, s[8:11], s86 offen offset:2048 sc1 lds
    v_mul_f32 v204, v196, v204
    v_mfma_f32_16x16x32_bf16 v[224:227], a[228:231], v[116:119], v[224:227]
    ds_read_b128 a[228:231], v1 offset:9216
    v_mul_f32_e64 v196, -v196, v8
    v_mfma_f32_16x16x32_bf16 v[216:219], a[232:235], v[112:115], v[216:219]
    v_exp_f32 v195, v195
    v_mfma_f32_16x16x32_bf16 v[232:235], a[232:235], v[116:119], v[232:235]
    ds_read_b128 a[232:235], v1 offset:10240
    v_add_f32 v195, 1.0, v195
    v_mfma_f32_16x16x32_bf16 v[212:215], a[236:239], v[112:115], v[212:215]
    v_rcp_f32 v195, v195
    v_mfma_f32_16x16x32_bf16 v[228:231], a[236:239], v[116:119], v[228:231]
    ds_read_b128 a[236:239], v1 offset:11264
    v_mul_f32 v203, v203, v195
    v_mfma_f32_16x16x32_bf16 v[220:223], a[240:243], v[112:115], v[220:223]
    v_cvt_pk_bf16_f32 v241, v202, v203
    v_fma_f32 v9, v197, v197, v4
    v_mfma_f32_16x16x32_bf16 v[236:239], a[240:243], v[116:119], v[236:239]
    ds_read_b128 a[240:243], v1 offset:12288
    s_waitcnt lgkmcnt(5)
    v_mfma_f32_16x16x32_bf16 v[208:211], a[244:247], v[120:123], v[208:211]
    buffer_load_dwordx4 v1, s[8:11], s86 offen offset:3072 sc1 lds
    v_mul_f32 v205, v197, v205
    v_mfma_f32_16x16x32_bf16 v[224:227], a[244:247], v[124:127], v[224:227]
    ds_read_b128 a[244:247], v1 offset:13312
    v_mul_f32_e64 v197, -v197, v9
    v_mfma_f32_16x16x32_bf16 v[216:219], a[248:251], v[120:123], v[216:219]
    v_exp_f32 v196, v196
    v_mfma_f32_16x16x32_bf16 v[232:235], a[248:251], v[124:127], v[232:235]
    ds_read_b128 a[248:251], v1 offset:14336
    v_add_f32 v196, 1.0, v196
    v_mfma_f32_16x16x32_bf16 v[212:215], a[252:255], v[120:123], v[212:215]
    s_add_u32 s86, s85, 49152
    s_add_u32 m0, s87, 81920
    v_mfma_f32_16x16x32_bf16 v[228:231], a[252:255], v[124:127], v[228:231]
    ds_read_b128 a[252:255], v1 offset:15360
    v_fma_f32 v10, v198, v198, v4
    v_mfma_f32_16x16x32_bf16 v[220:223], a[220:223], v[120:123], v[220:223]
    buffer_load_dwordx4 v1, s[8:11], s86 offen offset:0 sc1 lds
    v_mul_f32 v206, v198, v206
    v_mfma_f32_16x16x32_bf16 v[236:239], a[220:223], v[124:127], v[236:239]
    ds_read_b128 a[220:223], v1 offset:16384
    s_waitcnt lgkmcnt(5)
    v_mfma_f32_16x16x32_bf16 v[208:211], a[224:227], v[128:131], v[208:211]
    v_rcp_f32 v196, v196
    v_mfma_f32_16x16x32_bf16 v[224:227], a[224:227], v[132:135], v[224:227]
    ds_read_b128 a[224:227], v1 offset:17408
    v_mul_f32 v204, v204, v196
    v_mfma_f32_16x16x32_bf16 v[216:219], a[228:231], v[128:131], v[216:219]
    v_exp_f32 v197, v197
    v_mfma_f32_16x16x32_bf16 v[232:235], a[228:231], v[132:135], v[232:235]
    ds_read_b128 a[228:231], v1 offset:18432
    v_add_f32 v197, 1.0, v197
    v_mfma_f32_16x16x32_bf16 v[212:215], a[232:235], v[128:131], v[212:215]
    v_rcp_f32 v197, v197
    v_mfma_f32_16x16x32_bf16 v[228:231], a[232:235], v[132:135], v[228:231]
    ds_read_b128 a[232:235], v1 offset:19456
    buffer_load_dwordx4 v1, s[8:11], s86 offen offset:1024 sc1 lds
    v_mfma_f32_16x16x32_bf16 v[220:223], a[236:239], v[128:131], v[220:223]
    v_mul_f32 v205, v205, v197
    v_cvt_pk_bf16_f32 v242, v204, v205
    v_mfma_f32_16x16x32_bf16 v[236:239], a[236:239], v[132:135], v[236:239]
    ds_read_b128 a[236:239], v1 offset:20480
    s_waitcnt lgkmcnt(5)
    v_mfma_f32_16x16x32_bf16 v[208:211], a[240:243], v[136:139], v[208:211]
    v_mul_f32_e64 v198, -v198, v10
    v_fma_f32 v11, v199, v199, v4
    v_mfma_f32_16x16x32_bf16 v[224:227], a[240:243], v[140:143], v[224:227]
    ds_read_b128 a[240:243], v1 offset:21504
    v_mul_f32 v207, v199, v207
    v_mfma_f32_16x16x32_bf16 v[216:219], a[244:247], v[136:139], v[216:219]
    v_exp_f32 v198, v198
    v_mfma_f32_16x16x32_bf16 v[232:235], a[244:247], v[140:143], v[232:235]
    ds_read_b128 a[244:247], v1 offset:22528
    v_add_f32 v198, 1.0, v198
    v_mfma_f32_16x16x32_bf16 v[212:215], a[248:251], v[136:139], v[212:215]
    buffer_load_dwordx4 v1, s[8:11], s86 offen offset:2048 sc1 lds
    v_mul_f32_e64 v199, -v199, v11
    v_mfma_f32_16x16x32_bf16 v[228:231], a[248:251], v[140:143], v[228:231]
    ds_read_b128 a[248:251], v1 offset:23552
    v_mfma_f32_16x16x32_bf16 v[220:223], a[252:255], v[136:139], v[220:223]
    v_rcp_f32 v198, v198
    v_mfma_f32_16x16x32_bf16 v[236:239], a[252:255], v[140:143], v[236:239]
    ds_read_b128 a[252:255], v1 offset:24576
    s_waitcnt lgkmcnt(5)
    v_mfma_f32_16x16x32_bf16 v[208:211], a[220:223], v[144:147], v[208:211]
    v_mul_f32 v206, v206, v198
    v_mfma_f32_16x16x32_bf16 v[224:227], a[220:223], v[148:151], v[224:227]
    ds_read_b128 a[220:223], v1 offset:25600
    v_mfma_f32_16x16x32_bf16 v[216:219], a[224:227], v[144:147], v[216:219]
    v_exp_f32 v199, v199
    v_mfma_f32_16x16x32_bf16 v[232:235], a[224:227], v[148:151], v[232:235]
    ds_read_b128 a[224:227], v1 offset:26624
    buffer_load_dwordx4 v1, s[8:11], s86 offen offset:3072 sc1 lds
    v_mfma_f32_16x16x32_bf16 v[212:215], a[228:231], v[144:147], v[212:215]
    v_add_f32 v199, 1.0, v199
    v_mfma_f32_16x16x32_bf16 v[228:231], a[228:231], v[148:151], v[228:231]
    ds_read_b128 a[228:231], v1 offset:27648
    v_mfma_f32_16x16x32_bf16 v[220:223], a[232:235], v[144:147], v[220:223]
    v_rcp_f32 v199, v199
    v_mfma_f32_16x16x32_bf16 v[236:239], a[232:235], v[148:151], v[236:239]
    ds_read_b128 a[232:235], v1 offset:28672
    s_waitcnt lgkmcnt(5)
    v_mfma_f32_16x16x32_bf16 v[208:211], a[236:239], v[152:155], v[208:211]
    v_mul_f32 v207, v207, v199
    v_cvt_pk_bf16_f32 v243, v206, v207
    v_mfma_f32_16x16x32_bf16 v[224:227], a[236:239], v[156:159], v[224:227]
    ds_read_b128 a[236:239], v1 offset:29696
    buffer_store_dwordx4 v[240:243], v1, s[8:11], s80 offen sc1
    v_mfma_f32_16x16x32_bf16 v[216:219], a[240:243], v[152:155], v[216:219]
    s_sub_u32 s92, s92, 4096
    s_sub_u32 s80, s80, 4096
    v_mfma_f32_16x16x32_bf16 v[232:235], a[240:243], v[156:159], v[232:235]
    ds_read_b128 a[240:243], v1 offset:30720
    v_mfma_f32_16x16x32_bf16 v[212:215], a[244:247], v[152:155], v[212:215]
    v_mfma_f32_16x16x32_bf16 v[228:231], a[244:247], v[156:159], v[228:231]
    ds_read_b128 a[244:247], v1 offset:31744
    v_mfma_f32_16x16x32_bf16 v[220:223], a[248:251], v[152:155], v[220:223]
    v_mfma_f32_16x16x32_bf16 v[236:239], a[248:251], v[156:159], v[236:239]
    s_waitcnt vmcnt(10)
    s_barrier
    ds_read_b128 a[248:251], v1 offset:32768
    s_waitcnt lgkmcnt(5)
    v_mfma_f32_16x16x32_bf16 v[208:211], a[252:255], v[160:163], v[208:211]
    s_add_u32 s86, s85, 65536
    s_add_u32 m0, s87, 98304
    v_mfma_f32_16x16x32_bf16 v[224:227], a[252:255], v[164:167], v[224:227]
    ds_read_b128 a[252:255], v1 offset:33792
    v_mfma_f32_16x16x32_bf16 v[216:219], a[220:223], v[160:163], v[216:219]
    buffer_load_dwordx4 v1, s[8:11], s86 offen offset:0 sc1 lds
    v_mfma_f32_16x16x32_bf16 v[232:235], a[220:223], v[164:167], v[232:235]
    ds_read_b128 a[220:223], v1 offset:34816
    v_mfma_f32_16x16x32_bf16 v[212:215], a[224:227], v[160:163], v[212:215]
    v_mfma_f32_16x16x32_bf16 v[228:231], a[224:227], v[164:167], v[228:231]
    ds_read_b128 a[224:227], v1 offset:35840
    v_mfma_f32_16x16x32_bf16 v[220:223], a[228:231], v[160:163], v[220:223]
    v_mfma_f32_16x16x32_bf16 v[236:239], a[228:231], v[164:167], v[236:239]
    ds_read_b128 a[228:231], v1 offset:36864
    s_waitcnt lgkmcnt(5)
    v_mfma_f32_16x16x32_bf16 v[208:211], a[232:235], v[168:171], v[208:211]
    v_mfma_f32_16x16x32_bf16 v[224:227], a[232:235], v[172:175], v[224:227]
    ds_read_b128 a[232:235], v1 offset:37888
    buffer_load_dwordx4 v1, s[8:11], s86 offen offset:1024 sc1 lds
    v_mfma_f32_16x16x32_bf16 v[216:219], a[236:239], v[168:171], v[216:219]
    v_mfma_f32_16x16x32_bf16 v[232:235], a[236:239], v[172:175], v[232:235]
    ds_read_b128 a[236:239], v1 offset:38912
    v_mfma_f32_16x16x32_bf16 v[212:215], a[240:243], v[168:171], v[212:215]
    v_mfma_f32_16x16x32_bf16 v[228:231], a[240:243], v[172:175], v[228:231]
    ds_read_b128 a[240:243], v1 offset:39936
    v_mfma_f32_16x16x32_bf16 v[220:223], a[244:247], v[168:171], v[220:223]
    v_mfma_f32_16x16x32_bf16 v[236:239], a[244:247], v[172:175], v[236:239]
    ds_read_b128 a[244:247], v1 offset:40960
    s_waitcnt lgkmcnt(5)
    v_mfma_f32_16x16x32_bf16 v[176:179], a[248:251], v[16:19], 0
    buffer_load_dwordx4 v1, s[8:11], s86 offen offset:2048 sc1 lds
    v_mfma_f32_16x16x32_bf16 v[192:195], a[248:251], v[20:23], 0
    ds_read_b128 a[248:251], v1 offset:41984
    s_branch L_past9
L_page9:
    s_setpc_b64 s[98:99]
L_past9:
    v_mfma_f32_16x16x32_bf16 v[184:187], a[252:255], v[16:19], 0
    v_mfma_f32_16x16x32_bf16 v[200:203], a[252:255], v[20:23], 0
    ds_read_b128 a[252:255], v1 offset:43008
    v_fma_f32 v8, v208, v208, v4
    v_mfma_f32_16x16x32_bf16 v[180:183], a[220:223], v[16:19], 0
    v_mul_f32 v216, v208, v216
    v_mul_f32_e64 v208, -v208, v8
    v_mfma_f32_16x16x32_bf16 v[196:199], a[220:223], v[20:23], 0
    ds_read_b128 a[220:223], v1 offset:44032
    v_fma_f32 v9, v209, v209, v4
    v_mfma_f32_16x16x32_bf16 v[188:191], a[224:227], v[16:19], 0
    v_exp_f32 v208, v208
    v_mfma_f32_16x16x32_bf16 v[204:207], a[224:227], v[20:23], 0
    ds_read_b128 a[224:227], v1 offset:45056
    s_waitcnt lgkmcnt(5)
    v_mfma_f32_16x16x32_bf16 v[176:179], a[228:231], v[24:27], v[176:179]
    buffer_load_dwordx4 v1, s[8:11], s86 offen offset:3072 sc1 lds
    v_add_f32 v208, 1.0, v208
    v_mfma_f32_16x16x32_bf16 v[192:195], a[228:231], v[28:31], v[192:195]
    ds_read_b128 a[228:231], v1 offset:46080
    v_mul_f32 v217, v209, v217
    v_mfma_f32_16x16x32_bf16 v[184:187], a[232:235], v[24:27], v[184:187]
    v_rcp_f32 v208, v208
    v_mfma_f32_16x16x32_bf16 v[200:203], a[232:235], v[28:31], v[200:203]
    ds_read_b128 a[232:235], v1 offset:47104
    v_mul_f32 v216, v216, v208
    v_mfma_f32_16x16x32_bf16 v[180:183], a[236:239], v[24:27], v[180:183]
    s_add_u32 s86, s85, 245760
    s_add_u32 m0, s87, 114688
    v_mfma_f32_16x16x32_bf16 v[196:199], a[236:239], v[28:31], v[196:199]
    ds_read_b128 a[236:239], v1 offset:48128
    v_mul_f32_e64 v209, -v209, v9
    v_mfma_f32_16x16x32_bf16 v[188:191], a[240:243], v[24:27], v[188:191]
    buffer_load_dwordx4 v1, s[8:11], s86 offen offset:0 sc1 lds
    v_fma_f32 v10, v210, v210, v4
    v_mfma_f32_16x16x32_bf16 v[204:207], a[240:243], v[28:31], v[204:207]
    ds_read_b128 a[240:243], v1 offset:49152
    s_waitcnt lgkmcnt(5)
    v_mfma_f32_16x16x32_bf16 v[176:179], a[244:247], v[32:35], v[176:179]
    v_exp_f32 v209, v209
    v_mfma_f32_16x16x32_bf16 v[192:195], a[244:247], v[36:39], v[192:195]
    ds_read_b128 a[244:247], v1 offset:50176
    v_add_f32 v209, 1.0, v209
    v_mfma_f32_16x16x32_bf16 v[184:187], a[248:251], v[32:35], v[184:187]
    v_rcp_f32 v209, v209
    v_mfma_f32_16x16x32_bf16 v[200:203], a[248:251], v[36:39], v[200:203]
    ds_read_b128 a[248:251], v1 offset:51200
    v_mul_f32 v217, v217, v209
    v_mfma_f32_16x16x32_bf16 v[180:183], a[252:255], v[32:35], v[180:183]
    v_cvt_pk_bf16_f32 v12, v216, v217
    v_mul_f32 v218, v210, v218
    v_mfma_f32_16x16x32_bf16 v[196:199], a[252:255], v[36:39], v[196:199]
    ds_read_b128 a[252:255], v1 offset:52224
    buffer_load_dwordx4 v1, s[8:11], s86 offen offset:1024 sc1 lds
    v_mfma_f32_16x16x32_bf16 v[188:191], a[220:223], v[32:35], v[188:191]
    v_mul_f32_e64 v210, -v210, v10
    v_fma_f32 v11, v211, v211, v4
    v_mfma_f32_16x16x32_bf16 v[204:207], a[220:223], v[36:39], v[204:207]
    ds_read_b128 a[220:223], v1 offset:53248
    s_waitcnt lgkmcnt(5)
    v_mfma_f32_16x16x32_bf16 v[176:179], a[224:227], v[40:43], v[176:179]
    v_exp_f32 v210, v210
    v_mfma_f32_16x16x32_bf16 v[192:195], a[224:227], v[44:47], v[192:195]
    ds_read_b128 a[224:227], v1 offset:54272
    v_add_f32 v210, 1.0, v210
    v_mfma_f32_16x16x32_bf16 v[184:187], a[228:231], v[40:43], v[184:187]
    v_rcp_f32 v210, v210
    v_mfma_f32_16x16x32_bf16 v[200:203], a[228:231], v[44:47], v[200:203]
    ds_read_b128 a[228:231], v1 offset:55296
    v_mul_f32 v218, v218, v210
    v_mfma_f32_16x16x32_bf16 v[180:183], a[232:235], v[40:43], v[180:183]
    buffer_load_dwordx4 v1, s[8:11], s86 offen offset:2048 sc1 lds
    v_mul_f32 v219, v211, v219
    v_mfma_f32_16x16x32_bf16 v[196:199], a[232:235], v[44:47], v[196:199]
    ds_read_b128 a[232:235], v1 offset:56320
    v_mul_f32_e64 v211, -v211, v11
    v_mfma_f32_16x16x32_bf16 v[188:191], a[236:239], v[40:43], v[188:191]
    v_exp_f32 v211, v211
    v_mfma_f32_16x16x32_bf16 v[204:207], a[236:239], v[44:47], v[204:207]
    ds_read_b128 a[236:239], v1 offset:57344
    s_waitcnt lgkmcnt(5)
    v_mfma_f32_16x16x32_bf16 v[176:179], a[240:243], v[48:51], v[176:179]
    v_add_f32 v211, 1.0, v211
    v_fma_f32 v8, v212, v212, v4
    v_mfma_f32_16x16x32_bf16 v[192:195], a[240:243], v[52:55], v[192:195]
    ds_read_b128 a[240:243], v1 offset:58368
    v_mul_f32 v220, v212, v220
    v_mfma_f32_16x16x32_bf16 v[184:187], a[244:247], v[48:51], v[184:187]
    v_rcp_f32 v211, v211
    v_mfma_f32_16x16x32_bf16 v[200:203], a[244:247], v[52:55], v[200:203]
    ds_read_b128 a[244:247], v1 offset:59392
    buffer_load_dwordx4 v1, s[8:11], s86 offen offset:3072 sc1 lds
    v_mfma_f32_16x16x32_bf16 v[180:183], a[248:251], v[48:51], v[180:183]
    v_mul_f32 v219, v219, v211
    v_cvt_pk_bf16_f32 v13, v218, v219
    v_mfma_f32_16x16x32_bf16 v[196:199], a[248:251], v[52:55], v[196:199]
    ds_read_b128 a[248:251], v1 offset:60416
    v_mul_f32_e64 v212, -v212, v8
    v_mfma_f32_16x16x32_bf16 v[188:191], a[252:255], v[48:51], v[188:191]
    v_exp_f32 v212, v212
    v_mfma_f32_16x16x32_bf16 v[204:207], a[252:255], v[52:55], v[204:207]
    ds_read_b128 a[252:255], v1 offset:61440
    s_waitcnt lgkmcnt(5)
    v_mfma_f32_16x16x32_bf16 v[176:179], a[220:223], v[56:59], v[176:179]
    v_add_f32 v212, 1.0, v212
    v_fma_f32 v9, v213, v213, v4
    v_mfma_f32_16x16x32_bf16 v[192:195], a[220:223], v[60:63], v[192:195]
    ds_read_b128 a[220:223], v1 offset:62464
    v_mul_f32 v221, v213, v221
    v_mfma_f32_16x16x32_bf16 v[184:187], a[224:227], v[56:59], v[184:187]
    v_rcp_f32 v212, v212
    v_mfma_f32_16x16x32_bf16 v[200:203], a[224:227], v[60:63], v[200:203]
    ds_read_b128 a[224:227], v1 offset:63488
    v_mul_f32 v220, v220, v212
    v_mfma_f32_16x16x32_bf16 v[180:183], a[228:231], v[56:59], v[180:183]
    v_mul_f32_e64 v213, -v213, v9
    v_fma_f32 v10, v214, v214, v4
    v_mfma_f32_16x16x32_bf16 v[196:199], a[228:231], v[60:63], v[196:199]
    ds_read_b128 a[228:231], v1 offset:64512
    v_mul_f32 v222, v214, v222
    v_mfma_f32_16x16x32_bf16 v[188:191], a[232:235], v[56:59], v[188:191]
    v_exp_f32 v213, v213
    v_mfma_f32_16x16x32_bf16 v[204:207], a[232:235], v[60:63], v[204:207]
    s_waitcnt vmcnt(8)
    s_barrier
    s_add_u32 s78, s76, 0
    s_cmp_lg_u32 s52, 0
    s_cbranch_scc1 w089
    s_mov_b64 exec, 1
    v_mov_b32 v6, s78
    v_mov_b32 v7, 1
    global_atomic_add v6, v7, s[40:41] sc1
    s_mov_b64 exec, -1
w089:
    ds_read_b128 a[232:235], v2 offset:0
    s_waitcnt lgkmcnt(5)
    v_mfma_f32_16x16x32_bf16 v[176:179], a[236:239], v[64:67], v[176:179]
    s_add_u32 s86, s85, 262144
    s_add_u32 m0, s87, 0
    v_mfma_f32_16x16x32_bf16 v[192:195], a[236:239], v[68:71], v[192:195]
    ds_read_b128 a[236:239], v2 offset:1024
    v_add_f32 v213, 1.0, v213
    v_mfma_f32_16x16x32_bf16 v[184:187], a[240:243], v[64:67], v[184:187]
    buffer_load_dwordx4 v1, s[8:11], s86 offen offset:0 sc1 lds
    v_mul_f32_e64 v214, -v214, v10
    v_mfma_f32_16x16x32_bf16 v[200:203], a[240:243], v[68:71], v[200:203]
    ds_read_b128 a[240:243], v2 offset:2048
    v_fma_f32 v11, v215, v215, v4
    v_mfma_f32_16x16x32_bf16 v[180:183], a[244:247], v[64:67], v[180:183]
    v_rcp_f32 v213, v213
    v_mfma_f32_16x16x32_bf16 v[196:199], a[244:247], v[68:71], v[196:199]
    ds_read_b128 a[244:247], v2 offset:3072
    v_mul_f32 v221, v221, v213
    v_mfma_f32_16x16x32_bf16 v[188:191], a[248:251], v[64:67], v[188:191]
    v_cvt_pk_bf16_f32 v14, v220, v221
    v_mul_f32 v223, v215, v223
    v_mfma_f32_16x16x32_bf16 v[204:207], a[248:251], v[68:71], v[204:207]
    ds_read_b128 a[248:251], v2 offset:4096
    s_waitcnt lgkmcnt(5)
    v_mfma_f32_16x16x32_bf16 v[176:179], a[252:255], v[72:75], v[176:179]
    v_exp_f32 v214, v214
    v_mfma_f32_16x16x32_bf16 v[192:195], a[252:255], v[76:79], v[192:195]
    ds_read_b128 a[252:255], v2 offset:5120
    buffer_load_dwordx4 v1, s[8:11], s86 offen offset:1024 sc1 lds
    v_mfma_f32_16x16x32_bf16 v[184:187], a[220:223], v[72:75], v[184:187]
    v_add_f32 v214, 1.0, v214
    v_mul_f32_e64 v215, -v215, v11
    v_mfma_f32_16x16x32_bf16 v[200:203], a[220:223], v[76:79], v[200:203]
    ds_read_b128 a[220:223], v2 offset:6144
    v_fma_f32 v8, v224, v224, v4
    v_mfma_f32_16x16x32_bf16 v[180:183], a[224:227], v[72:75], v[180:183]
    v_rcp_f32 v214, v214
    v_mfma_f32_16x16x32_bf16 v[196:199], a[224:227], v[76:79], v[196:199]
    ds_read_b128 a[224:227], v2 offset:7168
    v_mul_f32 v222, v222, v214
    v_mfma_f32_16x16x32_bf16 v[188:191], a[228:231], v[72:75], v[188:191]
    v_exp_f32 v215, v215
    v_mfma_f32_16x16x32_bf16 v[204:207], a[228:231], v[76:79], v[204:207]
    ds_read_b128 a[228:231], v2 offset:8192
    s_waitcnt lgkmcnt(5)
    v_mfma_f32_16x16x32_bf16 v[176:179], a[232:235], v[80:83], v[176:179]
    buffer_load_dwordx4 v1, s[8:11], s86 offen offset:2048 sc1 lds
    v_add_f32 v215, 1.0, v215
    v_mfma_f32_16x16x32_bf16 v[192:195], a[232:235], v[84:87], v[192:195]
    ds_read_b128 a[232:235], v2 offset:9216
    v_mul_f32 v232, v224, v232
    v_mfma_f32_16x16x32_bf16 v[184:187], a[236:239], v[80:83], v[184:187]
    v_rcp_f32 v215, v215
    v_mfma_f32_16x16x32_bf16 v[200:203], a[236:239], v[84:87], v[200:203]
    ds_read_b128 a[236:239], v2 offset:10240
    v_mul_f32 v223, v223, v215
    v_mfma_f32_16x16x32_bf16 v[180:183], a[240:243], v[80:83], v[180:183]
    v_cvt_pk_bf16_f32 v15, v222, v223
    v_mul_f32_e64 v224, -v224, v8
    v_mfma_f32_16x16x32_bf16 v[196:199], a[240:243], v[84:87], v[196:199]
    ds_read_b128 a[240:243], v2 offset:11264
    buffer_store_dwordx4 v[12:15], v1, s[8:11], s92 offen sc1
    v_mfma_f32_16x16x32_bf16 v[188:191], a[244:247], v[80:83], v[188:191]
    v_exp_f32 v224, v224
    v_mfma_f32_16x16x32_bf16 v[204:207], a[244:247], v[84:87], v[204:207]
    ds_read_b128 a[244:247], v2 offset:12288
    s_waitcnt lgkmcnt(5)
    v_mfma_f32_16x16x32_bf16 v[176:179], a[248:251], v[88:91], v[176:179]
    buffer_load_dwordx4 v1, s[8:11], s86 offen offset:3072 sc1 lds
    v_add_f32 v224, 1.0, v224
    v_mfma_f32_16x16x32_bf16 v[192:195], a[248:251], v[92:95], v[192:195]
    ds_read_b128 a[248:251], v2 offset:13312
    v_fma_f32 v9, v225, v225, v4
    v_mfma_f32_16x16x32_bf16 v[184:187], a[252:255], v[88:91], v[184:187]
    v_rcp_f32 v224, v224
    v_mfma_f32_16x16x32_bf16 v[200:203], a[252:255], v[92:95], v[200:203]
    ds_read_b128 a[252:255], v2 offset:14336
    v_mul_f32 v232, v232, v224
    v_mfma_f32_16x16x32_bf16 v[180:183], a[220:223], v[88:91], v[180:183]
    s_add_u32 s86, s85, 278528
    s_add_u32 m0, s87, 16384
    v_mfma_f32_16x16x32_bf16 v[196:199], a[220:223], v[92:95], v[196:199]
    ds_read_b128 a[220:223], v2 offset:15360
    v_mul_f32 v233, v225, v233
    v_mfma_f32_16x16x32_bf16 v[188:191], a[224:227], v[88:91], v[188:191]
    buffer_load_dwordx4 v1, s[8:11], s86 offen offset:0 sc1 lds
    v_mul_f32_e64 v225, -v225, v9
    v_mfma_f32_16x16x32_bf16 v[204:207], a[224:227], v[92:95], v[204:207]
    ds_read_b128 a[224:227], v2 offset:16384
    s_waitcnt lgkmcnt(5)
    v_mfma_f32_16x16x32_bf16 v[176:179], a[228:231], v[96:99], v[176:179]
    v_exp_f32 v225, v225
    v_mfma_f32_16x16x32_bf16 v[192:195], a[228:231], v[100:103], v[192:195]
    ds_read_b128 a[228:231], v2 offset:17408
    v_add_f32 v225, 1.0, v225
    v_mfma_f32_16x16x32_bf16 v[184:187], a[232:235], v[96:99], v[184:187]
    v_rcp_f32 v225, v225
    v_mfma_f32_16x16x32_bf16 v[200:203], a[232:235], v[100:103], v[200:203]
    ds_read_b128 a[232:235], v2 offset:18432
    v_mul_f32 v233, v233, v225
    v_mfma_f32_16x16x32_bf16 v[180:183], a[236:239], v[96:99], v[180:183]
    v_cvt_pk_bf16_f32 v240, v232, v233
    v_fma_f32 v10, v226, v226, v4
    v_mfma_f32_16x16x32_bf16 v[196:199], a[236:239], v[100:103], v[196:199]
    ds_read_b128 a[236:239], v2 offset:19456
    buffer_load_dwordx4 v1, s[8:11], s86 offen offset:1024 sc1 lds
    v_mfma_f32_16x16x32_bf16 v[188:191], a[240:243], v[96:99], v[188:191]
    v_mul_f32 v234, v226, v234
    v_mul_f32_e64 v226, -v226, v10
    v_mfma_f32_16x16x32_bf16 v[204:207], a[240:243], v[100:103], v[204:207]
    ds_read_b128 a[240:243], v2 offset:20480
    s_waitcnt lgkmcnt(5)
    v_mfma_f32_16x16x32_bf16 v[176:179], a[244:247], v[104:107], v[176:179]
    v_exp_f32 v226, v226
    v_mfma_f32_16x16x32_bf16 v[192:195], a[244:247], v[108:111], v[192:195]
    ds_read_b128 a[244:247], v2 offset:21504
    v_add_f32 v226, 1.0, v226
    v_mfma_f32_16x16x32_bf16 v[184:187], a[248:251], v[104:107], v[184:187]
    v_rcp_f32 v226, v226
    v_mfma_f32_16x16x32_bf16 v[200:203], a[248:251], v[108:111], v[200:203]
    ds_read_b128 a[248:251], v2 offset:22528
    v_mul_f32 v234, v234, v226
    v_mfma_f32_16x16x32_bf16 v[180:183], a[252:255], v[104:107], v[180:183]
    buffer_load_dwordx4 v1, s[8:11], s86 offen offset:2048 sc1 lds
    v_fma_f32 v11, v227, v227, v4
    v_mfma_f32_16x16x32_bf16 v[196:199], a[252:255], v[108:111], v[196:199]
    ds_read_b128 a[252:255], v2 offset:23552
    v_mul_f32 v235, v227, v235
    v_mfma_f32_16x16x32_bf16 v[188:191], a[220:223], v[104:107], v[188:191]
    v_mul_f32_e64 v227, -v227, v11
    v_fma_f32 v8, v228, v228, v4
    v_mfma_f32_16x16x32_bf16 v[204:207], a[220:223], v[108:111], v[204:207]
    ds_read_b128 a[220:223], v2 offset:24576
    s_waitcnt lgkmcnt(5)
    v_mfma_f32_16x16x32_bf16 v[176:179], a[224:227], v[112:115], v[176:179]
    v_exp_f32 v227, v227
    v_mfma_f32_16x16x32_bf16 v[192:195], a[224:227], v[116:119], v[192:195]
    ds_read_b128 a[224:227], v2 offset:25600
    v_add_f32 v227, 1.0, v227
    v_mfma_f32_16x16x32_bf16 v[184:187], a[228:231], v[112:115], v[184:187]
    v_rcp_f32 v227, v227
    v_mfma_f32_16x16x32_bf16 v[200:203], a[228:231], v[116:119], v[200:203]
    ds_read_b128 a[228:231], v2 offset:26624
    buffer_load_dwordx4 v1, s[8:11], s86 offen offset:3072 sc1 lds
    v_mfma_f32_16x16x32_bf16 v[180:183], a[232:235], v[112:115], v[180:183]
    v_mul_f32 v235, v235, v227
    v_cvt_pk_bf16_f32 v241, v234, v235
    v_mfma_f32_16x16x32_bf16 v[196:199], a[232:235], v[116:119], v[196:199]
    ds_read_b128 a[232:235], v2 offset:27648
    v_mul_f32 v236, v228, v236
    v_mfma_f32_16x16x32_bf16 v[188:191], a[236:239], v[112:115], v[188:191]
    v_mul_f32_e64 v228, -v228, v8
    v_fma_f32 v9, v229, v229, v4
    v_mfma_f32_16x16x32_bf16 v[204:207], a[236:239], v[116:119], v[204:207]
    ds_read_b128 a[236:239], v2 offset:28672
    s_waitcnt lgkmcnt(5)
    v_mfma_f32_16x16x32_bf16 v[176:179], a[240:243], v[120:123], v[176:179]
    v_exp_f32 v228, v228
    v_mfma_f32_16x16x32_bf16 v[192:195], a[240:243], v[124:127], v[192:195]
    ds_read_b128 a[240:243], v2 offset:29696
    v_add_f32 v228, 1.0, v228
    v_mfma_f32_16x16x32_bf16 v[184:187], a[244:247], v[120:123], v[184:187]
    v_rcp_f32 v228, v228
    v_mfma_f32_16x16x32_bf16 v[200:203], a[244:247], v[124:127], v[200:203]
    ds_read_b128 a[244:247], v2 offset:30720
    v_mul_f32 v236, v236, v228
    v_mfma_f32_16x16x32_bf16 v[180:183], a[248:251], v[120:123], v[180:183]
    v_mul_f32 v237, v229, v237
    v_mul_f32_e64 v229, -v229, v9
    v_mfma_f32_16x16x32_bf16 v[196:199], a[248:251], v[124:127], v[196:199]
    ds_read_b128 a[248:251], v2 offset:31744
    v_fma_f32 v10, v230, v230, v4
    v_mfma_f32_16x16x32_bf16 v[188:191], a[252:255], v[120:123], v[188:191]
    v_exp_f32 v229, v229
    v_mfma_f32_16x16x32_bf16 v[204:207], a[252:255], v[124:127], v[204:207]
    s_waitcnt vmcnt(9)
    s_barrier
    ds_read_b128 a[252:255], v2 offset:32768
    s_waitcnt lgkmcnt(5)
    v_mfma_f32_16x16x32_bf16 v[176:179], a[220:223], v[128:131], v[176:179]
    v_add_f32 v229, 1.0, v229
    v_mul_f32 v238, v230, v238
    v_mfma_f32_16x16x32_bf16 v[192:195], a[220:223], v[132:135], v[192:195]
    ds_read_b128 a[220:223], v2 offset:33792
    v_mul_f32_e64 v230, -v230, v10
    v_mfma_f32_16x16x32_bf16 v[184:187], a[224:227], v[128:131], v[184:187]
    global_load_dword v247, v244, s[40:41] sc1
    v_fma_f32 v11, v231, v231, v4
    v_mfma_f32_16x16x32_bf16 v[200:203], a[224:227], v[132:135], v[200:203]
    ds_read_b128 a[224:227], v2 offset:34816
    v_mul_f32 v239, v231, v239
    v_mfma_f32_16x16x32_bf16 v[180:183], a[228:231], v[128:131], v[180:183]
    v_rcp_f32 v229, v229
    v_mfma_f32_16x16x32_bf16 v[196:199], a[228:231], v[132:135], v[196:199]
    ds_read_b128 a[228:231], v2 offset:35840
    v_mul_f32 v237, v237, v229
    v_mfma_f32_16x16x32_bf16 v[188:191], a[232:235], v[128:131], v[188:191]
    v_cvt_pk_bf16_f32 v242, v236, v237
    v_mul_f32_e64 v231, -v231, v11
    v_mfma_f32_16x16x32_bf16 v[204:207], a[232:235], v[132:135], v[204:207]
    ds_read_b128 a[232:235], v2 offset:36864
    s_waitcnt lgkmcnt(5)
    v_mfma_f32_16x16x32_bf16 v[176:179], a[236:239], v[136:139], v[176:179]
    v_exp_f32 v230, v230
    v_mfma_f32_16x16x32_bf16 v[192:195], a[236:239], v[140:143], v[192:195]
    ds_read_b128 a[236:239], v2 offset:37888
    v_add_f32 v230, 1.0, v230
    v_mfma_f32_16x16x32_bf16 v[184:187], a[240:243], v[136:139], v[184:187]
    v_rcp_f32 v230, v230
    v_mfma_f32_16x16x32_bf16 v[200:203], a[240:243], v[140:143], v[200:203]
    ds_read_b128 a[240:243], v2 offset:38912
    v_mul_f32 v238, v238, v230
    v_mfma_f32_16x16x32_bf16 v[180:183], a[244:247], v[136:139], v[180:183]
    v_exp_f32 v231, v231
    v_mfma_f32_16x16x32_bf16 v[196:199], a[244:247], v[140:143], v[196:199]
    ds_read_b128 a[244:247], v2 offset:39936
    v_add_f32 v231, 1.0, v231
    v_mfma_f32_16x16x32_bf16 v[188:191], a[248:251], v[136:139], v[188:191]
    v_rcp_f32 v231, v231
    v_mfma_f32_16x16x32_bf16 v[204:207], a[248:251], v[140:143], v[204:207]
    ds_read_b128 a[248:251], v2 offset:40960
    s_waitcnt lgkmcnt(5)
    v_mfma_f32_16x16x32_bf16 v[176:179], a[252:255], v[144:147], v[176:179]
    v_mul_f32 v239, v239, v231
    v_cvt_pk_bf16_f32 v243, v238, v239
    v_mfma_f32_16x16x32_bf16 v[192:195], a[252:255], v[148:151], v[192:195]
    ds_read_b128 a[252:255], v2 offset:41984
    buffer_store_dwordx4 v[240:243], v1, s[8:11], s80 offen sc1
    v_mfma_f32_16x16x32_bf16 v[184:187], a[220:223], v[144:147], v[184:187]
    s_sub_u32 s92, s92, 4096
    s_sub_u32 s80, s80, 4096
    v_mfma_f32_16x16x32_bf16 v[200:203], a[220:223], v[148:151], v[200:203]
    ds_read_b128 a[220:223], v2 offset:43008
    v_mfma_f32_16x16x32_bf16 v[180:183], a[224:227], v[144:147], v[180:183]
    v_mfma_f32_16x16x32_bf16 v[196:199], a[224:227], v[148:151], v[196:199]
    ds_read_b128 a[224:227], v2 offset:44032
    v_mfma_f32_16x16x32_bf16 v[188:191], a[228:231], v[144:147], v[188:191]
    v_mfma_f32_16x16x32_bf16 v[204:207], a[228:231], v[148:151], v[204:207]
    ds_read_b128 a[228:231], v2 offset:45056
    s_waitcnt lgkmcnt(5)
    v_mfma_f32_16x16x32_bf16 v[176:179], a[232:235], v[152:155], v[176:179]
    v_mfma_f32_16x16x32_bf16 v[192:195], a[232:235], v[156:159], v[192:195]
    ds_read_b128 a[232:235], v2 offset:46080
    v_mfma_f32_16x16x32_bf16 v[184:187], a[236:239], v[152:155], v[184:187]
    v_mfma_f32_16x16x32_bf16 v[200:203], a[236:239], v[156:159], v[200:203]
    ds_read_b128 a[236:239], v2 offset:47104
    v_mfma_f32_16x16x32_bf16 v[180:183], a[240:243], v[152:155], v[180:183]
    v_mfma_f32_16x16x32_bf16 v[196:199], a[240:243], v[156:159], v[196:199]
    ds_read_b128 a[240:243], v2 offset:48128
    v_mfma_f32_16x16x32_bf16 v[188:191], a[244:247], v[152:155], v[188:191]
    v_mfma_f32_16x16x32_bf16 v[204:207], a[244:247], v[156:159], v[204:207]
    ds_read_b128 a[244:247], v2 offset:49152
    s_waitcnt lgkmcnt(5)
    v_mfma_f32_16x16x32_bf16 v[176:179], a[248:251], v[160:163], v[176:179]
    v_mfma_f32_16x16x32_bf16 v[192:195], a[248:251], v[164:167], v[192:195]
    ds_read_b128 a[248:251], v2 offset:50176
    v_mfma_f32_16x16x32_bf16 v[184:187], a[252:255], v[160:163], v[184:187]
    v_mfma_f32_16x16x32_bf16 v[200:203], a[252:255], v[164:167], v[200:203]
    ds_read_b128 a[252:255], v2 offset:51200
    v_mfma_f32_16x16x32_bf16 v[180:183], a[220:223], v[160:163], v[180:183]
    v_mfma_f32_16x16x32_bf16 v[196:199], a[220:223], v[164:167], v[196:199]
    ds_read_b128 a[220:223], v2 offset:52224
    v_mfma_f32_16x16x32_bf16 v[188:191], a[224:227], v[160:163], v[188:191]
    v_mfma_f32_16x16x32_bf16 v[204:207], a[224:227], v[164:167], v[204:207]
    ds_read_b128 a[224:227], v2 offset:53248
    s_waitcnt lgkmcnt(5)
    v_mfma_f32_16x16x32_bf16 v[176:179], a[228:231], v[168:171], v[176:179]
    v_mfma_f32_16x16x32_bf16 v[192:195], a[228:231], v[172:175], v[192:195]
    ds_read_b128 a[228:231], v2 offset:54272
    v_mfma_f32_16x16x32_bf16 v[184:187], a[232:235], v[168:171], v[184:187]
    v_mfma_f32_16x16x32_bf16 v[200:203], a[232:235], v[172:175], v[200:203]
    ds_read_b128 a[232:235], v2 offset:55296
    v_mfma_f32_16x16x32_bf16 v[180:183], a[236:239], v[168:171], v[180:183]
    v_mfma_f32_16x16x32_bf16 v[196:199], a[236:239], v[172:175], v[196:199]
    ds_read_b128 a[236:239], v2 offset:56320
    v_mfma_f32_16x16x32_bf16 v[188:191], a[240:243], v[168:171], v[188:191]
    v_mfma_f32_16x16x32_bf16 v[204:207], a[240:243], v[172:175], v[204:207]
    ds_read_b128 a[240:243], v2 offset:57344
    s_waitcnt vmcnt(1)
    v_cmp_gt_u32 vcc, 16, v247
    s_cbranch_vccz rdy90
    s_mov_b32 s84, 0
spin91:
    global_load_dword v247, v244, s[40:41] sc1
    s_add_u32 s84, s84, 1
    s_cmp_gt_u32 s84, 2000000
    s_cbranch_scc1 spun92
    s_waitcnt vmcnt(0)
    v_cmp_gt_u32 vcc, 16, v247
    s_cbranch_vccnz spin91
spun92:
    s_waitcnt vmcnt(0)
rdy90:
    s_waitcnt lgkmcnt(5)
    v_mfma_f32_16x16x32_bf16 v[208:211], a[244:247], v[16:19], 0
    v_mfma_f32_16x16x32_bf16 v[216:219], a[244:247], v[20:23], 0
    ds_read_b128 a[244:247], v2 offset:58368
    v_mfma_f32_16x16x32_bf16 v[212:215], a[248:251], v[16:19], 0
    v_mfma_f32_16x16x32_bf16 v[220:223], a[248:251], v[20:23], 0
    ds_read_b128 a[248:251], v2 offset:59392
    v_fma_f32 v8, v176, v176, v4
    v_mfma_f32_16x16x32_bf16 v[208:211], a[252:255], v[24:27], v[208:211]
    buffer_load_dwordx4 v[16:19], v1, s[8:11], s88 offen offset:0 sc1
    v_mul_f32 v184, v176, v184
    v_mul_f32_e64 v176, -v176, v8
    v_exp_f32 v176, v176
    v_mfma_f32_16x16x32_bf16 v[216:219], a[252:255], v[28:31], v[216:219]
    ds_read_b128 a[252:255], v2 offset:60416
    v_add_f32 v176, 1.0, v176
    v_mfma_f32_16x16x32_bf16 v[212:215], a[220:223], v[24:27], v[212:215]
    v_rcp_f32 v176, v176
    v_mfma_f32_16x16x32_bf16 v[220:223], a[220:223], v[28:31], v[220:223]
    ds_read_b128 a[220:223], v2 offset:61440
    s_waitcnt lgkmcnt(5)
    v_mfma_f32_16x16x32_bf16 v[208:211], a[224:227], v[32:35], v[208:211]
    buffer_load_dwordx4 v[20:23], v1, s[8:11], s89 offen offset:0 sc1
    v_mul_f32 v184, v184, v176
    v_fma_f32 v9, v177, v177, v4
    v_mul_f32 v185, v177, v185
    v_mul_f32_e64 v177, -v177, v9
    v_fma_f32 v10, v178, v178, v4
    v_mfma_f32_16x16x32_bf16 v[216:219], a[224:227], v[36:39], v[216:219]
    ds_read_b128 a[224:227], v2 offset:62464
    v_mul_f32 v186, v178, v186
    v_mfma_f32_16x16x32_bf16 v[212:215], a[228:231], v[32:35], v[212:215]
    v_exp_f32 v177, v177
    v_mfma_f32_16x16x32_bf16 v[220:223], a[228:231], v[36:39], v[220:223]
    ds_read_b128 a[228:231], v2 offset:63488
    v_add_f32 v177, 1.0, v177
    v_mfma_f32_16x16x32_bf16 v[208:211], a[232:235], v[40:43], v[208:211]
    buffer_load_dwordx4 v[24:27], v1, s[8:11], s90 offen offset:0 sc1
    v_rcp_f32 v177, v177
    v_mfma_f32_16x16x32_bf16 v[216:219], a[232:235], v[44:47], v[216:219]
    ds_read_b128 a[232:235], v2 offset:64512
    v_mul_f32 v185, v185, v177
    v_mfma_f32_16x16x32_bf16 v[212:215], a[236:239], v[40:43], v[212:215]
    v_cvt_pk_bf16_f32 v12, v184, v185
    v_mul_f32_e64 v178, -v178, v10
    v_exp_f32 v178, v178
    v_mfma_f32_16x16x32_bf16 v[220:223], a[236:239], v[44:47], v[220:223]
    s_barrier
    ds_read_b128 a[236:239], v1 offset:0
    s_waitcnt lgkmcnt(5)
    v_mfma_f32_16x16x32_bf16 v[208:211], a[240:243], v[48:51], v[208:211]
    buffer_load_dwordx4 v[28:31], v1, s[8:11], s91 offen offset:0 sc1
    v_add_f32 v178, 1.0, v178
    v_rcp_f32 v178, v178
    v_mfma_f32_16x16x32_bf16 v[216:219], a[240:243], v[52:55], v[216:219]
    ds_read_b128 a[240:243], v1 offset:1024
    v_mul_f32 v186, v186, v178
    v_mfma_f32_16x16x32_bf16 v[212:215], a[244:247], v[48:51], v[212:215]
    v_fma_f32 v11, v179, v179, v4
    v_mul_f32 v187, v179, v187
    v_mul_f32_e64 v179, -v179, v11
    v_exp_f32 v179, v179
    v_mfma_f32_16x16x32_bf16 v[220:223], a[244:247], v[52:55], v[220:223]
    ds_read_b128 a[244:247], v1 offset:2048
    v_add_f32 v179, 1.0, v179
    v_mfma_f32_16x16x32_bf16 v[208:211], a[248:251], v[56:59], v[208:211]
    s_waitcnt vmcnt(4)
    s_barrier
    s_add_u32 s78, s76, 64
    s_cmp_lg_u32 s52, 0
    s_cbranch_scc1 w093
    s_mov_b64 exec, 1
    v_mov_b32 v6, s78
    v_mov_b32 v7, 1
    global_atomic_add v6, v7, s[40:41] sc1
    s_mov_b64 exec, -1
w093:
    s_add_u32 s81, s94, 32768
    buffer_load_dwordx4 v[224:227], v1, s[8:11], s81 offen offset:3072 sc1
    v_rcp_f32 v179, v179
    v_mfma_f32_16x16x32_bf16 v[216:219], a[248:251], v[60:63], v[216:219]
    ds_read_b128 a[248:251], v1 offset:3072
    v_mul_f32 v187, v187, v179
    v_mfma_f32_16x16x32_bf16 v[212:215], a[252:255], v[56:59], v[212:215]
    v_cvt_pk_bf16_f32 v13, v186, v187
    v_fma_f32 v8, v180, v180, v4
    v_mul_f32 v188, v180, v188
    v_mul_f32_e64 v180, -v180, v8
    v_exp_f32 v180, v180
    v_mfma_f32_16x16x32_bf16 v[220:223], a[252:255], v[60:63], v[220:223]
    ds_read_b128 a[252:255], v1 offset:4096
    s_waitcnt lgkmcnt(5)
    v_mfma_f32_16x16x32_bf16 v[208:211], a[220:223], v[64:67], v[208:211]
    buffer_load_dwordx4 v[32:35], v1, s[8:11], s88 offen offset:1024 sc1
    v_add_f32 v180, 1.0, v180
    v_rcp_f32 v180, v180
    v_mfma_f32_16x16x32_bf16 v[216:219], a[220:223], v[68:71], v[216:219]
    ds_read_b128 a[220:223], v1 offset:5120
    v_mul_f32 v188, v188, v180
    v_mfma_f32_16x16x32_bf16 v[212:215], a[224:227], v[64:67], v[212:215]
    v_fma_f32 v9, v181, v181, v4
    v_mul_f32 v189, v181, v189
    v_mul_f32_e64 v181, -v181, v9
    v_exp_f32 v181, v181
    v_mfma_f32_16x16x32_bf16 v[220:223], a[224:227], v[68:71], v[220:223]
    ds_read_b128 a[224:227], v1 offset:6144
    v_add_f32 v181, 1.0, v181
    v_mfma_f32_16x16x32_bf16 v[208:211], a[228:231], v[72:75], v[208:211]
    buffer_load_dwordx4 v[36:39], v1, s[8:11], s89 offen offset:1024 sc1
    v_rcp_f32 v181, v181
    v_mfma_f32_16x16x32_bf16 v[216:219], a[228:231], v[76:79], v[216:219]
    ds_read_b128 a[228:231], v1 offset:7168
    v_mul_f32 v189, v189, v181
    v_mfma_f32_16x16x32_bf16 v[212:215], a[232:235], v[72:75], v[212:215]
    v_cvt_pk_bf16_f32 v14, v188, v189
    v_fma_f32 v10, v182, v182, v4
    v_mul_f32 v190, v182, v190
    v_mul_f32_e64 v182, -v182, v10
    v_exp_f32 v182, v182
    v_mfma_f32_16x16x32_bf16 v[220:223], a[232:235], v[76:79], v[220:223]
    ds_read_b128 a[232:235], v1 offset:8192
    s_waitcnt lgkmcnt(5)
    v_mfma_f32_16x16x32_bf16 v[208:211], a[236:239], v[80:83], v[208:211]
    buffer_load_dwordx4 v[40:43], v1, s[8:11], s90 offen offset:1024 sc1
    v_add_f32 v182, 1.0, v182
    v_rcp_f32 v182, v182
    v_mfma_f32_16x16x32_bf16 v[216:219], a[236:239], v[84:87], v[216:219]
    ds_read_b128 a[236:239], v1 offset:9216
    v_mul_f32 v190, v190, v182
    v_mfma_f32_16x16x32_bf16 v[212:215], a[240:243], v[80:83], v[212:215]
    v_fma_f32 v11, v183, v183, v4
    v_mul_f32 v191, v183, v191
    v_mul_f32_e64 v183, -v183, v11
    v_exp_f32 v183, v183
    v_mfma_f32_16x16x32_bf16 v[220:223], a[240:243], v[84:87], v[220:223]
    ds_read_b128 a[240:243], v1 offset:10240
    v_add_f32 v183, 1.0, v183
    v_mfma_f32_16x16x32_bf16 v[208:211], a[244:247], v[88:91], v[208:211]
    s_add_u32 s81, s94, 36864
    buffer_load_dwordx4 v[228:231], v1, s[8:11], s81 offen offset:0 sc1
    v_rcp_f32 v183, v183
    v_mfma_f32_16x16x32_bf16 v[216:219], a[244:247], v[92:95], v[216:219]
    ds_read_b128 a[244:247], v1 offset:11264
    v_mul_f32 v191, v191, v183
    v_mfma_f32_16x16x32_bf16 v[212:215], a[248:251], v[88:91], v[212:215]
    v_cvt_pk_bf16_f32 v15, v190, v191
    v_fma_f32 v8, v192, v192, v4
    v_mul_f32 v200, v192, v200
    v_mul_f32_e64 v192, -v192, v8
    v_exp_f32 v192, v192
    v_mfma_f32_16x16x32_bf16 v[220:223], a[248:251], v[92:95], v[220:223]
    ds_read_b128 a[248:251], v1 offset:12288
    s_waitcnt lgkmcnt(5)
    v_mfma_f32_16x16x32_bf16 v[208:211], a[252:255], v[96:99], v[208:211]
    buffer_load_dwordx4 v[44:47], v1, s[8:11], s91 offen offset:1024 sc1
    buffer_store_dwordx4 v[12:15], v1, s[8:11], s92 offen sc1
    v_add_f32 v192, 1.0, v192
    v_rcp_f32 v192, v192
    v_mfma_f32_16x16x32_bf16 v[216:219], a[252:255], v[100:103], v[216:219]
    ds_read_b128 a[252:255], v1 offset:13312
    v_mul_f32 v200, v200, v192
    v_mfma_f32_16x16x32_bf16 v[212:215], a[220:223], v[96:99], v[212:215]
    v_fma_f32 v9, v193, v193, v4
    v_mul_f32 v201, v193, v201
    v_mul_f32_e64 v193, -v193, v9
    v_exp_f32 v193, v193
    v_mfma_f32_16x16x32_bf16 v[220:223], a[220:223], v[100:103], v[220:223]
    ds_read_b128 a[220:223], v1 offset:14336
    v_add_f32 v193, 1.0, v193
    v_mfma_f32_16x16x32_bf16 v[208:211], a[224:227], v[104:107], v[208:211]
    buffer_load_dwordx4 v[48:51], v1, s[8:11], s88 offen offset:2048 sc1
    v_rcp_f32 v193, v193
    v_mfma_f32_16x16x32_bf16 v[216:219], a[224:227], v[108:111], v[216:219]
    ds_read_b128 a[224:227], v1 offset:15360
    v_mul_f32 v201, v201, v193
    v_mfma_f32_16x16x32_bf16 v[212:215], a[228:231], v[104:107], v[212:215]
    v_cvt_pk_bf16_f32 v240, v200, v201
    v_fma_f32 v10, v194, v194, v4
    v_mul_f32 v202, v194, v202
    v_mul_f32_e64 v194, -v194, v10
    v_exp_f32 v194, v194
    v_mfma_f32_16x16x32_bf16 v[220:223], a[228:231], v[108:111], v[220:223]
    ds_read_b128 a[228:231], v1 offset:16384
    s_branch L_past10
L_page10:
    s_setpc_b64 s[98:99]
L_past10:
    s_waitcnt lgkmcnt(5)
    v_mfma_f32_16x16x32_bf16 v[208:211], a[232:235], v[112:115], v[208:211]
    buffer_load_dwordx4 v[52:55], v1, s[8:11], s89 offen offset:2048 sc1
    v_add_f32 v194, 1.0, v194
    v_rcp_f32 v194, v194
    v_mfma_f32_16x16x32_bf16 v[216:219], a[232:235], v[116:119], v[216:219]
    ds_read_b128 a[232:235], v1 offset:17408
    v_mul_f32 v202, v202, v194
    v_mfma_f32_16x16x32_bf16 v[212:215], a[236:239], v[112:115], v[212:215]
    v_fma_f32 v11, v195, v195, v4
    v_mul_f32 v203, v195, v203
    v_mul_f32_e64 v195, -v195, v11
    v_exp_f32 v195, v195
    v_mfma_f32_16x16x32_bf16 v[220:223], a[236:239], v[116:119], v[220:223]
    ds_read_b128 a[236:239], v1 offset:18432
    v_add_f32 v195, 1.0, v195
    v_mfma_f32_16x16x32_bf16 v[208:211], a[240:243], v[120:123], v[208:211]
    global_load_dword v247, v245, s[40:41] sc1
    buffer_load_dwordx4 v[232:235], v1, s[8:11], s81 offen offset:1024 sc1
    v_rcp_f32 v195, v195
    v_mfma_f32_16x16x32_bf16 v[216:219], a[240:243], v[124:127], v[216:219]
    ds_read_b128 a[240:243], v1 offset:19456
    v_mul_f32 v203, v203, v195
    v_mfma_f32_16x16x32_bf16 v[212:215], a[244:247], v[120:123], v[212:215]
    v_cvt_pk_bf16_f32 v241, v202, v203
    v_fma_f32 v8, v196, v196, v4
    v_mul_f32 v204, v196, v204
    v_mul_f32_e64 v196, -v196, v8
    v_exp_f32 v196, v196
    v_mfma_f32_16x16x32_bf16 v[220:223], a[244:247], v[124:127], v[220:223]
    ds_read_b128 a[244:247], v1 offset:20480
    s_waitcnt lgkmcnt(5)
    v_mfma_f32_16x16x32_bf16 v[208:211], a[248:251], v[128:131], v[208:211]
    buffer_load_dwordx4 v[56:59], v1, s[8:11], s90 offen offset:2048 sc1
    v_add_f32 v196, 1.0, v196
    v_rcp_f32 v196, v196
    v_mfma_f32_16x16x32_bf16 v[216:219], a[248:251], v[132:135], v[216:219]
    ds_read_b128 a[248:251], v1 offset:21504
    v_mul_f32 v204, v204, v196
    v_mfma_f32_16x16x32_bf16 v[212:215], a[252:255], v[128:131], v[212:215]
    v_fma_f32 v9, v197, v197, v4
    v_mul_f32 v205, v197, v205
    v_mul_f32_e64 v197, -v197, v9
    v_exp_f32 v197, v197
    v_mfma_f32_16x16x32_bf16 v[220:223], a[252:255], v[132:135], v[220:223]
    ds_read_b128 a[252:255], v1 offset:22528
    v_add_f32 v197, 1.0, v197
    v_mfma_f32_16x16x32_bf16 v[208:211], a[220:223], v[136:139], v[208:211]
    buffer_load_dwordx4 v[60:63], v1, s[8:11], s91 offen offset:2048 sc1
    v_rcp_f32 v197, v197
    v_mfma_f32_16x16x32_bf16 v[216:219], a[220:223], v[140:143], v[216:219]
    ds_read_b128 a[220:223], v1 offset:23552
    v_mul_f32 v205, v205, v197
    v_mfma_f32_16x16x32_bf16 v[212:215], a[224:227], v[136:139], v[212:215]
    v_cvt_pk_bf16_f32 v242, v204, v205
    v_fma_f32 v10, v198, v198, v4
    v_mul_f32 v206, v198, v206
    v_mul_f32_e64 v198, -v198, v10
    v_exp_f32 v198, v198
    v_mfma_f32_16x16x32_bf16 v[220:223], a[224:227], v[140:143], v[220:223]
    v_add_f32 v198, 1.0, v198
    s_waitcnt lgkmcnt(4)
    v_mfma_f32_16x16x32_bf16 v[208:211], a[228:231], v[144:147], v[208:211]
    buffer_load_dwordx4 v[64:67], v1, s[8:11], s88 offen offset:3072 sc1
    v_rcp_f32 v198, v198
    v_mfma_f32_16x16x32_bf16 v[216:219], a[228:231], v[148:151], v[216:219]
    v_mul_f32 v206, v206, v198
    v_fma_f32 v11, v199, v199, v4
    v_mfma_f32_16x16x32_bf16 v[212:215], a[232:235], v[144:147], v[212:215]
    v_mul_f32 v207, v199, v207
    v_mul_f32_e64 v199, -v199, v11
    v_exp_f32 v199, v199
    v_mfma_f32_16x16x32_bf16 v[220:223], a[232:235], v[148:151], v[220:223]
    v_add_f32 v199, 1.0, v199
    v_mfma_f32_16x16x32_bf16 v[208:211], a[236:239], v[152:155], v[208:211]
    buffer_load_dwordx4 v[236:239], v1, s[8:11], s81 offen offset:2048 sc1
    v_rcp_f32 v199, v199
    v_mfma_f32_16x16x32_bf16 v[216:219], a[236:239], v[156:159], v[216:219]
    v_mul_f32 v207, v207, v199
    v_cvt_pk_bf16_f32 v243, v206, v207
    v_mfma_f32_16x16x32_bf16 v[212:215], a[240:243], v[152:155], v[212:215]
    buffer_store_dwordx4 v[240:243], v1, s[8:11], s80 offen sc1
    v_mfma_f32_16x16x32_bf16 v[220:223], a[240:243], v[156:159], v[220:223]
    s_waitcnt lgkmcnt(0)
    v_mfma_f32_16x16x32_bf16 v[208:211], a[244:247], v[160:163], v[208:211]
    buffer_load_dwordx4 v[68:71], v1, s[8:11], s89 offen offset:3072 sc1
    v_mfma_f32_16x16x32_bf16 v[216:219], a[244:247], v[164:167], v[216:219]
    v_mfma_f32_16x16x32_bf16 v[212:215], a[248:251], v[160:163], v[212:215]
    v_mfma_f32_16x16x32_bf16 v[220:223], a[248:251], v[164:167], v[220:223]
    v_mfma_f32_16x16x32_bf16 v[208:211], a[252:255], v[168:171], v[208:211]
    buffer_load_dwordx4 v[72:75], v1, s[8:11], s90 offen offset:3072 sc1
    v_mfma_f32_16x16x32_bf16 v[216:219], a[252:255], v[172:175], v[216:219]
    v_mfma_f32_16x16x32_bf16 v[212:215], a[220:223], v[168:171], v[212:215]
    v_mfma_f32_16x16x32_bf16 v[220:223], a[220:223], v[172:175], v[220:223]
    s_waitcnt vmcnt(21)
    v_mfma_f32_16x16x32_bf16 v[80:83], a[140:143], v[16:19], 0
    buffer_load_dwordx4 v[76:79], v1, s[8:11], s91 offen offset:3072 sc1
    v_mfma_f32_16x16x32_bf16 v[84:87], a[144:147], v[16:19], 0
    v_mfma_f32_16x16x32_bf16 v[88:91], a[148:151], v[16:19], 0
    v_mfma_f32_16x16x32_bf16 v[92:95], a[152:155], v[16:19], 0
    v_fma_f32 v8, v208, v208, v4
    v_mul_f32 v212, v208, v212
    v_mfma_f32_16x16x32_bf16 v[96:99], a[156:159], v[16:19], 0
    v_mul_f32_e64 v208, -v208, v8
    v_exp_f32 v208, v208
    s_waitcnt vmcnt(21)
    v_mfma_f32_16x16x32_bf16 v[100:103], a[140:143], v[20:23], 0
    v_add_f32 v208, 1.0, v208
    v_fma_f32 v9, v209, v209, v4
    v_mfma_f32_16x16x32_bf16 v[104:107], a[144:147], v[20:23], 0
    v_rcp_f32 v208, v208
    v_mfma_f32_16x16x32_bf16 v[108:111], a[148:151], v[20:23], 0
    buffer_load_dwordx4 v[160:163], v1, s[8:11], s81 offen offset:3072 sc1
    v_mul_f32 v212, v212, v208
    v_mfma_f32_16x16x32_bf16 v[112:115], a[152:155], v[20:23], 0
    v_mul_f32 v213, v209, v213
    v_mul_f32_e64 v209, -v209, v9
    v_exp_f32 v209, v209
    v_mfma_f32_16x16x32_bf16 v[116:119], a[156:159], v[20:23], 0
    v_add_f32 v209, 1.0, v209
    s_waitcnt vmcnt(21)
    v_mfma_f32_16x16x32_bf16 v[120:123], a[140:143], v[24:27], 0
    v_rcp_f32 v209, v209
    v_mfma_f32_16x16x32_bf16 v[124:127], a[144:147], v[24:27], 0
    v_mul_f32 v213, v213, v209
    v_cvt_pk_bf16_f32 v12, v212, v213
    v_mfma_f32_16x16x32_bf16 v[128:131], a[148:151], v[24:27], 0
    v_fma_f32 v10, v210, v210, v4
    v_mul_f32 v214, v210, v214
    v_mul_f32_e64 v210, -v210, v10
    v_fma_f32 v11, v211, v211, v4
    v_mfma_f32_16x16x32_bf16 v[132:135], a[152:155], v[24:27], 0
    v_exp_f32 v210, v210
    v_mfma_f32_16x16x32_bf16 v[136:139], a[156:159], v[24:27], 0
    v_add_f32 v210, 1.0, v210
    v_rcp_f32 v210, v210
    s_waitcnt vmcnt(20)
    v_mfma_f32_16x16x32_bf16 v[140:143], a[140:143], v[28:31], 0
    v_mul_f32 v214, v214, v210
    v_mul_f32 v215, v211, v215
    v_mfma_f32_16x16x32_bf16 v[144:147], a[144:147], v[28:31], 0
    v_mul_f32_e64 v211, -v211, v11
    v_exp_f32 v211, v211
    v_mfma_f32_16x16x32_bf16 v[148:151], a[148:151], v[28:31], 0
    s_waitcnt vmcnt(10)
    v_cmp_gt_u32 vcc, 16, v247
    s_cbranch_vccz rdy94
    s_mov_b32 s84, 0
spin95:
    global_load_dword v247, v245, s[40:41] sc1
    s_add_u32 s84, s84, 1
    s_cmp_gt_u32 s84, 2000000
    s_cbranch_scc1 spun96
    s_waitcnt vmcnt(0)
    v_cmp_gt_u32 vcc, 16, v247
    s_cbranch_vccnz spin95
spun96:
    s_waitcnt vmcnt(0)
rdy94:
    v_mfma_f32_16x16x32_bf16 v[152:155], a[152:155], v[28:31], 0
    s_sub_u32 s88, s88, 4096
    buffer_load_dwordx4 v[16:19], v1, s[8:11], s88 offen offset:0 sc1
    v_add_f32 v211, 1.0, v211
    v_fma_f32 v8, v216, v216, v4
    v_mfma_f32_16x16x32_bf16 v[156:159], a[156:159], v[28:31], 0
    v_rcp_f32 v211, v211
    v_mfma_f32_16x16x32_bf16 v[80:83], a[160:163], v[32:35], v[80:83]
    v_mul_f32 v215, v215, v211
    v_cvt_pk_bf16_f32 v13, v214, v215
    v_mul_f32 v220, v216, v220
    v_mul_f32_e64 v216, -v216, v8
    v_mfma_f32_16x16x32_bf16 v[84:87], a[164:167], v[32:35], v[84:87]
    v_exp_f32 v216, v216
    v_mfma_f32_16x16x32_bf16 v[88:91], a[168:171], v[32:35], v[88:91]
    s_sub_u32 s89, s89, 4096
    buffer_load_dwordx4 v[20:23], v1, s[8:11], s89 offen offset:0 sc1
    v_add_f32 v216, 1.0, v216
    v_fma_f32 v9, v217, v217, v4
    v_mfma_f32_16x16x32_bf16 v[92:95], a[172:175], v[32:35], v[92:95]
    v_rcp_f32 v216, v216
    v_mfma_f32_16x16x32_bf16 v[96:99], a[176:179], v[32:35], v[96:99]
    v_mul_f32 v220, v220, v216
    v_mul_f32 v221, v217, v221
    v_mul_f32_e64 v217, -v217, v9
    v_fma_f32 v10, v218, v218, v4
    v_mfma_f32_16x16x32_bf16 v[100:103], a[160:163], v[36:39], v[100:103]
    v_exp_f32 v217, v217
    v_mfma_f32_16x16x32_bf16 v[104:107], a[164:167], v[36:39], v[104:107]
    s_add_u32 s81, s94, 61440
    buffer_load_dwordx4 v[164:167], v1, s[8:11], s81 offen offset:0 sc1
    v_add_f32 v217, 1.0, v217
    v_mul_f32 v222, v218, v222
    v_mfma_f32_16x16x32_bf16 v[108:111], a[168:171], v[36:39], v[108:111]
    v_rcp_f32 v217, v217
    v_mfma_f32_16x16x32_bf16 v[112:115], a[172:175], v[36:39], v[112:115]
    v_mul_f32 v221, v221, v217
    v_cvt_pk_bf16_f32 v14, v220, v221
    v_mul_f32_e64 v218, -v218, v10
    v_fma_f32 v11, v219, v219, v4
    v_mfma_f32_16x16x32_bf16 v[116:119], a[176:179], v[36:39], v[116:119]
    v_exp_f32 v218, v218
    v_mfma_f32_16x16x32_bf16 v[120:123], a[160:163], v[40:43], v[120:123]
    s_sub_u32 s90, s90, 4096
    buffer_load_dwordx4 v[24:27], v1, s[8:11], s90 offen offset:0 sc1
    v_add_f32 v218, 1.0, v218
    v_mul_f32 v223, v219, v223
    v_mfma_f32_16x16x32_bf16 v[124:127], a[164:167], v[40:43], v[124:127]
    v_rcp_f32 v218, v218
    v_mfma_f32_16x16x32_bf16 v[128:131], a[168:171], v[40:43], v[128:131]
    v_mul_f32 v222, v222, v218
    v_mul_f32_e64 v219, -v219, v11
    v_exp_f32 v219, v219
    v_mfma_f32_16x16x32_bf16 v[132:135], a[172:175], v[40:43], v[132:135]
    v_add_f32 v219, 1.0, v219
    v_mfma_f32_16x16x32_bf16 v[136:139], a[176:179], v[40:43], v[136:139]
    s_sub_u32 s91, s91, 4096
    buffer_load_dwordx4 v[28:31], v1, s[8:11], s91 offen offset:0 sc1
    v_rcp_f32 v219, v219
    v_mfma_f32_16x16x32_bf16 v[140:143], a[160:163], v[44:47], v[140:143]
    v_mul_f32 v223, v223, v219
    v_cvt_pk_bf16_f32 v15, v222, v223
    v_mfma_f32_16x16x32_bf16 v[144:147], a[164:167], v[44:47], v[144:147]
    v_permlane16_swap_b32 v12, v14
    v_mfma_f32_16x16x32_bf16 v[148:151], a[168:171], v[44:47], v[148:151]
    v_permlane16_swap_b32 v13, v15
    v_mfma_f32_16x16x32_bf16 v[152:155], a[172:175], v[44:47], v[152:155]
    buffer_load_dwordx4 v[32:35], v1, s[8:11], s88 offen offset:1024 sc1
    buffer_store_dwordx4 v[12:15], v3, s[8:11], s93 offen sc1
    v_mfma_f32_16x16x32_bf16 v[156:159], a[176:179], v[44:47], v[156:159]
    v_mfma_f32_16x16x32_bf16 v[80:83], a[180:183], v[48:51], v[80:83]
    s_waitcnt vmcnt(11)
    s_barrier
    s_add_u32 s78, s76, 256
    s_cmp_lg_u32 s52, 0
    s_cbranch_scc1 w097
    s_mov_b64 exec, 1
    v_mov_b32 v6, s78
    v_mov_b32 v7, 1
    global_atomic_add v6, v7, s[40:41] sc1
    s_mov_b64 exec, -1
w097:
    v_mfma_f32_16x16x32_bf16 v[84:87], a[184:187], v[48:51], v[84:87]
    v_mfma_f32_16x16x32_bf16 v[88:91], a[188:191], v[48:51], v[88:91]
    buffer_load_dwordx4 v[168:171], v1, s[8:11], s81 offen offset:1024 sc1
    v_mfma_f32_16x16x32_bf16 v[92:95], a[192:195], v[48:51], v[92:95]
    v_mfma_f32_16x16x32_bf16 v[96:99], a[196:199], v[48:51], v[96:99]
    v_mfma_f32_16x16x32_bf16 v[100:103], a[180:183], v[52:55], v[100:103]
    v_mfma_f32_16x16x32_bf16 v[104:107], a[184:187], v[52:55], v[104:107]
    buffer_load_dwordx4 v[36:39], v1, s[8:11], s89 offen offset:1024 sc1
    v_mfma_f32_16x16x32_bf16 v[108:111], a[188:191], v[52:55], v[108:111]
    v_mfma_f32_16x16x32_bf16 v[112:115], a[192:195], v[52:55], v[112:115]
    v_mfma_f32_16x16x32_bf16 v[116:119], a[196:199], v[52:55], v[116:119]
    v_mfma_f32_16x16x32_bf16 v[120:123], a[180:183], v[56:59], v[120:123]
    buffer_load_dwordx4 v[40:43], v1, s[8:11], s90 offen offset:1024 sc1
    v_mfma_f32_16x16x32_bf16 v[124:127], a[184:187], v[56:59], v[124:127]
    v_mfma_f32_16x16x32_bf16 v[128:131], a[188:191], v[56:59], v[128:131]
    v_mfma_f32_16x16x32_bf16 v[132:135], a[192:195], v[56:59], v[132:135]
    v_mfma_f32_16x16x32_bf16 v[136:139], a[196:199], v[56:59], v[136:139]
    buffer_load_dwordx4 v[44:47], v1, s[8:11], s91 offen offset:1024 sc1
    v_mfma_f32_16x16x32_bf16 v[140:143], a[180:183], v[60:63], v[140:143]
    v_mfma_f32_16x16x32_bf16 v[144:147], a[184:187], v[60:63], v[144:147]
    v_mfma_f32_16x16x32_bf16 v[148:151], a[188:191], v[60:63], v[148:151]
    v_mfma_f32_16x16x32_bf16 v[152:155], a[192:195], v[60:63], v[152:155]
    buffer_load_dwordx4 v[172:175], v1, s[8:11], s81 offen offset:2048 sc1
    v_mfma_f32_16x16x32_bf16 v[156:159], a[196:199], v[60:63], v[156:159]
    v_mfma_f32_16x16x32_bf16 v[80:83], a[200:203], v[64:67], v[80:83]
    v_mfma_f32_16x16x32_bf16 v[84:87], a[204:207], v[64:67], v[84:87]
    v_mfma_f32_16x16x32_bf16 v[88:91], a[208:211], v[64:67], v[88:91]
    buffer_load_dwordx4 v[48:51], v1, s[8:11], s88 offen offset:2048 sc1
    v_mfma_f32_16x16x32_bf16 v[92:95], a[212:215], v[64:67], v[92:95]
    v_mfma_f32_16x16x32_bf16 v[96:99], a[216:219], v[64:67], v[96:99]
    s_waitcnt vmcnt(16)
    v_mfma_f32_16x16x32_bf16 v[100:103], a[200:203], v[68:71], v[100:103]
    v_mfma_f32_16x16x32_bf16 v[104:107], a[204:207], v[68:71], v[104:107]
    buffer_load_dwordx4 v[52:55], v1, s[8:11], s89 offen offset:2048 sc1
    v_mfma_f32_16x16x32_bf16 v[108:111], a[208:211], v[68:71], v[108:111]
    v_mfma_f32_16x16x32_bf16 v[112:115], a[212:215], v[68:71], v[112:115]
    v_mfma_f32_16x16x32_bf16 v[116:119], a[216:219], v[68:71], v[116:119]
    s_waitcnt vmcnt(16)
    v_mfma_f32_16x16x32_bf16 v[120:123], a[200:203], v[72:75], v[120:123]
    buffer_load_dwordx4 v[56:59], v1, s[8:11], s90 offen offset:2048 sc1
    v_mfma_f32_16x16x32_bf16 v[124:127], a[204:207], v[72:75], v[124:127]
    v_mfma_f32_16x16x32_bf16 v[128:131], a[208:211], v[72:75], v[128:131]
    global_load_dword v247, v246, s[40:41] sc1
    v_mfma_f32_16x16x32_bf16 v[132:135], a[212:215], v[72:75], v[132:135]
    v_mfma_f32_16x16x32_bf16 v[136:139], a[216:219], v[72:75], v[136:139]
    buffer_load_dwordx4 v[176:179], v1, s[8:11], s81 offen offset:3072 sc1
    s_waitcnt vmcnt(18)
    v_mfma_f32_16x16x32_bf16 v[140:143], a[200:203], v[76:79], v[140:143]
    v_mfma_f32_16x16x32_bf16 v[144:147], a[204:207], v[76:79], v[144:147]
    v_mfma_f32_16x16x32_bf16 v[148:151], a[208:211], v[76:79], v[148:151]
    v_mfma_f32_16x16x32_bf16 v[152:155], a[212:215], v[76:79], v[152:155]
    buffer_load_dwordx4 v[60:63], v1, s[8:11], s91 offen offset:2048 sc1
    v_mfma_f32_16x16x32_bf16 v[156:159], a[216:219], v[76:79], v[156:159]
    s_waitcnt vmcnt(17)
    v_mfma_f32_16x16x32_bf16 v[80:83], a[80:83], v[16:19], v[80:83]
    v_mfma_f32_16x16x32_bf16 v[84:87], a[84:87], v[16:19], v[84:87]
    v_mfma_f32_16x16x32_bf16 v[88:91], a[88:91], v[16:19], v[88:91]
    buffer_load_dwordx4 v[64:67], v1, s[8:11], s88 offen offset:3072 sc1
    v_mfma_f32_16x16x32_bf16 v[92:95], a[92:95], v[16:19], v[92:95]
    v_mfma_f32_16x16x32_bf16 v[96:99], a[96:99], v[16:19], v[96:99]
    s_waitcnt vmcnt(17)
    v_mfma_f32_16x16x32_bf16 v[100:103], a[80:83], v[20:23], v[100:103]
    v_mfma_f32_16x16x32_bf16 v[104:107], a[84:87], v[20:23], v[104:107]
    buffer_load_dwordx4 v[68:71], v1, s[8:11], s89 offen offset:3072 sc1
    v_mfma_f32_16x16x32_bf16 v[108:111], a[88:91], v[20:23], v[108:111]
    v_mfma_f32_16x16x32_bf16 v[112:115], a[92:95], v[20:23], v[112:115]
    s_waitcnt vmcnt(13)
    s_barrier
    s_add_u32 s78, s76, 512
    s_cmp_lg_u32 s52, 0
    s_cbranch_scc1 w098
    s_mov_b64 exec, 1
    v_mov_b32 v6, s78
    v_mov_b32 v7, 1
    global_atomic_add v6, v7, s[40:41] sc1
    s_mov_b64 exec, -1
w098:
    v_mfma_f32_16x16x32_bf16 v[116:119], a[96:99], v[20:23], v[116:119]
    v_mfma_f32_16x16x32_bf16 v[120:123], a[80:83], v[24:27], v[120:123]
    s_add_u32 s81, s94, 65536
    buffer_load_dwordx4 v[180:183], v1, s[8:11], s81 offen offset:0 sc1
    v_mfma_f32_16x16x32_bf16 v[124:127], a[84:87], v[24:27], v[124:127]
    v_mfma_f32_16x16x32_bf16 v[128:131], a[88:91], v[24:27], v[128:131]
    v_mfma_f32_16x16x32_bf16 v[132:135], a[92:95], v[24:27], v[132:135]
    v_mfma_f32_16x16x32_bf16 v[136:139], a[96:99], v[24:27], v[136:139]
    buffer_load_dwordx4 v[72:75], v1, s[8:11], s90 offen offset:3072 sc1
    v_mfma_f32_16x16x32_bf16 v[140:143], a[80:83], v[28:31], v[140:143]
    v_mfma_f32_16x16x32_bf16 v[144:147], a[84:87], v[28:31], v[144:147]
    v_mfma_f32_16x16x32_bf16 v[148:151], a[88:91], v[28:31], v[148:151]
    v_mfma_f32_16x16x32_bf16 v[152:155], a[92:95], v[28:31], v[152:155]
    buffer_load_dwordx4 v[76:79], v1, s[8:11], s91 offen offset:3072 sc1
    v_mfma_f32_16x16x32_bf16 v[156:159], a[96:99], v[28:31], v[156:159]
    v_mfma_f32_16x16x32_bf16 v[80:83], a[100:103], v[32:35], v[80:83]
    v_mfma_f32_16x16x32_bf16 v[84:87], a[104:107], v[32:35], v[84:87]
    v_mfma_f32_16x16x32_bf16 v[88:91], a[108:111], v[32:35], v[88:91]
    buffer_load_dwordx4 v[184:187], v1, s[8:11], s81 offen offset:1024 sc1
    v_mfma_f32_16x16x32_bf16 v[92:95], a[112:115], v[32:35], v[92:95]
    v_mfma_f32_16x16x32_bf16 v[96:99], a[116:119], v[32:35], v[96:99]
    s_waitcnt vmcnt(15)
    v_mfma_f32_16x16x32_bf16 v[100:103], a[100:103], v[36:39], v[100:103]
    v_mfma_f32_16x16x32_bf16 v[104:107], a[104:107], v[36:39], v[104:107]
    v_mfma_f32_16x16x32_bf16 v[108:111], a[108:111], v[36:39], v[108:111]
    v_mfma_f32_16x16x32_bf16 v[112:115], a[112:115], v[36:39], v[112:115]
    v_mfma_f32_16x16x32_bf16 v[116:119], a[116:119], v[36:39], v[116:119]
    s_waitcnt vmcnt(14)
    v_mfma_f32_16x16x32_bf16 v[120:123], a[100:103], v[40:43], v[120:123]
    v_mfma_f32_16x16x32_bf16 v[124:127], a[104:107], v[40:43], v[124:127]
    v_mfma_f32_16x16x32_bf16 v[128:131], a[108:111], v[40:43], v[128:131]
    v_mfma_f32_16x16x32_bf16 v[132:135], a[112:115], v[40:43], v[132:135]
    v_mfma_f32_16x16x32_bf16 v[136:139], a[116:119], v[40:43], v[136:139]
    s_waitcnt vmcnt(13)
    v_mfma_f32_16x16x32_bf16 v[140:143], a[100:103], v[44:47], v[140:143]
    v_mfma_f32_16x16x32_bf16 v[144:147], a[104:107], v[44:47], v[144:147]
    v_mfma_f32_16x16x32_bf16 v[148:151], a[108:111], v[44:47], v[148:151]
    s_waitcnt vmcnt(8)
    v_cmp_gt_u32 vcc, 16, v247
    s_cbranch_vccz rdy99
    s_mov_b32 s84, 0
spin100:
    global_load_dword v247, v246, s[40:41] sc1
    s_add_u32 s84, s84, 1
    s_cmp_gt_u32 s84, 2000000
    s_cbranch_scc1 spun101
    s_waitcnt vmcnt(0)
    v_cmp_gt_u32 vcc, 16, v247
    s_cbranch_vccnz spin100
spun101:
    s_waitcnt vmcnt(0)
rdy99:
    v_mfma_f32_16x16x32_bf16 v[152:155], a[112:115], v[44:47], v[152:155]
    s_sub_u32 s88, s88, 4096
    buffer_load_dwordx4 v[16:19], v1, s[8:11], s88 offen offset:0 sc1
    v_mfma_f32_16x16x32_bf16 v[156:159], a[116:119], v[44:47], v[156:159]
    v_lshrrev_b32 v8, 4, v0
    v_and_b32 v9, 15, v0
    v_mfma_f32_16x16x32_bf16 v[80:83], a[120:123], v[48:51], v[80:83]
    v_lshrrev_b32 v11, 1, v8
    v_lshlrev_b32 v11, 8, v11
    v_mfma_f32_16x16x32_bf16 v[84:87], a[124:127], v[48:51], v[84:87]
    v_lshl_add_u32 v11, v9, 4, v11
    v_add_u32 v11, 2048, v11
    v_mfma_f32_16x16x32_bf16 v[88:91], a[128:131], v[48:51], v[88:91]
    s_sub_u32 s89, s89, 4096
    buffer_load_dwordx4 v[20:23], v1, s[8:11], s89 offen offset:0 sc1
    v_mfma_f32_16x16x32_bf16 v[92:95], a[132:135], v[48:51], v[92:95]
    v_mov_b32 v15, 0x80000000
    v_and_b32 v12, 16, v0
    v_mfma_f32_16x16x32_bf16 v[96:99], a[136:139], v[48:51], v[96:99]
    v_cmp_eq_u32 s[98:99], 0, v12
    s_lshl_b32 s72, s55, 3
    v_mfma_f32_16x16x32_bf16 v[100:103], a[120:123], v[52:55], v[100:103]
    s_lshl_b32 s73, s56, 2
    s_add_u32 s72, s72, s73
    v_mfma_f32_16x16x32_bf16 v[104:107], a[124:127], v[52:55], v[104:107]
    s_sub_u32 s90, s90, 4096
    buffer_load_dwordx4 v[24:27], v1, s[8:11], s90 offen offset:0 sc1
    v_mfma_f32_16x16x32_bf16 v[108:111], a[128:131], v[52:55], v[108:111]
    s_add_u32 s72, s72, s52
    v_cndmask_b32 v11, v15, v11, s[98:99]
    v_mfma_f32_16x16x32_bf16 v[112:115], a[132:135], v[52:55], v[112:115]
    s_mul_i32 s71, s72, 20480
    s_mul_i32 s72, s72, 20480
    v_mfma_f32_16x16x32_bf16 v[116:119], a[136:139], v[52:55], v[116:119]
    s_mul_i32 s73, s57, 2560
    s_add_u32 s72, s72, s73
    v_mfma_f32_16x16x32_bf16 v[120:123], a[120:123], v[56:59], v[120:123]
    buffer_load_dwordx4 v[188:191], v1, s[8:11], s81 offen offset:2048 sc1
    s_add_u32 s72, s72, 11534336
    v_mfma_f32_16x16x32_bf16 v[124:127], a[124:127], v[56:59], v[124:127]
    s_mul_i32 s64, s52, 15360
    v_add_u32 v204, s64, v2
    v_mfma_f32_16x16x32_bf16 v[128:131], a[128:131], v[56:59], v[128:131]
    s_add_u32 s64, s52, 1
    s_and_b32 s64, s64, 3
    v_mfma_f32_16x16x32_bf16 v[132:135], a[132:135], v[56:59], v[132:135]
    s_mul_i32 s64, s64, 15360
    v_add_u32 v205, s64, v2
    v_mfma_f32_16x16x32_bf16 v[136:139], a[136:139], v[56:59], v[136:139]
    s_sub_u32 s91, s91, 4096
    s_waitcnt vmcnt(10)
    v_mfma_f32_16x16x32_bf16 v[140:143], a[120:123], v[60:63], v[140:143]
    buffer_load_dwordx4 v[28:31], v1, s[8:11], s91 offen offset:0 sc1
    s_add_u32 s64, s52, 2
    v_mfma_f32_16x16x32_bf16 v[144:147], a[124:127], v[60:63], v[144:147]
    s_and_b32 s64, s64, 3
    s_mul_i32 s64, s64, 15360
    v_mfma_f32_16x16x32_bf16 v[148:151], a[128:131], v[60:63], v[148:151]
    v_add_u32 v206, s64, v2
    s_add_u32 s64, s52, 3
    v_mfma_f32_16x16x32_bf16 v[152:155], a[132:135], v[60:63], v[152:155]
    buffer_load_dwordx4 v[32:35], v1, s[8:11], s88 offen offset:1024 sc1
    s_and_b32 s64, s64, 3
    v_mfma_f32_16x16x32_bf16 v[156:159], a[136:139], v[60:63], v[156:159]
    s_mul_i32 s64, s64, 15360
    s_waitcnt vmcnt(11)
    v_mfma_f32_16x16x32_bf16 v[80:83], v[224:227], v[64:67], v[80:83]
    v_add_u32 v207, s64, v2
    s_mul_i32 s73, s57, 160
    v_mfma_f32_16x16x32_bf16 v[84:87], v[228:231], v[64:67], v[84:87]
    s_add_u32 s71, s71, s73
    v_mul_u32_u24 v10, 1280, v9
    v_mfma_f32_16x16x32_bf16 v[88:91], v[232:235], v[64:67], v[88:91]
    buffer_load_dwordx4 v[36:39], v1, s[8:11], s89 offen offset:1024 sc1
    v_lshrrev_b32 v13, 1, v8
    v_mfma_f32_16x16x32_bf16 v[92:95], v[236:239], v[64:67], v[92:95]
    v_lshl_add_u32 v13, v13, 4, v10
    v_lshl_add_u32 v10, v8, 4, v10
    v_mfma_f32_16x16x32_bf16 v[96:99], v[160:163], v[64:67], v[96:99]
    v_cndmask_b32 v13, v15, v13, s[98:99]
    s_waitcnt vmcnt(11)
    v_mfma_f32_16x16x32_bf16 v[100:103], v[224:227], v[68:71], v[100:103]
    s_mov_b32 s12, s36
    s_mov_b32 s13, s37
    v_mfma_f32_16x16x32_bf16 v[104:107], v[228:231], v[68:71], v[104:107]
    buffer_load_dwordx4 v[192:195], v1, s[8:11], s81 offen offset:3072 sc1
    s_mov_b32 s14, 2621440
    v_mfma_f32_16x16x32_bf16 v[108:111], v[232:235], v[68:71], v[108:111]
    s_mov_b32 s15, 0x20000
    s_mov_b32 s96, 0x4091afa4
    v_mfma_f32_16x16x32_bf16 v[112:115], v[236:239], v[68:71], v[112:115]
    v_mfma_f32_16x16x32_bf16 v[116:119], v[160:163], v[68:71], v[116:119]
    s_waitcnt vmcnt(10)
    v_mfma_f32_16x16x32_bf16 v[120:123], v[224:227], v[72:75], v[120:123]
    buffer_load_dwordx4 v[40:43], v1, s[8:11], s90 offen offset:1024 sc1
    v_mfma_f32_16x16x32_bf16 v[124:127], v[228:231], v[72:75], v[124:127]
    v_mfma_f32_16x16x32_bf16 v[128:131], v[232:235], v[72:75], v[128:131]
    global_load_dword v247, v248, s[40:41] sc1
    v_mfma_f32_16x16x32_bf16 v[132:135], v[236:239], v[72:75], v[132:135]
    v_mfma_f32_16x16x32_bf16 v[136:139], v[160:163], v[72:75], v[136:139]
    buffer_load_dwordx4 v[44:47], v1, s[8:11], s91 offen offset:1024 sc1
    s_waitcnt vmcnt(12)
    v_mfma_f32_16x16x32_bf16 v[140:143], v[224:227], v[76:79], v[140:143]
    v_mfma_f32_16x16x32_bf16 v[144:147], v[228:231], v[76:79], v[144:147]
    v_mfma_f32_16x16x32_bf16 v[148:151], v[232:235], v[76:79], v[148:151]
    v_mfma_f32_16x16x32_bf16 v[152:155], v[236:239], v[76:79], v[152:155]
    buffer_load_dwordx4 v[48:51], v1, s[8:11], s88 offen offset:2048 sc1
    v_mfma_f32_16x16x32_bf16 v[156:159], v[160:163], v[76:79], v[156:159]
    s_waitcnt vmcnt(11)
    v_mfma_f32_16x16x32_bf16 v[80:83], a[0:3], v[16:19], v[80:83]
    v_mfma_f32_16x16x32_bf16 v[84:87], a[4:7], v[16:19], v[84:87]
    v_mfma_f32_16x16x32_bf16 v[88:91], a[8:11], v[16:19], v[88:91]
    s_add_u32 s81, s94, 69632
    buffer_load_dwordx4 v[196:199], v1, s[8:11], s81 offen offset:0 sc1
    v_mfma_f32_16x16x32_bf16 v[92:95], a[12:15], v[16:19], v[92:95]
    v_mfma_f32_16x16x32_bf16 v[96:99], a[16:19], v[16:19], v[96:99]
    s_waitcnt vmcnt(11)
    v_mfma_f32_16x16x32_bf16 v[100:103], a[0:3], v[20:23], v[100:103]
    v_mfma_f32_16x16x32_bf16 v[104:107], a[4:7], v[20:23], v[104:107]
    buffer_load_dwordx4 v[52:55], v1, s[8:11], s89 offen offset:2048 sc1
    v_mfma_f32_16x16x32_bf16 v[108:111], a[8:11], v[20:23], v[108:111]
    v_mfma_f32_16x16x32_bf16 v[112:115], a[12:15], v[20:23], v[112:115]
    v_mfma_f32_16x16x32_bf16 v[116:119], a[16:19], v[20:23], v[116:119]
    s_waitcnt vmcnt(11)
    v_mfma_f32_16x16x32_bf16 v[120:123], a[0:3], v[24:27], v[120:123]
    buffer_load_dwordx4 v[56:59], v1, s[8:11], s90 offen offset:2048 sc1
    v_mfma_f32_16x16x32_bf16 v[124:127], a[4:7], v[24:27], v[124:127]
    v_mfma_f32_16x16x32_bf16 v[128:131], a[8:11], v[24:27], v[128:131]
    v_mfma_f32_16x16x32_bf16 v[132:135], a[12:15], v[24:27], v[132:135]
    v_mfma_f32_16x16x32_bf16 v[136:139], a[16:19], v[24:27], v[136:139]
    buffer_load_dwordx4 v[60:63], v1, s[8:11], s91 offen offset:2048 sc1
    s_waitcnt vmcnt(11)
    v_mfma_f32_16x16x32_bf16 v[140:143], a[0:3], v[28:31], v[140:143]
    v_mfma_f32_16x16x32_bf16 v[144:147], a[4:7], v[28:31], v[144:147]
    v_mfma_f32_16x16x32_bf16 v[148:151], a[8:11], v[28:31], v[148:151]
    v_mfma_f32_16x16x32_bf16 v[152:155], a[12:15], v[28:31], v[152:155]
    buffer_load_dwordx4 v[200:203], v1, s[8:11], s81 offen offset:1024 sc1
    v_mfma_f32_16x16x32_bf16 v[156:159], a[16:19], v[28:31], v[156:159]
    s_waitcnt vmcnt(11)
    v_mfma_f32_16x16x32_bf16 v[80:83], a[20:23], v[32:35], v[80:83]
    v_mfma_f32_16x16x32_bf16 v[84:87], a[24:27], v[32:35], v[84:87]
    v_mfma_f32_16x16x32_bf16 v[88:91], a[28:31], v[32:35], v[88:91]
    buffer_load_dwordx4 v[64:67], v1, s[8:11], s88 offen offset:3072 sc1
    v_mfma_f32_16x16x32_bf16 v[92:95], a[32:35], v[32:35], v[92:95]
    v_mfma_f32_16x16x32_bf16 v[96:99], a[36:39], v[32:35], v[96:99]
    s_waitcnt vmcnt(11)
    v_mfma_f32_16x16x32_bf16 v[100:103], a[20:23], v[36:39], v[100:103]
    v_mfma_f32_16x16x32_bf16 v[104:107], a[24:27], v[36:39], v[104:107]
    buffer_load_dwordx4 v[68:71], v1, s[8:11], s89 offen offset:3072 sc1
    v_mfma_f32_16x16x32_bf16 v[108:111], a[28:31], v[36:39], v[108:111]
    v_mfma_f32_16x16x32_bf16 v[112:115], a[32:35], v[36:39], v[112:115]
    v_mfma_f32_16x16x32_bf16 v[116:119], a[36:39], v[36:39], v[116:119]
    s_waitcnt vmcnt(10)
    v_mfma_f32_16x16x32_bf16 v[120:123], a[20:23], v[40:43], v[120:123]
    buffer_load_dwordx4 v[72:75], v1, s[8:11], s90 offen offset:3072 sc1
    v_mfma_f32_16x16x32_bf16 v[124:127], a[24:27], v[40:43], v[124:127]
    v_mfma_f32_16x16x32_bf16 v[128:131], a[28:31], v[40:43], v[128:131]
    v_mfma_f32_16x16x32_bf16 v[132:135], a[32:35], v[40:43], v[132:135]
    v_mfma_f32_16x16x32_bf16 v[136:139], a[36:39], v[40:43], v[136:139]
    buffer_load_dwordx4 v[76:79], v1, s[8:11], s91 offen offset:3072 sc1
    s_waitcnt vmcnt(10)
    v_mfma_f32_16x16x32_bf16 v[140:143], a[20:23], v[44:47], v[140:143]
    v_mfma_f32_16x16x32_bf16 v[144:147], a[24:27], v[44:47], v[144:147]
    v_mfma_f32_16x16x32_bf16 v[148:151], a[28:31], v[44:47], v[148:151]
    v_cmp_gt_u32 vcc, 16, v247
    s_cbranch_vccz rdy102
    s_mov_b32 s84, 0
spin103:
    global_load_dword v247, v248, s[40:41] sc1
    s_add_u32 s84, s84, 1
    s_cmp_gt_u32 s84, 2000000
    s_cbranch_scc1 spun104
    s_waitcnt vmcnt(0)
    v_cmp_gt_u32 vcc, 16, v247
    s_cbranch_vccnz spin103
spun104:
    s_waitcnt vmcnt(0)
rdy102:
    v_mfma_f32_16x16x32_bf16 v[152:155], a[32:35], v[44:47], v[152:155]
    s_add_u32 s89, s89, 12288
    buffer_load_dwordx4 v[20:23], v1, s[8:11], s89 offen offset:0 sc1
    v_mfma_f32_16x16x32_bf16 v[156:159], a[36:39], v[44:47], v[156:159]
    s_waitcnt vmcnt(10)
    v_mfma_f32_16x16x32_bf16 v[80:83], a[40:43], v[48:51], v[80:83]
    v_mfma_f32_16x16x32_bf16 v[84:87], a[44:47], v[48:51], v[84:87]
    v_mfma_f32_16x16x32_bf16 v[88:91], a[48:51], v[48:51], v[88:91]
    buffer_load_dwordx4 v[36:39], v1, s[8:11], s89 offen offset:1024 sc1
    v_mfma_f32_16x16x32_bf16 v[92:95], a[52:55], v[48:51], v[92:95]
    v_mfma_f32_16x16x32_bf16 v[96:99], a[56:59], v[48:51], v[96:99]
    s_waitcnt vmcnt(9)
    v_mfma_f32_16x16x32_bf16 v[100:103], a[40:43], v[52:55], v[100:103]
    v_mfma_f32_16x16x32_bf16 v[104:107], a[44:47], v[52:55], v[104:107]
    s_add_u32 s90, s90, 12288
    buffer_load_dwordx4 v[24:27], v1, s[8:11], s90 offen offset:0 sc1
    v_mfma_f32_16x16x32_bf16 v[108:111], a[48:51], v[52:55], v[108:111]
    v_mfma_f32_16x16x32_bf16 v[112:115], a[52:55], v[52:55], v[112:115]
    v_mfma_f32_16x16x32_bf16 v[116:119], a[56:59], v[52:55], v[116:119]
    s_waitcnt vmcnt(9)
    v_mfma_f32_16x16x32_bf16 v[120:123], a[40:43], v[56:59], v[120:123]
    buffer_load_dwordx4 v[40:43], v1, s[8:11], s90 offen offset:1024 sc1
    v_mfma_f32_16x16x32_bf16 v[124:127], a[44:47], v[56:59], v[124:127]
    v_mfma_f32_16x16x32_bf16 v[128:131], a[48:51], v[56:59], v[128:131]
    v_mfma_f32_16x16x32_bf16 v[132:135], a[52:55], v[56:59], v[132:135]
    v_mfma_f32_16x16x32_bf16 v[136:139], a[56:59], v[56:59], v[136:139]
    s_add_u32 s91, s91, 12288
    s_waitcnt vmcnt(9)
    v_mfma_f32_16x16x32_bf16 v[140:143], a[40:43], v[60:63], v[140:143]
    buffer_load_dwordx4 v[28:31], v1, s[8:11], s91 offen offset:0 sc1
    v_mfma_f32_16x16x32_bf16 v[144:147], a[44:47], v[60:63], v[144:147]
    v_mfma_f32_16x16x32_bf16 v[148:151], a[48:51], v[60:63], v[148:151]
    v_mfma_f32_16x16x32_bf16 v[152:155], a[52:55], v[60:63], v[152:155]
    buffer_load_dwordx4 v[44:47], v1, s[8:11], s91 offen offset:1024 sc1
    v_mfma_f32_16x16x32_bf16 v[156:159], a[56:59], v[60:63], v[156:159]
    s_waitcnt vmcnt(9)
    v_mfma_f32_16x16x32_bf16 v[80:83], a[60:63], v[64:67], v[80:83]
    v_mfma_f32_16x16x32_bf16 v[84:87], a[64:67], v[64:67], v[84:87]
    v_mfma_f32_16x16x32_bf16 v[88:91], a[68:71], v[64:67], v[88:91]
    s_add_u32 s88, s88, 12288
    buffer_load_dwordx4 v[16:19], v1, s[8:11], s88 offen offset:0 sc1
    v_mfma_f32_16x16x32_bf16 v[92:95], a[72:75], v[64:67], v[92:95]
    buffer_load_dwordx4 v[48:51], v1, s[8:11], s72 offen sc1
    buffer_load_dwordx4 v[52:55], v1, s[8:11], s72 offen offset:1024 sc1
    v_mfma_f32_16x16x32_bf16 v[96:99], a[76:79], v[64:67], v[96:99]
    buffer_load_dwordx4 v[56:59], v11, s[8:11], s72 offen sc1
    s_waitcnt vmcnt(12)
    v_mfma_f32_16x16x32_bf16 v[100:103], a[60:63], v[68:71], v[100:103]
    v_mfma_f32_16x16x32_bf16 v[104:107], a[64:67], v[68:71], v[104:107]
    buffer_load_dwordx4 v[32:35], v1, s[8:11], s88 offen offset:1024 sc1
    v_mfma_f32_16x16x32_bf16 v[108:111], a[68:71], v[68:71], v[108:111]
    v_mfma_f32_16x16x32_bf16 v[112:115], a[72:75], v[68:71], v[112:115]
    v_mfma_f32_16x16x32_bf16 v[116:119], a[76:79], v[68:71], v[116:119]
    s_waitcnt vmcnt(12)
    v_mfma_f32_16x16x32_bf16 v[120:123], a[60:63], v[72:75], v[120:123]
    v_mfma_f32_16x16x32_bf16 v[124:127], a[64:67], v[72:75], v[124:127]
    v_mfma_f32_16x16x32_bf16 v[128:131], a[68:71], v[72:75], v[128:131]
    v_mfma_f32_16x16x32_bf16 v[132:135], a[72:75], v[72:75], v[132:135]
    v_mfma_f32_16x16x32_bf16 v[136:139], a[76:79], v[72:75], v[136:139]
    s_waitcnt vmcnt(11)
    v_mfma_f32_16x16x32_bf16 v[140:143], a[60:63], v[76:79], v[140:143]
    v_mfma_f32_16x16x32_bf16 v[144:147], a[64:67], v[76:79], v[144:147]
    s_branch L_past11
L_page11:
    s_setpc_b64 s[98:99]
L_past11:
    v_mfma_f32_16x16x32_bf16 v[148:151], a[68:71], v[76:79], v[148:151]
    v_mfma_f32_16x16x32_bf16 v[152:155], a[72:75], v[76:79], v[152:155]
    v_mfma_f32_16x16x32_bf16 v[156:159], a[76:79], v[76:79], v[156:159]
    s_waitcnt vmcnt(10)
    v_mfma_f32_16x16x32_bf16 v[100:103], v[164:167], v[20:23], v[100:103]
    v_mfma_f32_16x16x32_bf16 v[104:107], v[168:171], v[20:23], v[104:107]
    v_mfma_f32_16x16x32_bf16 v[108:111], v[172:175], v[20:23], v[108:111]
    v_mfma_f32_16x16x32_bf16 v[112:115], v[176:179], v[20:23], v[112:115]
    v_mfma_f32_16x16x32_bf16 v[116:119], v[180:183], v[20:23], v[116:119]
    s_waitcnt vmcnt(9)
    v_mfma_f32_16x16x32_bf16 v[100:103], v[184:187], v[36:39], v[100:103]
    v_mfma_f32_16x16x32_bf16 v[104:107], v[188:191], v[36:39], v[104:107]
    v_mfma_f32_16x16x32_bf16 v[108:111], v[192:195], v[36:39], v[108:111]
    v_mfma_f32_16x16x32_bf16 v[112:115], v[196:199], v[36:39], v[112:115]
    v_mfma_f32_16x16x32_bf16 v[116:119], v[200:203], v[36:39], v[116:119]
    s_waitcnt vmcnt(8)
    v_mfma_f32_16x16x32_bf16 v[120:123], v[164:167], v[24:27], v[120:123]
    s_nop 1
    ds_write_b128 v205, v[100:103] offset:0
    v_mfma_f32_16x16x32_bf16 v[124:127], v[168:171], v[24:27], v[124:127]
    ds_write_b128 v205, v[104:107] offset:1024
    v_mfma_f32_16x16x32_bf16 v[128:131], v[172:175], v[24:27], v[128:131]
    ds_write_b128 v205, v[108:111] offset:2048
    v_mfma_f32_16x16x32_bf16 v[132:135], v[176:179], v[24:27], v[132:135]
    ds_write_b128 v205, v[112:115] offset:3072
    v_mfma_f32_16x16x32_bf16 v[136:139], v[180:183], v[24:27], v[136:139]
    ds_write_b128 v205, v[116:119] offset:4096
    s_waitcnt vmcnt(7)
    v_mfma_f32_16x16x32_bf16 v[120:123], v[184:187], v[40:43], v[120:123]
    v_mfma_f32_16x16x32_bf16 v[124:127], v[188:191], v[40:43], v[124:127]
    v_mfma_f32_16x16x32_bf16 v[128:131], v[192:195], v[40:43], v[128:131]
    v_mfma_f32_16x16x32_bf16 v[132:135], v[196:199], v[40:43], v[132:135]
    v_mfma_f32_16x16x32_bf16 v[136:139], v[200:203], v[40:43], v[136:139]
    s_waitcnt vmcnt(6)
    v_mfma_f32_16x16x32_bf16 v[140:143], v[164:167], v[28:31], v[140:143]
    s_nop 1
    ds_write_b128 v206, v[120:123] offset:5120
    v_mfma_f32_16x16x32_bf16 v[144:147], v[168:171], v[28:31], v[144:147]
    ds_write_b128 v206, v[124:127] offset:6144
    v_mfma_f32_16x16x32_bf16 v[148:151], v[172:175], v[28:31], v[148:151]
    ds_write_b128 v206, v[128:131] offset:7168
    v_mfma_f32_16x16x32_bf16 v[152:155], v[176:179], v[28:31], v[152:155]
    ds_write_b128 v206, v[132:135] offset:8192
    v_mfma_f32_16x16x32_bf16 v[156:159], v[180:183], v[28:31], v[156:159]
    ds_write_b128 v206, v[136:139] offset:9216
    s_waitcnt vmcnt(5)
    v_mfma_f32_16x16x32_bf16 v[140:143], v[184:187], v[44:47], v[140:143]
    v_mfma_f32_16x16x32_bf16 v[144:147], v[188:191], v[44:47], v[144:147]
    v_mfma_f32_16x16x32_bf16 v[148:151], v[192:195], v[44:47], v[148:151]
    v_mfma_f32_16x16x32_bf16 v[152:155], v[196:199], v[44:47], v[152:155]
    v_mfma_f32_16x16x32_bf16 v[156:159], v[200:203], v[44:47], v[156:159]
    s_waitcnt vmcnt(4)
    v_mfma_f32_16x16x32_bf16 v[80:83], v[164:167], v[16:19], v[80:83]
    s_nop 1
    ds_write_b128 v207, v[140:143] offset:10240
    v_mfma_f32_16x16x32_bf16 v[84:87], v[168:171], v[16:19], v[84:87]
    ds_write_b128 v207, v[144:147] offset:11264
    v_mfma_f32_16x16x32_bf16 v[88:91], v[172:175], v[16:19], v[88:91]
    ds_write_b128 v207, v[148:151] offset:12288
    v_mfma_f32_16x16x32_bf16 v[92:95], v[176:179], v[16:19], v[92:95]
    ds_write_b128 v207, v[152:155] offset:13312
    v_mfma_f32_16x16x32_bf16 v[96:99], v[180:183], v[16:19], v[96:99]
    s_waitcnt lgkmcnt(4)
    s_barrier
    s_waitcnt vmcnt(0)
    v_mfma_f32_16x16x32_bf16 v[80:83], v[184:187], v[32:35], v[80:83]
    ds_read_b128 v[64:67], v204 offset:0
    ds_read_b128 v[68:71], v204 offset:1024
    v_mfma_f32_16x16x32_bf16 v[84:87], v[188:191], v[32:35], v[84:87]
    ds_read_b128 v[72:75], v204 offset:2048
    ds_read_b128 v[76:79], v204 offset:3072
    v_mfma_f32_16x16x32_bf16 v[88:91], v[192:195], v[32:35], v[88:91]
    ds_read_b128 v[208:211], v204 offset:4096
    ds_read_b128 v[212:215], v204 offset:5120
    v_mfma_f32_16x16x32_bf16 v[92:95], v[196:199], v[32:35], v[92:95]
    ds_read_b128 v[216:219], v204 offset:6144
    ds_read_b128 v[220:223], v204 offset:7168
    v_mfma_f32_16x16x32_bf16 v[96:99], v[200:203], v[32:35], v[96:99]
    ds_write_b128 v207, v[156:159] offset:14336
    s_waitcnt lgkmcnt(0)
    s_barrier
    ds_read_b128 v[224:227], v204 offset:8192
    ds_read_b128 v[228:231], v204 offset:9216
    ds_read_b128 v[232:235], v204 offset:10240
    ds_read_b128 v[236:239], v204 offset:11264
    ds_read_b128 v[160:163], v204 offset:12288
    ds_read_b128 v[164:167], v204 offset:13312
    ds_read_b128 v[168:171], v204 offset:14336
    v_lshlrev_b32 v16, 16, v48
    v_and_b32 v17, s60, v48
    v_lshlrev_b32 v18, 16, v49
    v_and_b32 v19, s60, v49
    v_lshlrev_b32 v20, 16, v50
    v_and_b32 v21, s60, v50
    v_lshlrev_b32 v22, 16, v51
    v_and_b32 v23, s60, v51
    v_lshlrev_b32 v24, 16, v52
    v_and_b32 v25, s60, v52
    v_lshlrev_b32 v26, 16, v53
    v_and_b32 v27, s60, v53
    v_lshlrev_b32 v28, 16, v54
    v_and_b32 v29, s60, v54
    v_lshlrev_b32 v30, 16, v55
    v_and_b32 v31, s60, v55
    v_lshlrev_b32 v32, 16, v56
    v_and_b32 v33, s60, v56
    v_lshlrev_b32 v34, 16, v57
    v_and_b32 v35, s60, v57
    v_lshlrev_b32 v36, 16, v58
    v_and_b32 v37, s60, v58
    v_lshlrev_b32 v38, 16, v59
    v_and_b32 v39, s60, v59
    v_pk_add_f32 v[80:81], v[80:81], v[64:65]
    v_pk_add_f32 v[82:83], v[82:83], v[66:67]
    v_pk_add_f32 v[84:85], v[84:85], v[68:69]
    v_pk_add_f32 v[86:87], v[86:87], v[70:71]
    v_pk_add_f32 v[88:89], v[88:89], v[72:73]
    v_pk_add_f32 v[90:91], v[90:91], v[74:75]
    v_pk_add_f32 v[92:93], v[92:93], v[76:77]
    v_pk_add_f32 v[94:95], v[94:95], v[78:79]
    v_pk_add_f32 v[96:97], v[96:97], v[208:209]
    v_pk_add_f32 v[98:99], v[98:99], v[210:211]
    v_pk_add_f32 v[80:81], v[80:81], v[212:213]
    v_pk_add_f32 v[82:83], v[82:83], v[214:215]
    v_pk_add_f32 v[84:85], v[84:85], v[216:217]
    v_pk_add_f32 v[86:87], v[86:87], v[218:219]
    v_pk_add_f32 v[88:89], v[88:89], v[220:221]
    v_pk_add_f32 v[90:91], v[90:91], v[222:223]
    s_waitcnt lgkmcnt(6)
    v_pk_add_f32 v[92:93], v[92:93], v[224:225]
    v_pk_add_f32 v[94:95], v[94:95], v[226:227]
    s_waitcnt lgkmcnt(5)
    v_pk_add_f32 v[96:97], v[96:97], v[228:229]
    v_pk_add_f32 v[98:99], v[98:99], v[230:231]
    s_waitcnt lgkmcnt(4)
    v_pk_add_f32 v[80:81], v[80:81], v[232:233]
    v_pk_add_f32 v[82:83], v[82:83], v[234:235]
    s_waitcnt lgkmcnt(3)
    v_pk_add_f32 v[84:85], v[84:85], v[236:237]
    v_pk_add_f32 v[86:87], v[86:87], v[238:239]
    s_waitcnt lgkmcnt(2)
    v_pk_add_f32 v[88:89], v[88:89], v[160:161]
    v_pk_add_f32 v[90:91], v[90:91], v[162:163]
    s_waitcnt lgkmcnt(1)
    v_pk_add_f32 v[92:93], v[92:93], v[164:165]
    v_pk_add_f32 v[94:95], v[94:95], v[166:167]
    s_waitcnt lgkmcnt(0)
    v_pk_add_f32 v[96:97], v[96:97], v[168:169]
    v_pk_add_f32 v[98:99], v[98:99], v[170:171]
    v_pk_fma_f32 v[80:81], v[80:81], s[96:97], v[16:17] op_sel_hi:[1,0,1]
    v_pk_fma_f32 v[82:83], v[82:83], s[96:97], v[18:19] op_sel_hi:[1,0,1]
    v_pk_fma_f32 v[84:85], v[84:85], s[96:97], v[20:21] op_sel_hi:[1,0,1]
    v_pk_fma_f32 v[86:87], v[86:87], s[96:97], v[22:23] op_sel_hi:[1,0,1]
    v_cvt_pk_bf16_f32 v60, v80, v81
    v_cvt_pk_bf16_f32 v61, v82, v83
    v_cvt_pk_bf16_f32 v62, v84, v85
    v_cvt_pk_bf16_f32 v63, v86, v87
    buffer_store_dwordx4 v[60:63], v10, s[12:15], s71 offen offset:0
    v_pk_fma_f32 v[88:89], v[88:89], s[96:97], v[24:25] op_sel_hi:[1,0,1]
    v_pk_fma_f32 v[90:91], v[90:91], s[96:97], v[26:27] op_sel_hi:[1,0,1]
    v_pk_fma_f32 v[92:93], v[92:93], s[96:97], v[28:29] op_sel_hi:[1,0,1]
    v_pk_fma_f32 v[94:95], v[94:95], s[96:97], v[30:31] op_sel_hi:[1,0,1]
    v_cvt_pk_bf16_f32 v64, v88, v89
    v_cvt_pk_bf16_f32 v65, v90, v91
    v_cvt_pk_bf16_f32 v66, v92, v93
    v_cvt_pk_bf16_f32 v67, v94, v95
    buffer_store_dwordx4 v[64:67], v10, s[12:15], s71 offen offset:64
    v_mov_b32 v44, v96
    v_mov_b32 v45, v97
    v_mov_b32 v46, v98
    v_mov_b32 v47, v99
    v_permlane16_swap_b32 v96, v44
    v_permlane16_swap_b32 v97, v45
    v_permlane16_swap_b32 v98, v46
    v_permlane16_swap_b32 v99, v47
    v_pk_fma_f32 v[96:97], v[96:97], s[96:97], v[32:33] op_sel_hi:[1,0,1]
    v_pk_fma_f32 v[98:99], v[98:99], s[96:97], v[34:35] op_sel_hi:[1,0,1]
    v_pk_fma_f32 v[44:45], v[44:45], s[96:97], v[36:37] op_sel_hi:[1,0,1]
    v_pk_fma_f32 v[46:47], v[46:47], s[96:97], v[38:39] op_sel_hi:[1,0,1]
    v_cvt_pk_bf16_f32 v68, v96, v97
    v_cvt_pk_bf16_f32 v69, v98, v99
    v_cvt_pk_bf16_f32 v70, v44, v45
    v_cvt_pk_bf16_f32 v71, v46, v47
    buffer_store_dwordx4 v[68:71], v13, s[12:15], s71 offen offset:128
    s_or_b32 s64, s2, s52
    s_cmp_lg_u32 s64, 0
    s_cbranch_scc1 epo105
    s_mov_b64 exec, 1
    v_mov_b32 v6, 40960
    v_mov_b32 v7, s42
    global_store_dword v6, v7, s[40:41] sc1
    s_mov_b64 exec, -1
epo105:
L_exit:
    s_endpgm
.section .rodata,"a"
.p2align 6
.amdhsa_kernel interleave_layers__ssm_conv_h3__glu_gated_geglu__prompt_kernel
  .amdhsa_next_free_vgpr 512
  .amdhsa_next_free_sgpr 102
  .amdhsa_accum_offset 256
  .amdhsa_group_segment_fixed_size 0
  .amdhsa_kernarg_size 104
  .amdhsa_user_sgpr_count 2
  .amdhsa_user_sgpr_kernarg_segment_ptr 1
  .amdhsa_system_sgpr_workgroup_id_x 1
  .amdhsa_float_denorm_mode_32 3
.end_amdhsa_kernel
```
